```python
import torch

def _softmax(x, axis=-1):
    return torch.softmax(x, dim=axis)
def _gelu(x):
    return torch.nn.functional.gelu(x, approximate="tanh")
def _silu(x):
    return torch.nn.functional.silu(x)
def _sigmoid(x):
    return torch.sigmoid(x)
def _layernorm(x, axis=-1, eps=1e-5):
    m = x.mean(dim=axis, keepdim=True)
    v = x.var(dim=axis, keepdim=True, unbiased=False)
    return (x - m) / torch.sqrt(v + eps)
def _scatter_add(tgt, idx, src, axis=0):
    return tgt.clone().index_add_(axis, idx, src)
def _segment_sum(src, seg, n):
    out = torch.zeros((n,) + src.shape[1:], dtype=src.dtype)
    return out.index_add_(0, seg, src)
def _pad(x, pw):
    flat = tuple(v for pair in reversed(pw) for v in pair)
    return torch.nn.functional.pad(x, flat)

kernel_name = 'concat_heads__linear_kernel_hedgehog__sliding_local_dilated__prompt'

def setup_inputs():

    _w = (lambda a: (lambda t: t.to(torch.bfloat16) if t.is_floating_point() else t)(torch.as_tensor(a)))
    def _A_setup():
        B, S, D, H = 1, 2048, 576, 32
        Dh = D // H
        return {
            "x": _w((lambda *s: torch.randn(*s, dtype=torch.bfloat16) * 0.2)(B, S, D)),
            "wqkv": _w((lambda *s: torch.randn(*s, dtype=torch.bfloat16) * 0.8)(D, 3 * D)),
            "w_phi": _w((lambda *s: torch.randn(*s, dtype=torch.bfloat16) * 0.8)(H, Dh, Dh) * (Dh ** -0.5)),
            "wo": _w((lambda *s: torch.randn(*s, dtype=torch.bfloat16) * 0.2)(D, D)),
        }
    _A_in = _A_setup()

    def _B_setup():
        B, S, D = 1, 2048, 576
        return {
            "x": _w((lambda *s: torch.randn(*s, dtype=torch.bfloat16) * 0.2)(B, S, D)),
            "wqkv": _w((lambda *s: torch.randn(*s, dtype=torch.bfloat16) * 0.2)(D, 3 * D)),
            "wo": _w((lambda *s: torch.randn(*s, dtype=torch.bfloat16) * 0.05)(D, D)),
        }
    _B_in = _B_setup()

    return {
        "A_x": _A_in["x"],
        "A_wqkv": _A_in["wqkv"],
        "A_w_phi": _A_in["w_phi"],
        "A_wo": _A_in["wo"],
        "B_x": _B_in["x"],
        "B_wqkv": _B_in["wqkv"],
        "B_wo": _B_in["wo"],
    }

def reference(A_x, A_wqkv, A_w_phi, A_wo, B_x, B_wqkv, B_wo):
    def _A_ref(x, wqkv, w_phi, wo):
        B, S, D = x.shape
        H = 32; Dh = D // H
        qkv = (lambda x, *d: x.permute(*d))((x @ wqkv).reshape(B, S, 3, H, Dh), 2, 0, 3, 1, 4)
        q, k, v = qkv[0], qkv[1], qkv[2]
        pq = torch.einsum("bhsd,hdf->bhsf", q, w_phi)
        pk = torch.einsum("bhsd,hdf->bhsf", k, w_phi)
        phi_q = torch.concatenate([_softmax(pq, axis=-1), _softmax(-pq, axis=-1)], axis=-1)
        phi_k = torch.concatenate([_softmax(pk, axis=-1), _softmax(-pk, axis=-1)], axis=-1)
        kv = torch.einsum("bhsf,bhsd->bhfd", phi_k, v)
        z  = torch.einsum("bhsf->bhf", phi_k)
        num = torch.einsum("bhqf,bhfd->bhqd", phi_q, kv)
        den = torch.einsum("bhqf,bhf->bhq", phi_q, z)[..., None] + 1e-6
        o = num / den
        return (lambda x, *d: x.permute(*d))(o, 0, 2, 1, 3).reshape(B, S, D) @ wo

    def _B_ref(x, wqkv, wo):
        B, S, D = x.shape
        H = 32; Dh = D // H
        W, dil = 8, 2
        qkv = (lambda x, *d: x.permute(*d))((x @ wqkv).reshape(B, S, 3, H, Dh), 2, 0, 3, 1, 4)
        q, k, v = qkv[0], qkv[1], qkv[2]
        scale = Dh ** -0.5
        pos = torch.arange(S)
        off = torch.arange(W) * dil
        idx = pos[:, None] - off[None, :]
        mask = idx >= 0
        idx_c = torch.where(mask, idx, 0).reshape(-1)
        kg = k[:, :, idx_c, :].reshape(B, H, S, W, Dh)
        vg = v[:, :, idx_c, :].reshape(B, H, S, W, Dh)
        logits = torch.einsum("bhsd,bhswd->bhsw", q, kg) * scale
        logits = torch.where(mask[None, None, :, :], logits, -1e9)
        attn = _softmax(logits, axis=-1)
        o = torch.einsum("bhsw,bhswd->bhsd", attn, vg)
        return (lambda x, *d: x.permute(*d))(o, 0, 2, 1, 3).reshape(B, S, D) @ wo

    a = _A_ref(A_x, A_wqkv, A_w_phi, A_wo)
    b = _B_ref(B_x, B_wqkv, B_wo)
    return torch.concatenate([a, b], axis=-1)
```

```asm
; @launch grid=(256,1,1) block=(512,1,1) lds=163840
.amdgcn_target "amdgcn-amd-amdhsa--gfx950"
.text
.globl concat_heads__linear_kernel_hedgehog__sliding_local_dilated__prompt_kernel
.p2align 8
.type concat_heads__linear_kernel_hedgehog__sliding_local_dilated__prompt_kernel,@function
concat_heads__linear_kernel_hedgehog__sliding_local_dilated__prompt_kernel:
    s_cmp_ge_u32 s2, 256
    s_cbranch_scc1 L_end
    s_load_dwordx4 s[12:15], s[0:1], 0
    s_load_dwordx4 s[16:19], s[0:1], 32
    s_load_dwordx4 s[20:23], s[0:1], 16
    s_load_dwordx4 s[52:55], s[0:1], 64
    s_load_dwordx4 s[68:71], s[0:1], 48
    s_and_b32 s3, s2, 7
    s_lshr_b32 s4, s2, 3
    s_lshr_b32 s5, s3, 2
    s_bfe_u32 s6, s3, 0x10001
    s_lshl_b32 s6, s6, 2
    s_lshr_b32 s9, s4, 3
    s_add_u32 s6, s6, s9
    s_and_b32 s7, s3, 1
    s_lshl_b32 s7, s7, 3
    s_and_b32 s9, s4, 7
    s_add_u32 s7, s7, s9
    v_and_b32 v1, 63, v0
    v_lshrrev_b32 v9, 6, v0
    v_and_b32 v10, 15, v0
    v_readfirstlane_b32 s8, v9
    v_bfe_u32 v11, v0, 4, 2
    v_bfe_u32 v12, v0, 2, 2
    v_and_b32 v13, 3, v0
    v_bfe_u32 v16, v0, 3, 3
    v_and_b32 v17, 7, v0
    v_xor_b32 v17, v17, v16
    v_lshlrev_b32 v17, 4, v17
    s_lshl_b32 s9, s6, 3
    s_add_u32 s9, s9, s8
    s_mul_i32 s9, s9, 36864
    s_movk_i32 s10, 1152
    v_mad_u32_u24 v2, v16, s10, v17
    v_add_u32 v2, s9, v2
    s_lshl_b32 s9, s6, 8
    s_and_b32 s11, s8, 1
    s_lshl_b32 s11, s11, 3
    s_add_u32 s9, s9, s11
    s_sub_u32 s9, s9, 16
    v_add_u32 v4, s9, v16
    v_max_i32 v4, 0, v4
    v_mad_u32_u24 v4, v4, s10, v17
    s_lshl_b32 s59, s11, 7
    s_lshl_b32 s58, s8, 12
    s_add_u32 s58, s58, 2048
    v_mul_u32_u24 v14, 4370, v1
    v_lshrrev_b32 v14, 16, v14
    v_mul_u32_u24 v15, 15, v14
    v_sub_u32 v15, v1, v15
    s_movk_i32 s11, 3456
    v_mul_lo_u32 v5, v14, s11
    v_and_b32 v16, 1, v15
    v_lshlrev_b32 v16, 5, v16
    v_bfe_u32 v17, v15, 2, 1
    v_lshl_add_u32 v16, v17, 4, v16
    v_bfe_u32 v17, v15, 1, 1
    v_cmp_lt_u32 vcc, 7, v15
    s_nop 1
    v_cndmask_b32 v17, v17, 2, vcc
    v_mad_u32_u24 v16, v17, s10, v16
    v_cmp_eq_u32 vcc, 10, v15
    v_mov_b32 v17, 56
    s_nop 0
    v_cndmask_b32 v16, v16, v17, vcc
    v_cmp_eq_u32 vcc, 11, v15
    v_mov_b32 v17, 1216
    s_nop 0
    v_cndmask_b32 v16, v16, v17, vcc
    v_cmp_eq_u32 vcc, 14, v15
    v_mov_b32 v17, 2360
    s_nop 0
    v_cndmask_b32 v16, v16, v17, vcc
    s_mul_i32 s9, s7, 72
    v_add3_u32 v5, v5, v16, s9
    s_mul_i32 s50, s8, 27648
    s_mul_i32 s51, s8, 1920
    s_and_b32 s9, s4, 7
    s_mul_i32 s9, s9, 1
    s_lshr_b32 s10, s4, 3
    s_mul_i32 s10, s10, 2
    s_add_u32 s9, s9, s10
    s_mul_i32 s10, s9, 7282
    s_lshr_b32 s10, s10, 16
    s_mul_i32 s10, s10, 9
    s_sub_u32 s9, s9, s10
    s_mul_i32 s10, s9, 43
    s_lshr_b32 s10, s10, 7
    s_mul_i32 s9, s10, 3
    s_lshl_b32 s61, s9, 7
    s_mul_i32 s60, s9, 221184
    s_add_u32 s60, s60, s50
    s_waitcnt lgkmcnt(0)
    s_cmp_eq_u32 s5, 0
    s_cselect_b64 s[12:13], s[12:13], s[16:17]
    s_cselect_b64 s[14:15], s[14:15], s[18:19]
    s_mov_b32 s24, s12
    s_mov_b32 s25, s13
    s_mov_b32 s26, 2359296
    s_mov_b32 s27, 0x00020000
    s_mov_b32 s28, s14
    s_mov_b32 s29, s15
    s_mov_b32 s30, 1990656
    s_mov_b32 s31, 0x00020000
    s_cmp_lg_u32 s5, 0
    s_cbranch_scc1 L_B
    s_add_u32 s48, s60, 0
    s_add_u32 m0, s51, 0
    s_nop 0
    buffer_load_dwordx4 v5, s[28:31], s48 offen lds
    s_add_u32 s48, s60, 13824
    s_add_u32 m0, s51, 960
    s_nop 0
    buffer_load_dwordx4 v5, s[28:31], s48 offen lds
    s_add_u32 s48, s61, 0
    s_add_u32 m0, s58, 15424
    s_nop 0
    buffer_load_dwordx4 v2, s[24:27], s48 offen lds
    s_add_u32 s48, s61, 9216
    s_add_u32 m0, s58, 16448
    s_nop 0
    buffer_load_dwordx4 v2, s[24:27], s48 offen lds
    s_add_u32 s48, s61, 18432
    s_add_u32 m0, s58, 17472
    s_nop 0
    buffer_load_dwordx4 v2, s[24:27], s48 offen lds
    s_add_u32 s48, s61, 27648
    s_add_u32 m0, s58, 18496
    s_nop 0
    buffer_load_dwordx4 v2, s[24:27], s48 offen lds
    s_mov_b64 s[56:57], s[68:69]
    s_mov_b64 s[16:17], s[70:71]
    s_mov_b32 s44, s52
    s_mov_b32 s45, s53
    s_mov_b32 s46, 256
    s_mov_b32 s47, 0x00020000
    s_mov_b32 s36, s54
    s_mov_b32 s37, s55
    s_mov_b32 s38, 5242880
    s_mov_b32 s39, 0x00020000
    s_add_u32 s76, s54, 7340032
    s_addc_u32 s77, s55, 0
    s_mov_b32 s78, 524288
    s_mov_b32 s79, 0x00020000
    s_mov_b32 s32, s20
    s_mov_b32 s33, s21
    s_mov_b32 s34, 20736
    s_mov_b32 s35, 0x00020000
    s_add_u32 s40, s54, 5242880
    s_addc_u32 s41, s55, 0
    s_mov_b32 s42, 2097152
    s_mov_b32 s43, 0x00020000
    s_or_b32 s9, s2, s8
    s_cmp_lg_u32 s9, 0
    s_cbranch_scc1 L_nonce_done
    s_memrealtime s[10:11]
    s_waitcnt lgkmcnt(0)
    s_or_b32 s10, s10, 1
    v_mov_b32 v8, s10
    v_mov_b32 v9, s11
    v_mov_b32 v16, 64
    s_mov_b64 exec, 1
    buffer_store_dwordx2 v[8:9], v16, s[44:47], 0 offen sc0 sc1
    s_mov_b64 exec, -1
L_nonce_done:
    v_lshl_add_u32 v16, v11, 3, v12
    v_mul_u32_u24 v16, 240, v16
    v_lshrrev_b32 v17, 1, v13
    v_lshl_add_u32 v17, v17, 6, v16
    v_and_b32 v18, 1, v13
    v_lshl_add_u32 v164, v18, 3, v17
    v_lshlrev_b32 v17, 3, v13
    v_add_u32 v17, 168, v17
    v_cmp_lt_u32 vcc, 1, v13
    v_mov_b32 v18, 232
    s_nop 0
    v_cndmask_b32 v17, v17, v18, vcc
    v_add_u32 v165, v16, v17
    s_and_b32 s9, s8, 1
    s_lshl_b32 s9, s9, 4
    s_and_b32 s11, s8, 2
    s_mul_i32 s11, s11, 48
    s_add_u32 s9, s9, s11
    s_add_u32 s9, s9, 32
    v_add_u32 v166, s9, v164
    s_cmp_eq_u32 s8, 4
    s_cselect_b64 vcc, -1, 0
    v_cndmask_b32 v166, v166, v165, vcc
    v_and_b32 v16, 7, v10
    v_xor_b32 v16, v16, v11
    v_lshlrev_b32 v16, 4, v16
    v_lshl_add_u32 v16, v10, 7, v16
    v_add_u32 v169, 15424, v16
    v_xor_b32 v17, 64, v16
    v_add_u32 v170, 15424, v17
    v_add_u32 v167, s58, v169
    v_add_u32 v168, s58, v170
    v_add_u32 v172, 50240, v164
    v_add_u32 v173, 50240, v165
    v_add_u32 v174, 50240, v166
    v_add_u32 v175, 50240, v167
    v_add_u32 v176, 50240, v168
    v_add_u32 v177, 50240, v169
    v_add_u32 v178, 50240, v170
    v_add_u32 v180, 100480, v164
    v_add_u32 v181, 100480, v165
    v_add_u32 v182, 100480, v166
    v_add_u32 v183, 100480, v167
    v_add_u32 v184, 100480, v168
    v_add_u32 v185, 100480, v169
    v_add_u32 v186, 100480, v170
    s_add_u32 s61, s61, 128
    s_add_u32 s60, s60, 221184
    s_cmp_eq_u32 s61, 1152
    s_cselect_b32 s61, 0, s61
    s_cselect_b32 s60, s50, s60
    s_add_u32 s48, s60, 0
    s_add_u32 m0, s51, 50240
    s_nop 0
    buffer_load_dwordx4 v5, s[28:31], s48 offen lds
    s_add_u32 s48, s60, 13824
    s_add_u32 m0, s51, 51200
    s_nop 0
    buffer_load_dwordx4 v5, s[28:31], s48 offen lds
    s_add_u32 s48, s61, 0
    s_add_u32 m0, s58, 65664
    s_nop 0
    buffer_load_dwordx4 v2, s[24:27], s48 offen lds
    s_add_u32 s48, s61, 9216
    s_add_u32 m0, s58, 66688
    s_nop 0
    buffer_load_dwordx4 v2, s[24:27], s48 offen lds
    s_add_u32 s48, s61, 18432
    s_add_u32 m0, s58, 67712
    s_nop 0
    buffer_load_dwordx4 v2, s[24:27], s48 offen lds
    s_add_u32 s48, s61, 27648
    s_add_u32 m0, s58, 68736
    s_nop 0
    buffer_load_dwordx4 v2, s[24:27], s48 offen lds
    s_lshl_b32 s9, s4, 3
    s_add_u32 s9, s9, s8
    s_bfe_u32 s10, s3, 0x10001
    s_lshl_b32 s10, s10, 8
    s_add_u32 s10, s10, s9
    s_mul_i32 s10, s10, 4608
    v_mov_b32 v19, 0x80000000
    v_mul_u32_u24 v16, 1152, v1
    v_cmp_lt_u32 vcc, 3, v1
    v_add_u32 v16, s10, v16
    s_mul_i32 s10, s9, 9
    v_cndmask_b32 v226, v16, v19, vcc
    s_lshr_b32 s10, s10, 1
    v_add_u32 v16, s10, v1
    v_mul_u32_u24 v17, 3641, v16
    v_lshrrev_b32 v17, 16, v17
    v_mul_u32_u24 v18, 18, v17
    v_sub_u32 v18, v16, v18
    v_mul_u32_u24 v16, 11, v18
    v_lshrrev_b32 v16, 6, v16
    v_mul_u32_u24 v20, 6, v16
    v_sub_u32 v18, v18, v20
    v_lshlrev_b32 v18, 7, v18
    v_min_u32 v18, 572, v18
    v_mul_u32_u24 v16, 1152, v16
    v_mul_u32_u24 v17, 3456, v17
    v_add3_u32 v18, v18, v16, v17
    s_and_b32 s10, s3, 1
    s_mul_i32 s10, s10, 576
    v_cmp_lt_u32 vcc, 4, v1
    v_add_u32 v18, s10, v18
    s_mul_i32 s10, s9, 21
    v_cndmask_b32 v227, v18, v19, vcc
    v_add_u32 v16, s10, v1
    v_cmp_lt_u32 vcc, 20, v1
    v_lshlrev_b32 v16, 7, v16
    s_cmp_eq_u32 s5, 0
    s_cselect_b64 s[72:73], s[22:23], s[56:57]
    v_cndmask_b32 v228, v16, v19, vcc
    s_mov_b32 s74, 663552
    s_mov_b32 s75, 0x00020000
    v_and_b32 v16, 0x3ff, v0
    v_mul_u32_u24 v17, 7282, v16
    v_lshrrev_b32 v17, 16, v17
    v_mul_u32_u24 v18, 9, v17
    v_sub_u32 v18, v16, v18
    v_mul_u32_u24 v17, 40, v17
    v_lshl_add_u32 v17, v18, 2, v17
    v_add_u32 v14, 150720, v17
    v_lshlrev_b32 v18, 2, v16
    v_add_u32 v17, 152304, v18
    v_cmp_lt_u32 vcc, 323, v16
    v_min_u32 v17, 153848, v17
    v_add_u32 v3, 1440, v14
    v_cndmask_b32 v14, v14, v17, vcc
    v_mov_b32 v17, 153852
    v_cndmask_b32 v3, v3, v17, vcc
    s_mul_i32 s9, s7, 1296
    v_add_u32 v18, s9, v18
    v_mov_b32 v17, 0x80000000
    v_cndmask_b32 v18, v18, v17, vcc
    buffer_load_dword v15, v18, s[32:35], 0 offen
    s_waitcnt vmcnt(7)
    s_barrier
    ds_read_b128 v[140:143], v167 offset:0
    ds_read_b128 v[144:147], v167 offset:2048
    ds_read_b64_tr_b16 v[76:77], v164 offset:0
    ds_read_b64_tr_b16 v[78:79], v164 offset:960
    ds_read_b64_tr_b16 v[80:81], v164 offset:16
    ds_read_b64_tr_b16 v[82:83], v164 offset:976
    ds_read_b64_tr_b16 v[84:85], v164 offset:32
    ds_read_b64_tr_b16 v[86:87], v164 offset:992
    ds_read_b64_tr_b16 v[88:89], v164 offset:48
    ds_read_b64_tr_b16 v[90:91], v164 offset:1008
    s_waitcnt lgkmcnt(6)
    v_mfma_f32_16x16x32_bf16 v[16:19], v[76:79], v[140:143], 0
    ds_read_b64_tr_b16 v[92:93], v164 offset:128
    s_add_u32 s61, s61, 128
    s_add_u32 s60, s60, 221184
    s_cmp_eq_u32 s61, 1152
    s_cselect_b32 s61, 0, s61
    s_cselect_b32 s60, s50, s60
    s_add_u32 s48, s60, 0
    s_add_u32 m0, s51, 100480
    s_nop 0
    buffer_load_dwordx4 v5, s[28:31], s48 offen lds
    v_mfma_f32_16x16x32_bf16 v[44:47], v[76:79], v[144:147], 0
    ds_read_b64_tr_b16 v[94:95], v164 offset:1088
    v_lshl_add_u32 v210, v11, 2, v12
    v_add_u32 v211, 16, v210
    v_lshrrev_b32 v212, 1, v13
    v_mul_u32_u24 v212, 1440, v212
    s_waitcnt lgkmcnt(6)
    v_mfma_f32_16x16x32_bf16 v[20:23], v[80:83], v[140:143], 0
    ds_read_b64_tr_b16 v[96:97], v164 offset:144
    v_mfma_f32_16x16x32_bf16 v[48:51], v[80:83], v[144:147], 0
    ds_read_b64_tr_b16 v[98:99], v164 offset:1104
    v_add_u32 v212, 150720, v212
    v_and_b32 v213, 1, v13
    v_mov_b32 v214, 153600
    v_mad_u32_u24 v215, v210, 40, v212
    s_waitcnt lgkmcnt(6)
    v_mfma_f32_16x16x32_bf16 v[24:27], v[84:87], v[140:143], 0
    ds_read_b64_tr_b16 v[100:101], v165 offset:0
    v_mfma_f32_16x16x32_bf16 v[52:55], v[84:87], v[144:147], 0
    ds_read_b64_tr_b16 v[102:103], v165 offset:960
    s_add_u32 s48, s60, 13824
    s_add_u32 m0, s51, 101440
    s_nop 0
    buffer_load_dwordx4 v5, s[28:31], s48 offen lds
    v_cmp_eq_u32 vcc, 0, v213
    v_mad_u32_u24 v216, v211, 40, v212
    v_cmp_lt_u32 s[62:63], 17, v211
    v_cndmask_b32 v187, v214, v215, vcc
    s_waitcnt lgkmcnt(6)
    v_mfma_f32_16x16x32_bf16 v[28:31], v[88:91], v[140:143], 0
    ds_read_b128 v[148:151], v168 offset:0
    v_mfma_f32_16x16x32_bf16 v[56:59], v[88:91], v[144:147], 0
    ds_read_b128 v[152:155], v168 offset:2048
    s_nop 0
    v_cndmask_b32 v217, 0, 1, s[62:63]
    v_cmp_eq_u32 vcc, v217, v213
    v_add_u32 v218, 32, v12
    s_waitcnt lgkmcnt(6)
    v_mfma_f32_16x16x32_bf16 v[32:35], v[92:95], v[140:143], 0
    ds_read_b64_tr_b16 v[104:105], v164 offset:7680
    v_mfma_f32_16x16x32_bf16 v[60:63], v[92:95], v[144:147], 0
    ds_read_b64_tr_b16 v[106:107], v164 offset:8640
    s_add_u32 s48, s61, 0
    s_add_u32 m0, s58, 115904
    s_nop 0
    buffer_load_dwordx4 v2, s[24:27], s48 offen lds
    v_mad_u32_u24 v218, v218, 40, v212
    v_cndmask_b32 v188, v214, v216, vcc
    v_lshl_add_u32 v219, v11, 1, v213
    v_cmp_eq_u32 vcc, 1, v219
    s_waitcnt lgkmcnt(6)
    v_mfma_f32_16x16x32_bf16 v[36:39], v[96:99], v[140:143], 0
    ds_read_b64_tr_b16 v[108:109], v164 offset:7696
    v_mfma_f32_16x16x32_bf16 v[64:67], v[96:99], v[144:147], 0
    ds_read_b64_tr_b16 v[110:111], v164 offset:8656
    v_cmp_eq_u32 s[62:63], 3, v219
    s_nop 0
    v_cndmask_b32 v189, v214, v218, vcc
    v_cndmask_b32 v190, v214, v218, s[62:63]
    s_waitcnt lgkmcnt(6)
    v_mfma_f32_16x16x32_bf16 v[40:43], v[100:103], v[140:143], 0
    ds_read_b64_tr_b16 v[112:113], v164 offset:7712
    v_mfma_f32_16x16x32_bf16 v[68:71], v[100:103], v[144:147], 0
    ds_read_b64_tr_b16 v[114:115], v164 offset:8672
    s_add_u32 s48, s61, 9216
    s_add_u32 m0, s58, 116928
    s_nop 0
    buffer_load_dwordx4 v2, s[24:27], s48 offen lds
    v_and_b32 v210, 1, v11
    v_lshrrev_b32 v211, 1, v11
    v_mul_u32_u24 v215, 40, v210
    v_add_u32 v215, v215, v12
    s_waitcnt lgkmcnt(4)
    v_mfma_f32_16x16x32_bf16 v[16:19], v[104:107], v[148:151], v[16:19]
    ds_read_b64_tr_b16 v[116:117], v164 offset:7728
    v_mfma_f32_16x16x32_bf16 v[44:47], v[104:107], v[152:155], v[44:47]
    ds_read_b64_tr_b16 v[118:119], v164 offset:8688
    v_lshl_add_u32 v216, v211, 4, v215
    v_lshl_add_u32 v217, v211, 2, v215
    v_add_u32 v217, 32, v217
    v_lshrrev_b32 v218, 1, v13
    s_waitcnt lgkmcnt(4)
    v_mfma_f32_16x16x32_bf16 v[20:23], v[108:111], v[148:151], v[20:23]
    ds_read_b64_tr_b16 v[120:121], v164 offset:7808
    v_mfma_f32_16x16x32_bf16 v[48:51], v[108:111], v[152:155], v[48:51]
    ds_read_b64_tr_b16 v[122:123], v164 offset:8768
    s_add_u32 s48, s61, 18432
    s_add_u32 m0, s58, 117952
    s_nop 0
    buffer_load_dwordx4 v2, s[24:27], s48 offen lds
    v_mul_u32_u24 v218, 24, v218
    v_cmp_eq_u32 vcc, v210, v213
    v_mad_u32_u24 v216, v216, 48, v218
    v_mad_u32_u24 v217, v217, 48, v218
    s_waitcnt lgkmcnt(4)
    v_mfma_f32_16x16x32_bf16 v[24:27], v[112:115], v[148:151], v[24:27]
    ds_read_b64_tr_b16 v[124:125], v164 offset:7824
    v_mfma_f32_16x16x32_bf16 v[52:55], v[112:115], v[152:155], v[52:55]
    ds_read_b64_tr_b16 v[126:127], v164 offset:8784
    v_mov_b32 v214, 3840
    v_cndmask_b32 v206, v214, v216, vcc
    v_cndmask_b32 v207, v214, v217, vcc
    s_lshl_b32 s9, s8, 5
    s_waitcnt lgkmcnt(4)
    v_mfma_f32_16x16x32_bf16 v[28:31], v[116:119], v[148:151], v[28:31]
    ds_read_b64_tr_b16 v[128:129], v165 offset:7680
    v_mfma_f32_16x16x32_bf16 v[56:59], v[116:119], v[152:155], v[56:59]
    ds_read_b64_tr_b16 v[130:131], v165 offset:8640
    s_add_u32 s48, s61, 27648
    s_add_u32 m0, s58, 118976
    s_nop 0
    buffer_load_dwordx4 v2, s[24:27], s48 offen lds
    v_add_u32 v212, s9, v10
    v_mul_u32_u24 v215, 240, v212
    v_lshl_add_u32 v191, v11, 3, v215
    v_mul_u32_u24 v216, 80, v210
    s_waitcnt lgkmcnt(4)
    v_mfma_f32_16x16x32_bf16 v[32:35], v[120:123], v[148:151], v[32:35]
    v_mfma_f32_16x16x32_bf16 v[60:63], v[120:123], v[152:155], v[60:63]
    v_add_u32 v216, v216, v215
    v_lshl_add_u32 v192, v211, 5, v216
    v_lshl_add_u32 v193, v211, 3, v216
    v_mul_u32_u24 v215, 80, v212
    s_waitcnt lgkmcnt(2)
    v_mfma_f32_16x16x32_bf16 v[36:39], v[124:127], v[148:151], v[36:39]
    v_mfma_f32_16x16x32_bf16 v[64:67], v[124:127], v[152:155], v[64:67]
    v_mul_u32_u24 v216, 36, v210
    v_mul_u32_u24 v217, 20, v211
    v_add3_u32 v215, v215, v216, v217
    v_add_u32 v208, 61440, v215
    s_waitcnt lgkmcnt(0)
    v_mfma_f32_16x16x32_bf16 v[40:43], v[128:131], v[148:151], v[40:43]
    v_mfma_f32_16x16x32_bf16 v[68:71], v[128:131], v[152:155], v[68:71]
    s_mul_i32 s9, s7, 131072
    s_lshl_b32 s10, s8, 11
    s_add_u32 s9, s9, s10
    v_lshlrev_b32 v215, 4, v1
    s_waitcnt vmcnt(7)
    s_barrier
    ds_read_b128 v[140:143], v175 offset:0
    ds_read_b128 v[144:147], v175 offset:2048
    ds_read_b64_tr_b16 v[76:77], v172 offset:0
    ds_read_b64_tr_b16 v[78:79], v172 offset:960
    ds_read_b64_tr_b16 v[80:81], v172 offset:16
    ds_read_b64_tr_b16 v[82:83], v172 offset:976
    ds_read_b64_tr_b16 v[84:85], v172 offset:32
    ds_read_b64_tr_b16 v[86:87], v172 offset:992
    ds_read_b64_tr_b16 v[88:89], v172 offset:48
    ds_read_b64_tr_b16 v[90:91], v172 offset:1008
    s_waitcnt lgkmcnt(6)
    v_mfma_f32_16x16x32_bf16 v[16:19], v[76:79], v[140:143], v[16:19]
    ds_read_b64_tr_b16 v[92:93], v172 offset:128
    s_add_u32 s61, s61, 128
    s_add_u32 s60, s60, 221184
    s_cmp_eq_u32 s61, 1152
    s_cselect_b32 s61, 0, s61
    s_cselect_b32 s60, s50, s60
    s_add_u32 s48, s60, 0
    s_add_u32 m0, s51, 0
    s_nop 0
    buffer_load_dwordx4 v5, s[28:31], s48 offen lds
    v_mfma_f32_16x16x32_bf16 v[44:47], v[76:79], v[144:147], v[44:47]
    ds_read_b64_tr_b16 v[94:95], v172 offset:1088
    v_add_u32 v209, s9, v215
    s_sub_u32 s9, s8, 5
    s_cmp_lt_u32 s8, 5
    s_cselect_b32 s62, 1, 0
    s_cmp_lt_u32 s8, 5
    s_cselect_b32 s63, 2, 0
    s_waitcnt lgkmcnt(6)
    v_mfma_f32_16x16x32_bf16 v[20:23], v[80:83], v[140:143], v[20:23]
    ds_read_b64_tr_b16 v[96:97], v172 offset:144
    v_mfma_f32_16x16x32_bf16 v[48:51], v[80:83], v[144:147], v[48:51]
    ds_read_b64_tr_b16 v[98:99], v172 offset:1104
    s_cmp_lt_u32 s8, 5
    s_cselect_b32 s64, s8, s9
    v_and_b32 v210, 1, v11
    v_lshl_add_u32 v210, v210, 3, v12
    v_lshrrev_b32 v211, 1, v11
    s_waitcnt lgkmcnt(6)
    v_mfma_f32_16x16x32_bf16 v[24:27], v[84:87], v[140:143], v[24:27]
    ds_read_b64_tr_b16 v[100:101], v173 offset:0
    v_mfma_f32_16x16x32_bf16 v[52:55], v[84:87], v[144:147], v[52:55]
    ds_read_b64_tr_b16 v[102:103], v173 offset:960
    s_add_u32 s48, s60, 13824
    s_add_u32 m0, s51, 960
    s_nop 0
    buffer_load_dwordx4 v5, s[28:31], s48 offen lds
    v_lshl_add_u32 v210, v211, 5, v210
    v_mul_u32_u24 v210, 240, v210
    v_lshl_add_u32 v210, v13, 3, v210
    s_lshl_b32 s9, s62, 5
    s_waitcnt lgkmcnt(6)
    v_mfma_f32_16x16x32_bf16 v[28:31], v[88:91], v[140:143], v[28:31]
    ds_read_b128 v[148:151], v176 offset:0
    v_mfma_f32_16x16x32_bf16 v[56:59], v[88:91], v[144:147], v[56:59]
    ds_read_b128 v[152:155], v176 offset:2048
    s_add_u32 s9, s9, 160
    v_add_u32 v194, s9, v210
    s_lshl_b32 s9, s63, 5
    s_add_u32 s9, s9, 160
    s_waitcnt lgkmcnt(6)
    v_mfma_f32_16x16x32_bf16 v[32:35], v[92:95], v[140:143], v[32:35]
    ds_read_b64_tr_b16 v[104:105], v172 offset:7680
    v_mfma_f32_16x16x32_bf16 v[60:63], v[92:95], v[144:147], v[60:63]
    ds_read_b64_tr_b16 v[106:107], v172 offset:8640
    s_add_u32 s48, s61, 0
    s_add_u32 m0, s58, 15424
    s_nop 0
    buffer_load_dwordx4 v2, s[24:27], s48 offen lds
    v_add_u32 v195, s9, v210
    s_lshl_b32 s9, s64, 5
    v_add_u32 v196, s9, v210
    s_lshl_b32 s9, s64, 4
    s_waitcnt lgkmcnt(6)
    v_mfma_f32_16x16x32_bf16 v[36:39], v[96:99], v[140:143], v[36:39]
    ds_read_b64_tr_b16 v[108:109], v172 offset:7696
    v_mfma_f32_16x16x32_bf16 v[64:67], v[96:99], v[144:147], v[64:67]
    ds_read_b64_tr_b16 v[110:111], v172 offset:8656
    v_add_u32 v210, s9, v10
    v_cmp_lt_u32 vcc, 39, v210
    v_mul_u32_u24 v211, 48, v210
    v_mov_b32 v213, 4476
    s_waitcnt lgkmcnt(6)
    v_mfma_f32_16x16x32_bf16 v[40:43], v[100:103], v[140:143], v[40:43]
    ds_read_b64_tr_b16 v[112:113], v172 offset:7712
    v_mfma_f32_16x16x32_bf16 v[68:71], v[100:103], v[144:147], v[68:71]
    ds_read_b64_tr_b16 v[114:115], v172 offset:8672
    s_add_u32 s48, s61, 9216
    s_add_u32 m0, s58, 16448
    s_nop 0
    buffer_load_dwordx4 v2, s[24:27], s48 offen lds
    v_cndmask_b32 v212, 0, 18, vcc
    s_lshl_b32 s9, s62, 4
    s_add_u32 s9, s9, 0
    v_lshl_add_u32 v214, v11, 2, s9
    s_waitcnt lgkmcnt(4)
    v_mfma_f32_16x16x32_bf16 v[16:19], v[104:107], v[148:151], v[16:19]
    ds_read_b64_tr_b16 v[116:117], v172 offset:7728
    v_mfma_f32_16x16x32_bf16 v[44:47], v[104:107], v[152:155], v[44:47]
    ds_read_b64_tr_b16 v[118:119], v172 offset:8688
    v_sub_u32 v215, v214, v212
    v_cmp_gt_u32 s[70:71], 18, v215
    v_cmp_lt_u32 vcc, 9, v215
    v_lshlrev_b32 v216, 1, v215
    s_waitcnt lgkmcnt(4)
    v_mfma_f32_16x16x32_bf16 v[20:23], v[108:111], v[148:151], v[20:23]
    ds_read_b64_tr_b16 v[120:121], v172 offset:7808
    v_mfma_f32_16x16x32_bf16 v[48:51], v[108:111], v[152:155], v[48:51]
    ds_read_b64_tr_b16 v[122:123], v172 offset:8768
    s_add_u32 s48, s61, 18432
    s_add_u32 m0, s58, 17472
    s_nop 0
    buffer_load_dwordx4 v2, s[24:27], s48 offen lds
    v_add_u32 v217, 4, v216
    v_cndmask_b32 v216, v216, v217, vcc
    v_cmp_eq_u32 vcc, 36, v214
    v_mov_b32 v217, 20
    s_waitcnt lgkmcnt(4)
    v_mfma_f32_16x16x32_bf16 v[24:27], v[112:115], v[148:151], v[24:27]
    ds_read_b64_tr_b16 v[124:125], v172 offset:7824
    v_mfma_f32_16x16x32_bf16 v[52:55], v[112:115], v[152:155], v[52:55]
    ds_read_b64_tr_b16 v[126:127], v172 offset:8784
    s_or_b64 s[70:71], s[70:71], vcc
    v_cndmask_b32 v216, v216, v217, vcc
    v_add_u32 v216, v216, v211
    v_cndmask_b32 v197, v213, v216, s[70:71]
    s_waitcnt lgkmcnt(4)
    v_mfma_f32_16x16x32_bf16 v[28:31], v[116:119], v[148:151], v[28:31]
    ds_read_b64_tr_b16 v[128:129], v173 offset:7680
    v_mfma_f32_16x16x32_bf16 v[56:59], v[116:119], v[152:155], v[56:59]
    ds_read_b64_tr_b16 v[130:131], v173 offset:8640
    s_add_u32 s48, s61, 27648
    s_add_u32 m0, s58, 18496
    s_nop 0
    buffer_load_dwordx4 v2, s[24:27], s48 offen lds
    s_mov_b64 s[18:19], s[70:71]
    s_lshl_b32 s9, s62, 4
    s_add_u32 s9, s9, 1
    v_lshl_add_u32 v214, v11, 2, s9
    s_waitcnt lgkmcnt(4)
    v_mfma_f32_16x16x32_bf16 v[32:35], v[120:123], v[148:151], v[32:35]
    v_mfma_f32_16x16x32_bf16 v[60:63], v[120:123], v[152:155], v[60:63]
    v_sub_u32 v215, v214, v212
    v_cmp_gt_u32 s[70:71], 18, v215
    v_cmp_lt_u32 vcc, 9, v215
    v_lshlrev_b32 v216, 1, v215
    s_waitcnt lgkmcnt(2)
    v_mfma_f32_16x16x32_bf16 v[36:39], v[124:127], v[148:151], v[36:39]
    v_mfma_f32_16x16x32_bf16 v[64:67], v[124:127], v[152:155], v[64:67]
    v_add_u32 v217, 4, v216
    v_cndmask_b32 v216, v216, v217, vcc
    v_cmp_eq_u32 vcc, 36, v214
    v_mov_b32 v217, 20
    s_waitcnt lgkmcnt(0)
    v_mfma_f32_16x16x32_bf16 v[40:43], v[128:131], v[148:151], v[40:43]
    v_mfma_f32_16x16x32_bf16 v[68:71], v[128:131], v[152:155], v[68:71]
    s_or_b64 s[70:71], s[70:71], vcc
    v_cndmask_b32 v216, v216, v217, vcc
    v_add_u32 v216, v216, v211
    v_cndmask_b32 v198, v213, v216, s[70:71]
    s_waitcnt vmcnt(6)
    s_barrier
    ds_read_b128 v[140:143], v183 offset:0
    ds_read_b128 v[144:147], v183 offset:2048
    ds_read_b64_tr_b16 v[76:77], v180 offset:0
    ds_read_b64_tr_b16 v[78:79], v180 offset:960
    ds_read_b64_tr_b16 v[80:81], v180 offset:16
    ds_read_b64_tr_b16 v[82:83], v180 offset:976
    ds_read_b64_tr_b16 v[84:85], v180 offset:32
    ds_read_b64_tr_b16 v[86:87], v180 offset:992
    ds_read_b64_tr_b16 v[88:89], v180 offset:48
    ds_read_b64_tr_b16 v[90:91], v180 offset:1008
    ds_write_b32 v14, v15
    v_xor_b32 v15, 0x80008000, v15
    ds_write_b32 v3, v15
    s_waitcnt lgkmcnt(8)
    v_mfma_f32_16x16x32_bf16 v[16:19], v[76:79], v[140:143], v[16:19]
    ds_read_b64_tr_b16 v[92:93], v180 offset:128
    s_add_u32 s61, s61, 128
    s_add_u32 s60, s60, 221184
    s_cmp_eq_u32 s61, 1152
    s_cselect_b32 s61, 0, s61
    s_cselect_b32 s60, s50, s60
    s_add_u32 s48, s60, 0
    s_add_u32 m0, s51, 50240
    s_nop 0
    buffer_load_dwordx4 v5, s[28:31], s48 offen lds
    v_mfma_f32_16x16x32_bf16 v[44:47], v[76:79], v[144:147], v[44:47]
    ds_read_b64_tr_b16 v[94:95], v180 offset:1088
    s_or_b64 s[18:19], s[18:19], s[70:71]
    s_lshl_b32 s9, s62, 4
    s_add_u32 s9, s9, 2
    v_lshl_add_u32 v214, v11, 2, s9
    s_waitcnt lgkmcnt(8)
    v_mfma_f32_16x16x32_bf16 v[20:23], v[80:83], v[140:143], v[20:23]
    ds_read_b64_tr_b16 v[96:97], v180 offset:144
    v_mfma_f32_16x16x32_bf16 v[48:51], v[80:83], v[144:147], v[48:51]
    ds_read_b64_tr_b16 v[98:99], v180 offset:1104
    v_sub_u32 v215, v214, v212
    v_cmp_gt_u32 s[70:71], 18, v215
    v_cmp_lt_u32 vcc, 9, v215
    v_lshlrev_b32 v216, 1, v215
    s_waitcnt lgkmcnt(8)
    v_mfma_f32_16x16x32_bf16 v[24:27], v[84:87], v[140:143], v[24:27]
    ds_read_b64_tr_b16 v[100:101], v181 offset:0
    v_mfma_f32_16x16x32_bf16 v[52:55], v[84:87], v[144:147], v[52:55]
    ds_read_b64_tr_b16 v[102:103], v181 offset:960
    s_add_u32 s48, s60, 13824
    s_add_u32 m0, s51, 51200
    s_nop 0
    buffer_load_dwordx4 v5, s[28:31], s48 offen lds
    v_add_u32 v217, 4, v216
    v_cndmask_b32 v216, v216, v217, vcc
    v_cmp_eq_u32 vcc, 36, v214
    v_mov_b32 v217, 20
    s_waitcnt lgkmcnt(8)
    v_mfma_f32_16x16x32_bf16 v[28:31], v[88:91], v[140:143], v[28:31]
    ds_read_b128 v[148:151], v184 offset:0
    v_mfma_f32_16x16x32_bf16 v[56:59], v[88:91], v[144:147], v[56:59]
    ds_read_b128 v[152:155], v184 offset:2048
    s_or_b64 s[70:71], s[70:71], vcc
    v_cndmask_b32 v216, v216, v217, vcc
    v_add_u32 v216, v216, v211
    v_cndmask_b32 v199, v213, v216, s[70:71]
    s_waitcnt lgkmcnt(6)
    v_mfma_f32_16x16x32_bf16 v[32:35], v[92:95], v[140:143], v[32:35]
    ds_read_b64_tr_b16 v[104:105], v180 offset:7680
    v_mfma_f32_16x16x32_bf16 v[60:63], v[92:95], v[144:147], v[60:63]
    ds_read_b64_tr_b16 v[106:107], v180 offset:8640
    s_add_u32 s48, s61, 0
    s_add_u32 m0, s58, 65664
    s_nop 0
    buffer_load_dwordx4 v2, s[24:27], s48 offen lds
    s_or_b64 s[18:19], s[18:19], s[70:71]
    s_lshl_b32 s9, s62, 4
    s_add_u32 s9, s9, 3
    v_lshl_add_u32 v214, v11, 2, s9
    s_waitcnt lgkmcnt(6)
    v_mfma_f32_16x16x32_bf16 v[36:39], v[96:99], v[140:143], v[36:39]
    ds_read_b64_tr_b16 v[108:109], v180 offset:7696
    v_mfma_f32_16x16x32_bf16 v[64:67], v[96:99], v[144:147], v[64:67]
    ds_read_b64_tr_b16 v[110:111], v180 offset:8656
    v_sub_u32 v215, v214, v212
    v_cmp_gt_u32 s[70:71], 18, v215
    v_cmp_lt_u32 vcc, 9, v215
    v_lshlrev_b32 v216, 1, v215
    s_waitcnt lgkmcnt(6)
    v_mfma_f32_16x16x32_bf16 v[40:43], v[100:103], v[140:143], v[40:43]
    ds_read_b64_tr_b16 v[112:113], v180 offset:7712
    v_mfma_f32_16x16x32_bf16 v[68:71], v[100:103], v[144:147], v[68:71]
    ds_read_b64_tr_b16 v[114:115], v180 offset:8672
    s_add_u32 s48, s61, 9216
    s_add_u32 m0, s58, 66688
    s_nop 0
    buffer_load_dwordx4 v2, s[24:27], s48 offen lds
    v_add_u32 v217, 4, v216
    v_cndmask_b32 v216, v216, v217, vcc
    v_cmp_eq_u32 vcc, 36, v214
    v_mov_b32 v217, 20
    s_waitcnt lgkmcnt(4)
    v_mfma_f32_16x16x32_bf16 v[16:19], v[104:107], v[148:151], v[16:19]
    ds_read_b64_tr_b16 v[116:117], v180 offset:7728
    v_mfma_f32_16x16x32_bf16 v[44:47], v[104:107], v[152:155], v[44:47]
    ds_read_b64_tr_b16 v[118:119], v180 offset:8688
    s_or_b64 s[70:71], s[70:71], vcc
    v_cndmask_b32 v216, v216, v217, vcc
    v_add_u32 v216, v216, v211
    v_cndmask_b32 v200, v213, v216, s[70:71]
    s_waitcnt lgkmcnt(4)
    v_mfma_f32_16x16x32_bf16 v[20:23], v[108:111], v[148:151], v[20:23]
    ds_read_b64_tr_b16 v[120:121], v180 offset:7808
    v_mfma_f32_16x16x32_bf16 v[48:51], v[108:111], v[152:155], v[48:51]
    ds_read_b64_tr_b16 v[122:123], v180 offset:8768
    s_add_u32 s48, s61, 18432
    s_add_u32 m0, s58, 67712
    s_nop 0
    buffer_load_dwordx4 v2, s[24:27], s48 offen lds
    s_or_b64 s[18:19], s[18:19], s[70:71]
    v_mov_b32 v218, 0x80000000
    v_cndmask_b32 v230, v218, v209, s[18:19]
    s_lshl_b32 s9, s63, 4
    s_waitcnt lgkmcnt(4)
    v_mfma_f32_16x16x32_bf16 v[24:27], v[112:115], v[148:151], v[24:27]
    ds_read_b64_tr_b16 v[124:125], v180 offset:7824
    v_mfma_f32_16x16x32_bf16 v[52:55], v[112:115], v[152:155], v[52:55]
    ds_read_b64_tr_b16 v[126:127], v180 offset:8784
    s_add_u32 s9, s9, 0
    v_lshl_add_u32 v214, v11, 2, s9
    v_sub_u32 v215, v214, v212
    v_cmp_gt_u32 s[70:71], 18, v215
    s_waitcnt lgkmcnt(4)
    v_mfma_f32_16x16x32_bf16 v[28:31], v[116:119], v[148:151], v[28:31]
    ds_read_b64_tr_b16 v[128:129], v181 offset:7680
    v_mfma_f32_16x16x32_bf16 v[56:59], v[116:119], v[152:155], v[56:59]
    ds_read_b64_tr_b16 v[130:131], v181 offset:8640
    s_add_u32 s48, s61, 27648
    s_add_u32 m0, s58, 68736
    s_nop 0
    buffer_load_dwordx4 v2, s[24:27], s48 offen lds
    v_cmp_lt_u32 vcc, 9, v215
    v_lshlrev_b32 v216, 1, v215
    v_add_u32 v217, 4, v216
    v_cndmask_b32 v216, v216, v217, vcc
    s_waitcnt lgkmcnt(4)
    v_mfma_f32_16x16x32_bf16 v[32:35], v[120:123], v[148:151], v[32:35]
    v_mfma_f32_16x16x32_bf16 v[60:63], v[120:123], v[152:155], v[60:63]
    v_cmp_eq_u32 vcc, 36, v214
    v_mov_b32 v217, 20
    s_or_b64 s[70:71], s[70:71], vcc
    v_cndmask_b32 v216, v216, v217, vcc
    s_waitcnt lgkmcnt(2)
    v_mfma_f32_16x16x32_bf16 v[36:39], v[124:127], v[148:151], v[36:39]
    v_mfma_f32_16x16x32_bf16 v[64:67], v[124:127], v[152:155], v[64:67]
    s_cmp_lt_u32 s8, 5
    s_cselect_b64 s[70:71], s[70:71], 0
    v_add_u32 v216, v216, v211
    v_cndmask_b32 v201, v213, v216, s[70:71]
    s_mov_b64 s[18:19], s[70:71]
    s_waitcnt lgkmcnt(0)
    v_mfma_f32_16x16x32_bf16 v[40:43], v[128:131], v[148:151], v[40:43]
    v_mfma_f32_16x16x32_bf16 v[68:71], v[128:131], v[152:155], v[68:71]
    s_and_b64 s[70:71], s[70:71], vcc
    v_add_u32 v216, 24, v216
    v_cndmask_b32 v205, v213, v216, s[70:71]
    s_lshl_b32 s9, s63, 4
    s_waitcnt vmcnt(6)
    s_barrier
    ds_read_b128 v[140:143], v167 offset:0
    ds_read_b128 v[144:147], v167 offset:2048
    ds_read_b64_tr_b16 v[76:77], v164 offset:0
    ds_read_b64_tr_b16 v[78:79], v164 offset:960
    ds_read_b64_tr_b16 v[80:81], v164 offset:16
    ds_read_b64_tr_b16 v[82:83], v164 offset:976
    ds_read_b64_tr_b16 v[84:85], v164 offset:32
    ds_read_b64_tr_b16 v[86:87], v164 offset:992
    ds_read_b64_tr_b16 v[88:89], v164 offset:48
    ds_read_b64_tr_b16 v[90:91], v164 offset:1008
    s_waitcnt lgkmcnt(6)
    v_mfma_f32_16x16x32_bf16 v[16:19], v[76:79], v[140:143], v[16:19]
    ds_read_b64_tr_b16 v[92:93], v164 offset:128
    s_add_u32 s61, s61, 128
    s_add_u32 s60, s60, 221184
    s_cmp_eq_u32 s61, 1152
    s_cselect_b32 s61, 0, s61
    s_cselect_b32 s60, s50, s60
    s_add_u32 s48, s60, 0
    s_add_u32 m0, s51, 100480
    s_nop 0
    buffer_load_dwordx4 v5, s[28:31], s48 offen lds
    v_mfma_f32_16x16x32_bf16 v[44:47], v[76:79], v[144:147], v[44:47]
    ds_read_b64_tr_b16 v[94:95], v164 offset:1088
    s_add_u32 s9, s9, 1
    v_lshl_add_u32 v214, v11, 2, s9
    v_sub_u32 v215, v214, v212
    v_cmp_gt_u32 s[70:71], 18, v215
    s_waitcnt lgkmcnt(6)
    v_mfma_f32_16x16x32_bf16 v[20:23], v[80:83], v[140:143], v[20:23]
    ds_read_b64_tr_b16 v[96:97], v164 offset:144
    v_mfma_f32_16x16x32_bf16 v[48:51], v[80:83], v[144:147], v[48:51]
    ds_read_b64_tr_b16 v[98:99], v164 offset:1104
    v_cmp_lt_u32 vcc, 9, v215
    v_lshlrev_b32 v216, 1, v215
    v_add_u32 v217, 4, v216
    v_cndmask_b32 v216, v216, v217, vcc
    s_waitcnt lgkmcnt(6)
    v_mfma_f32_16x16x32_bf16 v[24:27], v[84:87], v[140:143], v[24:27]
    ds_read_b64_tr_b16 v[100:101], v165 offset:0
    s_add_u32 s48, s60, 13824
    s_add_u32 m0, s51, 101440
    s_nop 0
    buffer_load_dwordx4 v5, s[28:31], s48 offen lds
    v_mfma_f32_16x16x32_bf16 v[52:55], v[84:87], v[144:147], v[52:55]
    ds_read_b64_tr_b16 v[102:103], v165 offset:960
    v_cmp_eq_u32 vcc, 36, v214
    v_mov_b32 v217, 20
    s_or_b64 s[70:71], s[70:71], vcc
    v_cndmask_b32 v216, v216, v217, vcc
    s_waitcnt lgkmcnt(6)
    v_mfma_f32_16x16x32_bf16 v[28:31], v[88:91], v[140:143], v[28:31]
    ds_read_b128 v[148:151], v168 offset:0
    v_mfma_f32_16x16x32_bf16 v[56:59], v[88:91], v[144:147], v[56:59]
    ds_read_b128 v[152:155], v168 offset:2048
    s_cmp_lt_u32 s8, 5
    s_cselect_b64 s[70:71], s[70:71], 0
    v_add_u32 v216, v216, v211
    v_cndmask_b32 v202, v213, v216, s[70:71]
    s_or_b64 s[18:19], s[18:19], s[70:71]
    s_waitcnt lgkmcnt(6)
    v_mfma_f32_16x16x32_bf16 v[32:35], v[92:95], v[140:143], v[32:35]
    ds_read_b64_tr_b16 v[104:105], v164 offset:7680
    s_add_u32 s48, s61, 0
    s_add_u32 m0, s58, 115904
    s_nop 0
    buffer_load_dwordx4 v2, s[24:27], s48 offen lds
    v_mfma_f32_16x16x32_bf16 v[60:63], v[92:95], v[144:147], v[60:63]
    ds_read_b64_tr_b16 v[106:107], v164 offset:8640
    s_lshl_b32 s9, s63, 4
    s_add_u32 s9, s9, 2
    v_lshl_add_u32 v214, v11, 2, s9
    v_sub_u32 v215, v214, v212
    s_waitcnt lgkmcnt(6)
    v_mfma_f32_16x16x32_bf16 v[36:39], v[96:99], v[140:143], v[36:39]
    ds_read_b64_tr_b16 v[108:109], v164 offset:7696
    v_mfma_f32_16x16x32_bf16 v[64:67], v[96:99], v[144:147], v[64:67]
    ds_read_b64_tr_b16 v[110:111], v164 offset:8656
    s_add_u32 s48, s61, 9216
    s_add_u32 m0, s58, 116928
    s_nop 0
    buffer_load_dwordx4 v2, s[24:27], s48 offen lds
    v_cmp_gt_u32 s[70:71], 18, v215
    v_cmp_lt_u32 vcc, 9, v215
    v_lshlrev_b32 v216, 1, v215
    v_add_u32 v217, 4, v216
    s_waitcnt lgkmcnt(6)
    v_mfma_f32_16x16x32_bf16 v[40:43], v[100:103], v[140:143], v[40:43]
    ds_read_b64_tr_b16 v[112:113], v164 offset:7712
    v_mfma_f32_16x16x32_bf16 v[68:71], v[100:103], v[144:147], v[68:71]
    ds_read_b64_tr_b16 v[114:115], v164 offset:8672
    v_cndmask_b32 v216, v216, v217, vcc
    v_cmp_eq_u32 vcc, 36, v214
    v_mov_b32 v217, 20
    s_or_b64 s[70:71], s[70:71], vcc
    s_waitcnt lgkmcnt(4)
    v_mfma_f32_16x16x32_bf16 v[16:19], v[104:107], v[148:151], v[16:19]
    ds_read_b64_tr_b16 v[116:117], v164 offset:7728
    v_mfma_f32_16x16x32_bf16 v[44:47], v[104:107], v[152:155], v[44:47]
    ds_read_b64_tr_b16 v[118:119], v164 offset:8688
    s_add_u32 s48, s61, 18432
    s_add_u32 m0, s58, 117952
    s_nop 0
    buffer_load_dwordx4 v2, s[24:27], s48 offen lds
    v_cndmask_b32 v216, v216, v217, vcc
    s_cmp_lt_u32 s8, 5
    s_cselect_b64 s[70:71], s[70:71], 0
    v_add_u32 v216, v216, v211
    v_cndmask_b32 v203, v213, v216, s[70:71]
    s_waitcnt lgkmcnt(4)
    v_mfma_f32_16x16x32_bf16 v[20:23], v[108:111], v[148:151], v[20:23]
    ds_read_b64_tr_b16 v[120:121], v164 offset:7808
    v_mfma_f32_16x16x32_bf16 v[48:51], v[108:111], v[152:155], v[48:51]
    ds_read_b64_tr_b16 v[122:123], v164 offset:8768
    s_or_b64 s[18:19], s[18:19], s[70:71]
    s_lshl_b32 s9, s63, 4
    s_add_u32 s9, s9, 3
    v_lshl_add_u32 v214, v11, 2, s9
    s_waitcnt lgkmcnt(4)
    v_mfma_f32_16x16x32_bf16 v[24:27], v[112:115], v[148:151], v[24:27]
    ds_read_b64_tr_b16 v[124:125], v164 offset:7824
    s_add_u32 s48, s61, 27648
    s_add_u32 m0, s58, 118976
    s_nop 0
    buffer_load_dwordx4 v2, s[24:27], s48 offen lds
    v_mfma_f32_16x16x32_bf16 v[52:55], v[112:115], v[152:155], v[52:55]
    ds_read_b64_tr_b16 v[126:127], v164 offset:8784
    v_sub_u32 v215, v214, v212
    v_cmp_gt_u32 s[70:71], 18, v215
    v_cmp_lt_u32 vcc, 9, v215
    v_lshlrev_b32 v216, 1, v215
    s_waitcnt lgkmcnt(4)
    v_mfma_f32_16x16x32_bf16 v[28:31], v[116:119], v[148:151], v[28:31]
    ds_read_b64_tr_b16 v[128:129], v165 offset:7680
    v_mfma_f32_16x16x32_bf16 v[56:59], v[116:119], v[152:155], v[56:59]
    ds_read_b64_tr_b16 v[130:131], v165 offset:8640
    v_add_u32 v217, 4, v216
    v_cndmask_b32 v216, v216, v217, vcc
    v_cmp_eq_u32 vcc, 36, v214
    v_mov_b32 v217, 20
    s_waitcnt lgkmcnt(4)
    v_mfma_f32_16x16x32_bf16 v[32:35], v[120:123], v[148:151], v[32:35]
    s_nop 0
    buffer_load_dword v229, v228, s[72:75], 0 offen
    v_mfma_f32_16x16x32_bf16 v[60:63], v[120:123], v[152:155], v[60:63]
    s_or_b64 s[70:71], s[70:71], vcc
    v_cndmask_b32 v216, v216, v217, vcc
    s_cmp_lt_u32 s8, 5
    s_cselect_b64 s[70:71], s[70:71], 0
    v_add_u32 v216, v216, v211
    s_waitcnt lgkmcnt(2)
    v_mfma_f32_16x16x32_bf16 v[36:39], v[124:127], v[148:151], v[36:39]
    v_mfma_f32_16x16x32_bf16 v[64:67], v[124:127], v[152:155], v[64:67]
    v_cndmask_b32 v204, v213, v216, s[70:71]
    s_or_b64 s[18:19], s[18:19], s[70:71]
    v_mov_b32 v218, 0x80000000
    v_cndmask_b32 v231, v218, v209, s[18:19]
    s_waitcnt lgkmcnt(0)
    v_mfma_f32_16x16x32_bf16 v[40:43], v[128:131], v[148:151], v[40:43]
    v_mfma_f32_16x16x32_bf16 v[68:71], v[128:131], v[152:155], v[68:71]
    s_lshr_b32 s66, s8, 2
    s_add_u32 s65, s8, s66
    s_and_b32 s65, s65, 3
    s_and_b32 s67, s7, 3
    s_waitcnt vmcnt(7)
    s_barrier
    ds_read_b128 v[140:143], v175 offset:0
    ds_read_b128 v[144:147], v175 offset:2048
    ds_read_b64_tr_b16 v[76:77], v172 offset:0
    ds_read_b64_tr_b16 v[78:79], v172 offset:960
    ds_read_b64_tr_b16 v[80:81], v172 offset:16
    ds_read_b64_tr_b16 v[82:83], v172 offset:976
    ds_read_b64_tr_b16 v[84:85], v172 offset:32
    ds_read_b64_tr_b16 v[86:87], v172 offset:992
    ds_read_b64_tr_b16 v[88:89], v172 offset:48
    ds_read_b64_tr_b16 v[90:91], v172 offset:1008
    s_waitcnt lgkmcnt(6)
    v_mfma_f32_16x16x32_bf16 v[16:19], v[76:79], v[140:143], v[16:19]
    ds_read_b64_tr_b16 v[92:93], v172 offset:128
    s_add_u32 s61, s61, 128
    s_add_u32 s60, s60, 221184
    s_cmp_eq_u32 s61, 1152
    s_cselect_b32 s61, 0, s61
    s_cselect_b32 s60, s50, s60
    s_add_u32 s48, s60, 0
    s_add_u32 m0, s51, 0
    s_nop 0
    buffer_load_dwordx4 v5, s[28:31], s48 offen lds
    v_mfma_f32_16x16x32_bf16 v[44:47], v[76:79], v[144:147], v[44:47]
    ds_read_b64_tr_b16 v[94:95], v172 offset:1088
    s_lshr_b32 s68, s7, 2
    s_mul_i32 s10, s67, 288
    v_mov_b32 v216, 0x80000000
    s_lshl_b32 s9, s8, 6
    s_waitcnt lgkmcnt(6)
    v_mfma_f32_16x16x32_bf16 v[20:23], v[80:83], v[140:143], v[20:23]
    ds_read_b64_tr_b16 v[96:97], v172 offset:144
    v_mfma_f32_16x16x32_bf16 v[48:51], v[80:83], v[144:147], v[48:51]
    ds_read_b64_tr_b16 v[98:99], v172 offset:1104
    s_add_u32 s9, s9, 0
    v_add_u32 v210, s9, v1
    v_mul_u32_u24 v211, 1725, v210
    v_lshrrev_b32 v211, 18, v211
    s_waitcnt lgkmcnt(6)
    v_mfma_f32_16x16x32_bf16 v[24:27], v[84:87], v[140:143], v[24:27]
    ds_read_b64_tr_b16 v[100:101], v173 offset:0
    v_mfma_f32_16x16x32_bf16 v[52:55], v[84:87], v[144:147], v[52:55]
    ds_read_b64_tr_b16 v[102:103], v173 offset:960
    s_add_u32 s48, s60, 13824
    s_add_u32 m0, s51, 960
    s_nop 0
    buffer_load_dwordx4 v5, s[28:31], s48 offen lds
    v_mul_u32_u24 v212, 152, v211
    v_sub_u32 v212, v210, v212
    v_mul_u32_u24 v213, 3641, v212
    v_lshrrev_b32 v213, 16, v213
    s_waitcnt lgkmcnt(6)
    v_mfma_f32_16x16x32_bf16 v[28:31], v[88:91], v[140:143], v[28:31]
    ds_read_b128 v[148:151], v176 offset:0
    v_mfma_f32_16x16x32_bf16 v[56:59], v[88:91], v[144:147], v[56:59]
    ds_read_b128 v[152:155], v176 offset:2048
    v_mul_u32_u24 v214, 18, v213
    v_sub_u32 v214, v212, v214
    v_cmp_lt_u32 vcc, 143, v212
    v_lshl_add_u32 v213, v211, 3, v213
    s_waitcnt lgkmcnt(6)
    v_mfma_f32_16x16x32_bf16 v[32:35], v[92:95], v[140:143], v[32:35]
    ds_read_b64_tr_b16 v[104:105], v172 offset:7680
    v_mfma_f32_16x16x32_bf16 v[60:63], v[92:95], v[144:147], v[60:63]
    ds_read_b64_tr_b16 v[106:107], v172 offset:8640
    s_add_u32 s48, s61, 0
    s_add_u32 m0, s58, 15424
    s_nop 0
    buffer_load_dwordx4 v2, s[24:27], s48 offen lds
    v_lshlrev_b32 v214, 4, v214
    v_add_u32 v214, s10, v214
    v_lshrrev_b32 v215, 5, v213
    v_lshl_add_u32 v215, v215, 2, v213
    s_waitcnt lgkmcnt(6)
    v_mfma_f32_16x16x32_bf16 v[36:39], v[96:99], v[140:143], v[36:39]
    ds_read_b64_tr_b16 v[108:109], v172 offset:7696
    v_mfma_f32_16x16x32_bf16 v[64:67], v[96:99], v[144:147], v[64:67]
    ds_read_b64_tr_b16 v[110:111], v172 offset:8656
    v_mul_u32_u24 v215, 1152, v215
    v_add_u32 v215, v215, v214
    v_cndmask_b32 v232, v215, v216, vcc
    v_lshrrev_b32 v215, 2, v213
    s_waitcnt lgkmcnt(6)
    v_mfma_f32_16x16x32_bf16 v[40:43], v[100:103], v[140:143], v[40:43]
    ds_read_b64_tr_b16 v[112:113], v172 offset:7712
    v_mfma_f32_16x16x32_bf16 v[68:71], v[100:103], v[144:147], v[68:71]
    ds_read_b64_tr_b16 v[114:115], v172 offset:8672
    s_add_u32 s48, s61, 9216
    s_add_u32 m0, s58, 16448
    s_nop 0
    buffer_load_dwordx4 v2, s[24:27], s48 offen lds
    v_mul_u32_u24 v215, 36, v215
    v_and_b32 v213, 3, v213
    v_add3_u32 v215, v215, v213, 32
    v_mul_u32_u24 v215, 1152, v215
    s_waitcnt lgkmcnt(4)
    v_mfma_f32_16x16x32_bf16 v[16:19], v[104:107], v[148:151], v[16:19]
    ds_read_b64_tr_b16 v[116:117], v172 offset:7728
    v_mfma_f32_16x16x32_bf16 v[44:47], v[104:107], v[152:155], v[44:47]
    ds_read_b64_tr_b16 v[118:119], v172 offset:8688
    v_add_u32 v215, v215, v214
    v_cndmask_b32 v235, v215, v216, vcc
    s_lshl_b32 s9, s8, 6
    s_add_u32 s9, s9, 512
    s_waitcnt lgkmcnt(4)
    v_mfma_f32_16x16x32_bf16 v[20:23], v[108:111], v[148:151], v[20:23]
    ds_read_b64_tr_b16 v[120:121], v172 offset:7808
    v_mfma_f32_16x16x32_bf16 v[48:51], v[108:111], v[152:155], v[48:51]
    ds_read_b64_tr_b16 v[122:123], v172 offset:8768
    s_add_u32 s48, s61, 18432
    s_add_u32 m0, s58, 17472
    s_nop 0
    buffer_load_dwordx4 v2, s[24:27], s48 offen lds
    v_add_u32 v210, s9, v1
    v_mul_u32_u24 v211, 1725, v210
    v_lshrrev_b32 v211, 18, v211
    v_mul_u32_u24 v212, 152, v211
    s_waitcnt lgkmcnt(4)
    v_mfma_f32_16x16x32_bf16 v[24:27], v[112:115], v[148:151], v[24:27]
    ds_read_b64_tr_b16 v[124:125], v172 offset:7824
    v_mfma_f32_16x16x32_bf16 v[52:55], v[112:115], v[152:155], v[52:55]
    ds_read_b64_tr_b16 v[126:127], v172 offset:8784
    v_sub_u32 v212, v210, v212
    v_mul_u32_u24 v213, 3641, v212
    v_lshrrev_b32 v213, 16, v213
    v_mul_u32_u24 v214, 18, v213
    s_waitcnt lgkmcnt(4)
    v_mfma_f32_16x16x32_bf16 v[28:31], v[116:119], v[148:151], v[28:31]
    ds_read_b64_tr_b16 v[128:129], v173 offset:7680
    v_mfma_f32_16x16x32_bf16 v[56:59], v[116:119], v[152:155], v[56:59]
    ds_read_b64_tr_b16 v[130:131], v173 offset:8640
    s_add_u32 s48, s61, 27648
    s_add_u32 m0, s58, 18496
    s_nop 0
    buffer_load_dwordx4 v2, s[24:27], s48 offen lds
    v_sub_u32 v214, v212, v214
    v_cmp_lt_u32 vcc, 143, v212
    v_lshl_add_u32 v213, v211, 3, v213
    v_lshlrev_b32 v214, 4, v214
    s_waitcnt lgkmcnt(4)
    v_mfma_f32_16x16x32_bf16 v[32:35], v[120:123], v[148:151], v[32:35]
    v_mfma_f32_16x16x32_bf16 v[60:63], v[120:123], v[152:155], v[60:63]
    v_add_u32 v214, s10, v214
    v_lshrrev_b32 v215, 5, v213
    v_lshl_add_u32 v215, v215, 2, v213
    v_mul_u32_u24 v215, 1152, v215
    s_waitcnt lgkmcnt(2)
    v_mfma_f32_16x16x32_bf16 v[36:39], v[124:127], v[148:151], v[36:39]
    v_mfma_f32_16x16x32_bf16 v[64:67], v[124:127], v[152:155], v[64:67]
    v_add_u32 v215, v215, v214
    v_cndmask_b32 v233, v215, v216, vcc
    v_lshrrev_b32 v215, 2, v213
    v_mul_u32_u24 v215, 36, v215
    s_waitcnt lgkmcnt(0)
    v_mfma_f32_16x16x32_bf16 v[40:43], v[128:131], v[148:151], v[40:43]
    v_mfma_f32_16x16x32_bf16 v[68:71], v[128:131], v[152:155], v[68:71]
    v_and_b32 v213, 3, v213
    v_add3_u32 v215, v215, v213, 32
    v_mul_u32_u24 v215, 1152, v215
    v_add_u32 v215, v215, v214
    s_waitcnt vmcnt(7)
    s_barrier
    ds_read_b128 v[140:143], v183 offset:0
    ds_read_b128 v[144:147], v183 offset:2048
    ds_read_b64_tr_b16 v[76:77], v180 offset:0
    ds_read_b64_tr_b16 v[78:79], v180 offset:960
    ds_read_b64_tr_b16 v[80:81], v180 offset:16
    ds_read_b64_tr_b16 v[82:83], v180 offset:976
    ds_read_b64_tr_b16 v[84:85], v180 offset:32
    ds_read_b64_tr_b16 v[86:87], v180 offset:992
    ds_read_b64_tr_b16 v[88:89], v180 offset:48
    ds_read_b64_tr_b16 v[90:91], v180 offset:1008
    s_waitcnt lgkmcnt(6)
    v_mfma_f32_16x16x32_bf16 v[16:19], v[76:79], v[140:143], v[16:19]
    ds_read_b64_tr_b16 v[92:93], v180 offset:128
    s_add_u32 s61, s61, 128
    s_add_u32 s60, s60, 221184
    s_cmp_eq_u32 s61, 1152
    s_cselect_b32 s61, 0, s61
    s_cselect_b32 s60, s50, s60
    s_add_u32 s48, s60, 0
    s_add_u32 m0, s51, 50240
    s_nop 0
    buffer_load_dwordx4 v5, s[28:31], s48 offen lds
    v_mfma_f32_16x16x32_bf16 v[44:47], v[76:79], v[144:147], v[44:47]
    ds_read_b64_tr_b16 v[94:95], v180 offset:1088
    v_cndmask_b32 v236, v215, v216, vcc
    s_lshl_b32 s9, s8, 6
    s_add_u32 s9, s9, 1024
    v_add_u32 v210, s9, v1
    s_waitcnt lgkmcnt(6)
    v_mfma_f32_16x16x32_bf16 v[20:23], v[80:83], v[140:143], v[20:23]
    ds_read_b64_tr_b16 v[96:97], v180 offset:144
    v_mfma_f32_16x16x32_bf16 v[48:51], v[80:83], v[144:147], v[48:51]
    ds_read_b64_tr_b16 v[98:99], v180 offset:1104
    v_mul_u32_u24 v211, 1725, v210
    v_lshrrev_b32 v211, 18, v211
    v_mul_u32_u24 v212, 152, v211
    v_sub_u32 v212, v210, v212
    s_waitcnt lgkmcnt(6)
    v_mfma_f32_16x16x32_bf16 v[24:27], v[84:87], v[140:143], v[24:27]
    ds_read_b64_tr_b16 v[100:101], v181 offset:0
    v_mfma_f32_16x16x32_bf16 v[52:55], v[84:87], v[144:147], v[52:55]
    ds_read_b64_tr_b16 v[102:103], v181 offset:960
    s_add_u32 s48, s60, 13824
    s_add_u32 m0, s51, 51200
    s_nop 0
    buffer_load_dwordx4 v5, s[28:31], s48 offen lds
    v_mul_u32_u24 v213, 3641, v212
    v_lshrrev_b32 v213, 16, v213
    v_mul_u32_u24 v214, 18, v213
    v_sub_u32 v214, v212, v214
    s_waitcnt lgkmcnt(6)
    v_mfma_f32_16x16x32_bf16 v[28:31], v[88:91], v[140:143], v[28:31]
    ds_read_b128 v[148:151], v184 offset:0
    v_mfma_f32_16x16x32_bf16 v[56:59], v[88:91], v[144:147], v[56:59]
    ds_read_b128 v[152:155], v184 offset:2048
    v_cmp_lt_u32 vcc, 143, v212
    v_lshl_add_u32 v213, v211, 3, v213
    v_lshlrev_b32 v214, 4, v214
    v_add_u32 v214, s10, v214
    s_waitcnt lgkmcnt(6)
    v_mfma_f32_16x16x32_bf16 v[32:35], v[92:95], v[140:143], v[32:35]
    ds_read_b64_tr_b16 v[104:105], v180 offset:7680
    v_mfma_f32_16x16x32_bf16 v[60:63], v[92:95], v[144:147], v[60:63]
    ds_read_b64_tr_b16 v[106:107], v180 offset:8640
    s_add_u32 s48, s61, 0
    s_add_u32 m0, s58, 65664
    s_nop 0
    buffer_load_dwordx4 v2, s[24:27], s48 offen lds
    v_lshrrev_b32 v215, 5, v213
    v_lshl_add_u32 v215, v215, 2, v213
    v_mul_u32_u24 v215, 1152, v215
    v_add_u32 v215, v215, v214
    s_waitcnt lgkmcnt(6)
    v_mfma_f32_16x16x32_bf16 v[36:39], v[96:99], v[140:143], v[36:39]
    ds_read_b64_tr_b16 v[108:109], v180 offset:7696
    v_mfma_f32_16x16x32_bf16 v[64:67], v[96:99], v[144:147], v[64:67]
    ds_read_b64_tr_b16 v[110:111], v180 offset:8656
    v_cndmask_b32 v234, v215, v216, vcc
    v_lshrrev_b32 v215, 2, v213
    v_mul_u32_u24 v215, 36, v215
    v_and_b32 v213, 3, v213
    s_waitcnt lgkmcnt(6)
    v_mfma_f32_16x16x32_bf16 v[40:43], v[100:103], v[140:143], v[40:43]
    ds_read_b64_tr_b16 v[112:113], v180 offset:7712
    v_mfma_f32_16x16x32_bf16 v[68:71], v[100:103], v[144:147], v[68:71]
    ds_read_b64_tr_b16 v[114:115], v180 offset:8672
    s_add_u32 s48, s61, 9216
    s_add_u32 m0, s58, 66688
    s_nop 0
    buffer_load_dwordx4 v2, s[24:27], s48 offen lds
    v_add3_u32 v215, v215, v213, 32
    v_mul_u32_u24 v215, 1152, v215
    v_add_u32 v215, v215, v214
    v_cndmask_b32 v237, v215, v216, vcc
    s_waitcnt lgkmcnt(4)
    v_mfma_f32_16x16x32_bf16 v[16:19], v[104:107], v[148:151], v[16:19]
    ds_read_b64_tr_b16 v[116:117], v180 offset:7728
    v_mfma_f32_16x16x32_bf16 v[44:47], v[104:107], v[152:155], v[44:47]
    ds_read_b64_tr_b16 v[118:119], v180 offset:8688
    v_mul_u32_u24 v210, 2432, v11
    v_mul_u32_u24 v211, 288, v12
    v_lshlrev_b32 v212, 3, v13
    v_add3_u32 v211, v210, v211, v212
    s_waitcnt lgkmcnt(4)
    v_mfma_f32_16x16x32_bf16 v[20:23], v[108:111], v[148:151], v[20:23]
    ds_read_b64_tr_b16 v[120:121], v180 offset:7808
    v_mfma_f32_16x16x32_bf16 v[48:51], v[108:111], v[152:155], v[48:51]
    ds_read_b64_tr_b16 v[122:123], v180 offset:8768
    s_add_u32 s48, s61, 18432
    s_add_u32 m0, s58, 67712
    s_nop 0
    buffer_load_dwordx4 v2, s[24:27], s48 offen lds
    s_lshl_b32 s9, s65, 6
    s_add_u32 s9, s9, 81920
    v_add_u32 v238, s9, v211
    v_add_u32 v239, 82176, v211
    s_waitcnt lgkmcnt(4)
    v_mfma_f32_16x16x32_bf16 v[24:27], v[112:115], v[148:151], v[24:27]
    ds_read_b64_tr_b16 v[124:125], v180 offset:7824
    v_mfma_f32_16x16x32_bf16 v[52:55], v[112:115], v[152:155], v[52:55]
    ds_read_b64_tr_b16 v[126:127], v180 offset:8784
    v_add_u32 v240, 19456, v238
    v_add_u32 v241, 19456, v239
    v_add_u32 v242, 38912, v238
    v_add_u32 v243, 38912, v239
    s_waitcnt lgkmcnt(4)
    v_mfma_f32_16x16x32_bf16 v[28:31], v[116:119], v[148:151], v[28:31]
    ds_read_b64_tr_b16 v[128:129], v181 offset:7680
    v_mfma_f32_16x16x32_bf16 v[56:59], v[116:119], v[152:155], v[56:59]
    ds_read_b64_tr_b16 v[130:131], v181 offset:8640
    s_add_u32 s48, s61, 27648
    s_add_u32 m0, s58, 68736
    s_nop 0
    buffer_load_dwordx4 v2, s[24:27], s48 offen lds
    v_add_u32 v244, 58368, v238
    v_add_u32 v245, 58368, v239
    s_lshl_b32 s9, s66, 5
    v_add_u32 v210, s9, v10
    s_waitcnt lgkmcnt(4)
    v_mfma_f32_16x16x32_bf16 v[32:35], v[120:123], v[148:151], v[32:35]
    v_mfma_f32_16x16x32_bf16 v[60:63], v[120:123], v[152:155], v[60:63]
    v_mul_u32_u24 v211, 80, v210
    v_lshl_add_u32 v246, v11, 4, v211
    v_mul_u32_u24 v212, 10240, v11
    v_add3_u32 v247, v211, v212, 64
    s_waitcnt lgkmcnt(2)
    v_mfma_f32_16x16x32_bf16 v[36:39], v[124:127], v[148:151], v[36:39]
    v_mfma_f32_16x16x32_bf16 v[64:67], v[124:127], v[152:155], v[64:67]
    v_mul_u32_u24 v211, 304, v210
    v_lshl_add_u32 v211, v11, 3, v211
    s_lshl_b32 s9, s65, 6
    v_add_u32 v248, s9, v211
    s_waitcnt lgkmcnt(0)
    v_mfma_f32_16x16x32_bf16 v[40:43], v[128:131], v[148:151], v[40:43]
    v_mfma_f32_16x16x32_bf16 v[68:71], v[128:131], v[152:155], v[68:71]
    s_lshl_b32 s10, s6, 2
    s_add_u32 s10, s10, s68
    s_mul_i32 s10, s10, 147456
    s_mul_i32 s9, s5, 1152
    s_waitcnt vmcnt(6)
    s_barrier
    ds_read_b128 v[140:143], v167 offset:0
    ds_read_b128 v[144:147], v167 offset:2048
    ds_read_b64_tr_b16 v[76:77], v164 offset:0
    ds_read_b64_tr_b16 v[78:79], v164 offset:960
    ds_read_b64_tr_b16 v[80:81], v164 offset:16
    ds_read_b64_tr_b16 v[82:83], v164 offset:976
    ds_read_b64_tr_b16 v[84:85], v164 offset:32
    ds_read_b64_tr_b16 v[86:87], v164 offset:992
    ds_read_b64_tr_b16 v[88:89], v164 offset:48
    ds_read_b64_tr_b16 v[90:91], v164 offset:1008
    s_waitcnt lgkmcnt(6)
    v_mfma_f32_16x16x32_bf16 v[16:19], v[76:79], v[140:143], v[16:19]
    ds_read_b64_tr_b16 v[92:93], v164 offset:128
    s_add_u32 s61, s61, 128
    s_add_u32 s60, s60, 221184
    s_cmp_eq_u32 s61, 1152
    s_cselect_b32 s61, 0, s61
    s_cselect_b32 s60, s50, s60
    s_add_u32 s48, s60, 0
    s_add_u32 m0, s51, 100480
    s_nop 0
    buffer_load_dwordx4 v5, s[28:31], s48 offen lds
    v_mfma_f32_16x16x32_bf16 v[44:47], v[76:79], v[144:147], v[44:47]
    ds_read_b64_tr_b16 v[94:95], v164 offset:1088
    s_add_u32 s10, s10, s9
    s_mul_i32 s9, s67, 288
    s_add_u32 s10, s10, s9
    s_lshl_b32 s9, s8, 6
    s_waitcnt lgkmcnt(6)
    v_mfma_f32_16x16x32_bf16 v[20:23], v[80:83], v[140:143], v[20:23]
    ds_read_b64_tr_b16 v[96:97], v164 offset:144
    v_mfma_f32_16x16x32_bf16 v[48:51], v[80:83], v[144:147], v[48:51]
    ds_read_b64_tr_b16 v[98:99], v164 offset:1104
    s_add_u32 s9, s9, 0
    v_add_u32 v210, s9, v1
    v_mul_u32_u24 v211, 3641, v210
    v_lshrrev_b32 v211, 16, v211
    s_waitcnt lgkmcnt(6)
    v_mfma_f32_16x16x32_bf16 v[24:27], v[84:87], v[140:143], v[24:27]
    ds_read_b64_tr_b16 v[100:101], v165 offset:0
    v_mfma_f32_16x16x32_bf16 v[52:55], v[84:87], v[144:147], v[52:55]
    ds_read_b64_tr_b16 v[102:103], v165 offset:960
    s_add_u32 s48, s60, 13824
    s_add_u32 m0, s51, 101440
    s_nop 0
    buffer_load_dwordx4 v5, s[28:31], s48 offen lds
    v_mul_u32_u24 v212, 18, v211
    v_sub_u32 v212, v210, v212
    v_lshlrev_b32 v212, 4, v212
    v_mul_u32_u24 v213, 304, v211
    s_waitcnt lgkmcnt(6)
    v_mfma_f32_16x16x32_bf16 v[28:31], v[88:91], v[140:143], v[28:31]
    ds_read_b128 v[148:151], v168 offset:0
    v_mfma_f32_16x16x32_bf16 v[56:59], v[88:91], v[144:147], v[56:59]
    ds_read_b128 v[152:155], v168 offset:2048
    v_add_u32 v249, v213, v212
    v_mul_u32_u24 v213, 2304, v211
    v_add3_u32 v252, v213, v212, s10
    s_lshl_b32 s9, s8, 6
    s_waitcnt lgkmcnt(6)
    v_mfma_f32_16x16x32_bf16 v[32:35], v[92:95], v[140:143], v[32:35]
    ds_read_b64_tr_b16 v[104:105], v164 offset:7680
    v_mfma_f32_16x16x32_bf16 v[60:63], v[92:95], v[144:147], v[60:63]
    ds_read_b64_tr_b16 v[106:107], v164 offset:8640
    s_add_u32 s48, s61, 0
    s_add_u32 m0, s58, 115904
    s_nop 0
    buffer_load_dwordx4 v2, s[24:27], s48 offen lds
    s_add_u32 s9, s9, 512
    v_add_u32 v210, s9, v1
    v_mul_u32_u24 v211, 3641, v210
    v_lshrrev_b32 v211, 16, v211
    s_waitcnt lgkmcnt(6)
    v_mfma_f32_16x16x32_bf16 v[36:39], v[96:99], v[140:143], v[36:39]
    ds_read_b64_tr_b16 v[108:109], v164 offset:7696
    v_mfma_f32_16x16x32_bf16 v[64:67], v[96:99], v[144:147], v[64:67]
    ds_read_b64_tr_b16 v[110:111], v164 offset:8656
    v_mul_u32_u24 v212, 18, v211
    v_sub_u32 v212, v210, v212
    v_lshlrev_b32 v212, 4, v212
    v_mul_u32_u24 v213, 304, v211
    s_waitcnt lgkmcnt(6)
    v_mfma_f32_16x16x32_bf16 v[40:43], v[100:103], v[140:143], v[40:43]
    ds_read_b64_tr_b16 v[112:113], v164 offset:7712
    v_mfma_f32_16x16x32_bf16 v[68:71], v[100:103], v[144:147], v[68:71]
    ds_read_b64_tr_b16 v[114:115], v164 offset:8672
    s_add_u32 s48, s61, 9216
    s_add_u32 m0, s58, 116928
    s_nop 0
    buffer_load_dwordx4 v2, s[24:27], s48 offen lds
    v_add_u32 v250, v213, v212
    v_mul_u32_u24 v213, 2304, v211
    v_add3_u32 v253, v213, v212, s10
    s_lshl_b32 s9, s8, 6
    s_waitcnt lgkmcnt(4)
    v_mfma_f32_16x16x32_bf16 v[16:19], v[104:107], v[148:151], v[16:19]
    ds_read_b64_tr_b16 v[116:117], v164 offset:7728
    v_mfma_f32_16x16x32_bf16 v[44:47], v[104:107], v[152:155], v[44:47]
    ds_read_b64_tr_b16 v[118:119], v164 offset:8688
    s_add_u32 s9, s9, 1024
    v_add_u32 v210, s9, v1
    v_mul_u32_u24 v211, 3641, v210
    v_lshrrev_b32 v211, 16, v211
    s_waitcnt lgkmcnt(4)
    v_mfma_f32_16x16x32_bf16 v[20:23], v[108:111], v[148:151], v[20:23]
    ds_read_b64_tr_b16 v[120:121], v164 offset:7808
    v_mfma_f32_16x16x32_bf16 v[48:51], v[108:111], v[152:155], v[48:51]
    ds_read_b64_tr_b16 v[122:123], v164 offset:8768
    s_add_u32 s48, s61, 18432
    s_add_u32 m0, s58, 117952
    s_nop 0
    buffer_load_dwordx4 v2, s[24:27], s48 offen lds
    v_mul_u32_u24 v212, 18, v211
    v_sub_u32 v212, v210, v212
    v_lshlrev_b32 v212, 4, v212
    v_mul_u32_u24 v213, 304, v211
    s_waitcnt lgkmcnt(4)
    v_mfma_f32_16x16x32_bf16 v[24:27], v[112:115], v[148:151], v[24:27]
    ds_read_b64_tr_b16 v[124:125], v164 offset:7824
    v_mfma_f32_16x16x32_bf16 v[52:55], v[112:115], v[152:155], v[52:55]
    ds_read_b64_tr_b16 v[126:127], v164 offset:8784
    v_add_u32 v251, v213, v212
    v_mul_u32_u24 v213, 2304, v211
    v_add3_u32 v254, v213, v212, s10
    s_lshl_b32 s9, s5, 3
    s_waitcnt lgkmcnt(4)
    v_mfma_f32_16x16x32_bf16 v[28:31], v[116:119], v[148:151], v[28:31]
    ds_read_b64_tr_b16 v[128:129], v165 offset:7680
    v_mfma_f32_16x16x32_bf16 v[56:59], v[116:119], v[152:155], v[56:59]
    ds_read_b64_tr_b16 v[130:131], v165 offset:8640
    s_add_u32 s48, s61, 27648
    s_add_u32 m0, s58, 118976
    s_nop 0
    buffer_load_dwordx4 v2, s[24:27], s48 offen lds
    s_add_u32 s9, s9, s6
    s_lshl_b32 s9, s9, 3
    s_add_u32 s9, s9, s8
    s_mul_i32 s9, s9, 40960
    s_waitcnt lgkmcnt(4)
    v_mfma_f32_16x16x32_bf16 v[32:35], v[120:123], v[148:151], v[32:35]
    v_mfma_f32_16x16x32_bf16 v[60:63], v[120:123], v[152:155], v[60:63]
    s_mul_i32 s10, s68, 5120
    s_add_u32 s9, s9, s10
    v_lshlrev_b32 v210, 4, v1
    v_add_u32 v255, s9, v210
    s_waitcnt lgkmcnt(2)
    v_mfma_f32_16x16x32_bf16 v[36:39], v[124:127], v[148:151], v[36:39]
    v_mfma_f32_16x16x32_bf16 v[64:67], v[124:127], v[152:155], v[64:67]
    s_waitcnt lgkmcnt(0)
    v_mfma_f32_16x16x32_bf16 v[40:43], v[128:131], v[148:151], v[40:43]
    v_mfma_f32_16x16x32_bf16 v[68:71], v[128:131], v[152:155], v[68:71]
    s_waitcnt vmcnt(6)
    s_barrier
    ds_read_b128 v[140:143], v175 offset:0
    ds_read_b128 v[144:147], v175 offset:2048
    ds_read_b64_tr_b16 v[76:77], v172 offset:0
    ds_read_b64_tr_b16 v[78:79], v172 offset:960
    ds_read_b64_tr_b16 v[80:81], v172 offset:16
    ds_read_b64_tr_b16 v[82:83], v172 offset:976
    ds_read_b64_tr_b16 v[84:85], v172 offset:32
    ds_read_b64_tr_b16 v[86:87], v172 offset:992
    ds_read_b64_tr_b16 v[88:89], v172 offset:48
    ds_read_b64_tr_b16 v[90:91], v172 offset:1008
    s_waitcnt lgkmcnt(6)
    v_mfma_f32_16x16x32_bf16 v[16:19], v[76:79], v[140:143], v[16:19]
    ds_read_b64_tr_b16 v[92:93], v172 offset:128
    v_mov_b32 v8, 64
    s_nop 0
    buffer_load_dwordx2 v[6:7], v8, s[44:47], 0 offen sc1
    v_mfma_f32_16x16x32_bf16 v[44:47], v[76:79], v[144:147], v[44:47]
    ds_read_b64_tr_b16 v[94:95], v172 offset:1088
    s_waitcnt lgkmcnt(6)
    v_mfma_f32_16x16x32_bf16 v[20:23], v[80:83], v[140:143], v[20:23]
    ds_read_b64_tr_b16 v[96:97], v172 offset:144
    v_mfma_f32_16x16x32_bf16 v[48:51], v[80:83], v[144:147], v[48:51]
    ds_read_b64_tr_b16 v[98:99], v172 offset:1104
    s_waitcnt lgkmcnt(6)
    v_mfma_f32_16x16x32_bf16 v[24:27], v[84:87], v[140:143], v[24:27]
    ds_read_b64_tr_b16 v[100:101], v173 offset:0
    v_mfma_f32_16x16x32_bf16 v[52:55], v[84:87], v[144:147], v[52:55]
    ds_read_b64_tr_b16 v[102:103], v173 offset:960
    s_waitcnt lgkmcnt(6)
    v_mfma_f32_16x16x32_bf16 v[28:31], v[88:91], v[140:143], v[28:31]
    ds_read_b128 v[148:151], v176 offset:0
    v_mfma_f32_16x16x32_bf16 v[56:59], v[88:91], v[144:147], v[56:59]
    ds_read_b128 v[152:155], v176 offset:2048
    s_waitcnt lgkmcnt(6)
    v_mfma_f32_16x16x32_bf16 v[32:35], v[92:95], v[140:143], v[32:35]
    ds_read_b64_tr_b16 v[104:105], v172 offset:7680
    v_mfma_f32_16x16x32_bf16 v[60:63], v[92:95], v[144:147], v[60:63]
    ds_read_b64_tr_b16 v[106:107], v172 offset:8640
    s_waitcnt lgkmcnt(6)
    v_mfma_f32_16x16x32_bf16 v[36:39], v[96:99], v[140:143], v[36:39]
    ds_read_b64_tr_b16 v[108:109], v172 offset:7696
    v_mfma_f32_16x16x32_bf16 v[64:67], v[96:99], v[144:147], v[64:67]
    ds_read_b64_tr_b16 v[110:111], v172 offset:8656
    s_waitcnt lgkmcnt(6)
    v_mfma_f32_16x16x32_bf16 v[40:43], v[100:103], v[140:143], v[40:43]
    ds_read_b64_tr_b16 v[112:113], v172 offset:7712
    v_mfma_f32_16x16x32_bf16 v[68:71], v[100:103], v[144:147], v[68:71]
    ds_read_b64_tr_b16 v[114:115], v172 offset:8672
    s_waitcnt lgkmcnt(4)
    v_mfma_f32_16x16x32_bf16 v[16:19], v[104:107], v[148:151], v[16:19]
    ds_read_b64_tr_b16 v[116:117], v172 offset:7728
    v_mfma_f32_16x16x32_bf16 v[44:47], v[104:107], v[152:155], v[44:47]
    ds_read_b64_tr_b16 v[118:119], v172 offset:8688
    s_waitcnt lgkmcnt(4)
    v_mfma_f32_16x16x32_bf16 v[20:23], v[108:111], v[148:151], v[20:23]
    ds_read_b64_tr_b16 v[120:121], v172 offset:7808
    v_mfma_f32_16x16x32_bf16 v[48:51], v[108:111], v[152:155], v[48:51]
    ds_read_b64_tr_b16 v[122:123], v172 offset:8768
    s_waitcnt lgkmcnt(4)
    v_mfma_f32_16x16x32_bf16 v[24:27], v[112:115], v[148:151], v[24:27]
    ds_read_b64_tr_b16 v[124:125], v172 offset:7824
    v_mfma_f32_16x16x32_bf16 v[52:55], v[112:115], v[152:155], v[52:55]
    ds_read_b64_tr_b16 v[126:127], v172 offset:8784
    s_waitcnt lgkmcnt(4)
    v_mfma_f32_16x16x32_bf16 v[28:31], v[116:119], v[148:151], v[28:31]
    ds_read_b64_tr_b16 v[128:129], v173 offset:7680
    v_mfma_f32_16x16x32_bf16 v[56:59], v[116:119], v[152:155], v[56:59]
    ds_read_b64_tr_b16 v[130:131], v173 offset:8640
    s_waitcnt lgkmcnt(4)
    v_mfma_f32_16x16x32_bf16 v[32:35], v[120:123], v[148:151], v[32:35]
    v_mfma_f32_16x16x32_bf16 v[60:63], v[120:123], v[152:155], v[60:63]
    s_waitcnt lgkmcnt(2)
    v_mfma_f32_16x16x32_bf16 v[36:39], v[124:127], v[148:151], v[36:39]
    v_mfma_f32_16x16x32_bf16 v[64:67], v[124:127], v[152:155], v[64:67]
    s_waitcnt lgkmcnt(0)
    v_mfma_f32_16x16x32_bf16 v[40:43], v[128:131], v[148:151], v[40:43]
    v_mfma_f32_16x16x32_bf16 v[68:71], v[128:131], v[152:155], v[68:71]
    s_waitcnt vmcnt(1)
    s_barrier
    ds_read_b128 v[140:143], v183 offset:0
    ds_read_b128 v[144:147], v183 offset:2048
    ds_read_b64_tr_b16 v[76:77], v180 offset:0
    ds_read_b64_tr_b16 v[78:79], v180 offset:960
    ds_read_b64_tr_b16 v[80:81], v180 offset:16
    ds_read_b64_tr_b16 v[82:83], v180 offset:976
    ds_read_b64_tr_b16 v[84:85], v180 offset:32
    ds_read_b64_tr_b16 v[86:87], v180 offset:992
    ds_read_b64_tr_b16 v[88:89], v180 offset:48
    ds_read_b64_tr_b16 v[90:91], v180 offset:1008
    s_waitcnt lgkmcnt(6)
    v_mfma_f32_16x16x32_bf16 v[16:19], v[76:79], v[140:143], v[16:19]
    ds_read_b64_tr_b16 v[92:93], v180 offset:128
    v_mfma_f32_16x16x32_bf16 v[44:47], v[76:79], v[144:147], v[44:47]
    ds_read_b64_tr_b16 v[94:95], v180 offset:1088
    s_waitcnt lgkmcnt(6)
    v_mfma_f32_16x16x32_bf16 v[20:23], v[80:83], v[140:143], v[20:23]
    ds_read_b64_tr_b16 v[96:97], v180 offset:144
    v_mfma_f32_16x16x32_bf16 v[48:51], v[80:83], v[144:147], v[48:51]
    ds_read_b64_tr_b16 v[98:99], v180 offset:1104
    s_waitcnt lgkmcnt(6)
    v_mfma_f32_16x16x32_bf16 v[24:27], v[84:87], v[140:143], v[24:27]
    ds_read_b64_tr_b16 v[100:101], v181 offset:0
    v_mfma_f32_16x16x32_bf16 v[52:55], v[84:87], v[144:147], v[52:55]
    ds_read_b64_tr_b16 v[102:103], v181 offset:960
    s_waitcnt lgkmcnt(6)
    v_mfma_f32_16x16x32_bf16 v[28:31], v[88:91], v[140:143], v[28:31]
    ds_read_b128 v[148:151], v184 offset:0
    v_mfma_f32_16x16x32_bf16 v[56:59], v[88:91], v[144:147], v[56:59]
    ds_read_b128 v[152:155], v184 offset:2048
    s_waitcnt lgkmcnt(6)
    v_mfma_f32_16x16x32_bf16 v[32:35], v[92:95], v[140:143], v[32:35]
    ds_read_b64_tr_b16 v[104:105], v180 offset:7680
    v_mfma_f32_16x16x32_bf16 v[60:63], v[92:95], v[144:147], v[60:63]
    ds_read_b64_tr_b16 v[106:107], v180 offset:8640
    s_waitcnt lgkmcnt(6)
    v_mfma_f32_16x16x32_bf16 v[36:39], v[96:99], v[140:143], v[36:39]
    ds_read_b64_tr_b16 v[108:109], v180 offset:7696
    v_mfma_f32_16x16x32_bf16 v[64:67], v[96:99], v[144:147], v[64:67]
    ds_read_b64_tr_b16 v[110:111], v180 offset:8656
    s_waitcnt lgkmcnt(6)
    v_mfma_f32_16x16x32_bf16 v[40:43], v[100:103], v[140:143], v[40:43]
    ds_read_b64_tr_b16 v[112:113], v180 offset:7712
    v_mfma_f32_16x16x32_bf16 v[68:71], v[100:103], v[144:147], v[68:71]
    ds_read_b64_tr_b16 v[114:115], v180 offset:8672
    s_waitcnt lgkmcnt(4)
    v_mfma_f32_16x16x32_bf16 v[16:19], v[104:107], v[148:151], v[16:19]
    ds_read_b64_tr_b16 v[116:117], v180 offset:7728
    v_mfma_f32_16x16x32_bf16 v[44:47], v[104:107], v[152:155], v[44:47]
    ds_read_b64_tr_b16 v[118:119], v180 offset:8688
    s_waitcnt lgkmcnt(4)
    v_mfma_f32_16x16x32_bf16 v[20:23], v[108:111], v[148:151], v[20:23]
    ds_read_b64_tr_b16 v[120:121], v180 offset:7808
    v_mfma_f32_16x16x32_bf16 v[48:51], v[108:111], v[152:155], v[48:51]
    ds_read_b64_tr_b16 v[122:123], v180 offset:8768
    s_waitcnt lgkmcnt(4)
    v_mfma_f32_16x16x32_bf16 v[24:27], v[112:115], v[148:151], v[24:27]
    ds_read_b64_tr_b16 v[124:125], v180 offset:7824
    v_mfma_f32_16x16x32_bf16 v[52:55], v[112:115], v[152:155], v[52:55]
    ds_read_b64_tr_b16 v[126:127], v180 offset:8784
    s_waitcnt lgkmcnt(4)
    v_mfma_f32_16x16x32_bf16 v[28:31], v[116:119], v[148:151], v[28:31]
    ds_read_b64_tr_b16 v[128:129], v181 offset:7680
    v_mfma_f32_16x16x32_bf16 v[56:59], v[116:119], v[152:155], v[56:59]
    ds_read_b64_tr_b16 v[130:131], v181 offset:8640
    s_waitcnt lgkmcnt(4)
    v_mfma_f32_16x16x32_bf16 v[32:35], v[120:123], v[148:151], v[32:35]
    v_mfma_f32_16x16x32_bf16 v[60:63], v[120:123], v[152:155], v[60:63]
    s_waitcnt lgkmcnt(2)
    v_mfma_f32_16x16x32_bf16 v[36:39], v[124:127], v[148:151], v[36:39]
    v_mfma_f32_16x16x32_bf16 v[64:67], v[124:127], v[152:155], v[64:67]
    s_waitcnt lgkmcnt(0)
    v_mfma_f32_16x16x32_bf16 v[40:43], v[128:131], v[148:151], v[40:43]
    v_mfma_f32_16x16x32_bf16 v[68:71], v[128:131], v[152:155], v[68:71]
    s_mov_b32 s60, 1069066811
    s_mov_b32 s61, 1069066811
    ds_read_b64_tr_b16 v[76:77], v187 offset:0
    ds_read_b64_tr_b16 v[78:79], v188 offset:0
    ds_read_b64_tr_b16 v[98:99], v190 offset:0
    ds_read_b64_tr_b16 v[96:97], v189 offset:0
    ds_read_b64_tr_b16 v[80:81], v187 offset:8
    ds_read_b64_tr_b16 v[82:83], v188 offset:8
    ds_read_b64_tr_b16 v[104:105], v190 offset:8
    ds_read_b64_tr_b16 v[102:103], v189 offset:8
    ds_read_b64_tr_b16 v[84:85], v187 offset:16
    ds_read_b64_tr_b16 v[86:87], v188 offset:16
    ds_read_b64_tr_b16 v[110:111], v190 offset:16
    ds_read_b64_tr_b16 v[108:109], v189 offset:16
    ds_read_b64_tr_b16 v[88:89], v187 offset:24
    ds_read_b64_tr_b16 v[90:91], v188 offset:24
    ds_read_b64_tr_b16 v[116:117], v190 offset:24
    ds_read_b64_tr_b16 v[114:115], v189 offset:24
    ds_read_b64_tr_b16 v[92:93], v187 offset:32
    ds_read_b64_tr_b16 v[94:95], v188 offset:32
    ds_read_b64_tr_b16 v[122:123], v190 offset:32
    ds_read_b64_tr_b16 v[120:121], v189 offset:32
    v_mov_b32 v100, 0
    v_mov_b32 v101, 0
    v_mov_b32 v106, 0
    v_mov_b32 v107, 0
    v_mov_b32 v112, 0
    v_mov_b32 v113, 0
    v_mov_b32 v118, 0
    v_mov_b32 v119, 0
    v_mov_b32 v124, 0
    v_mov_b32 v125, 0
    v_cvt_pk_bf16_f32 v130, v24, v25
    v_cvt_pk_bf16_f32 v131, v26, v27
    v_cvt_pk_bf16_f32 v132, v28, v29
    v_cvt_pk_bf16_f32 v133, v30, v31
    v_cvt_pk_bf16_f32 v134, v40, v41
    v_cvt_pk_bf16_f32 v135, v42, v43
    v_cvt_pk_bf16_f32 v126, v16, v17
    v_cvt_pk_bf16_f32 v127, v18, v19
    v_cvt_pk_bf16_f32 v128, v20, v21
    v_cvt_pk_bf16_f32 v129, v22, v23
    v_mov_b32 v136, 0
    v_mov_b32 v137, 0
    v_cvt_pk_bf16_f32 v138, v32, v33
    v_cvt_pk_bf16_f32 v139, v34, v35
    v_cvt_pk_bf16_f32 v140, v36, v37
    v_cvt_pk_bf16_f32 v141, v38, v39
    v_cvt_pk_bf16_f32 v146, v52, v53
    v_cvt_pk_bf16_f32 v147, v54, v55
    v_cvt_pk_bf16_f32 v148, v56, v57
    v_cvt_pk_bf16_f32 v149, v58, v59
    v_cvt_pk_bf16_f32 v150, v68, v69
    v_cvt_pk_bf16_f32 v151, v70, v71
    v_cvt_pk_bf16_f32 v142, v44, v45
    v_cvt_pk_bf16_f32 v143, v46, v47
    v_cvt_pk_bf16_f32 v144, v48, v49
    v_cvt_pk_bf16_f32 v145, v50, v51
    v_mov_b32 v152, 0
    v_mov_b32 v153, 0
    v_cvt_pk_bf16_f32 v154, v60, v61
    v_cvt_pk_bf16_f32 v155, v62, v63
    v_cvt_pk_bf16_f32 v156, v64, v65
    v_cvt_pk_bf16_f32 v157, v66, v67
    s_waitcnt lgkmcnt(0)
    v_mfma_f32_16x16x32_bf16 v[16:19], v[76:79], v[130:133], 0
    v_mfma_f32_16x16x32_bf16 v[20:23], v[80:83], v[130:133], 0
    v_mfma_f32_16x16x32_bf16 v[24:27], v[84:87], v[130:133], 0
    v_mfma_f32_16x16x32_bf16 v[28:31], v[88:91], v[130:133], 0
    v_mfma_f32_16x16x32_bf16 v[32:35], v[92:95], v[130:133], 0
    v_mfma_f32_16x16x32_bf16 v[16:19], v[98:101], v[134:137], v[16:19]
    v_mfma_f32_16x16x32_bf16 v[20:23], v[104:107], v[134:137], v[20:23]
    v_mfma_f32_16x16x32_bf16 v[24:27], v[110:113], v[134:137], v[24:27]
    v_mfma_f32_16x16x32_bf16 v[28:31], v[116:119], v[134:137], v[28:31]
    v_mfma_f32_16x16x32_bf16 v[32:35], v[122:125], v[134:137], v[32:35]
    v_mfma_f32_16x16x32_bf16 v[36:39], v[76:79], v[146:149], 0
    v_mfma_f32_16x16x32_bf16 v[40:43], v[80:83], v[146:149], 0
    v_mfma_f32_16x16x32_bf16 v[44:47], v[84:87], v[146:149], 0
    v_mfma_f32_16x16x32_bf16 v[48:51], v[88:91], v[146:149], 0
    v_mfma_f32_16x16x32_bf16 v[52:55], v[92:95], v[146:149], 0
    v_mfma_f32_16x16x32_bf16 v[36:39], v[98:101], v[150:153], v[36:39]
    v_mfma_f32_16x16x32_bf16 v[40:43], v[104:107], v[150:153], v[40:43]
    v_mfma_f32_16x16x32_bf16 v[44:47], v[110:113], v[150:153], v[44:47]
    v_mfma_f32_16x16x32_bf16 v[48:51], v[116:119], v[150:153], v[48:51]
    v_mfma_f32_16x16x32_bf16 v[52:55], v[122:125], v[150:153], v[52:55]
    ds_write_b64 v191, v[138:139] offset:160
    ds_write_b64 v191, v[140:141] offset:192
    ds_write_b64 v191, v[154:155] offset:4000
    ds_write_b64 v191, v[156:157] offset:4032
    v_cmp_eq_u32 vcc, 3, v11
    v_mov_b32 v210, 0x3f80
    s_mov_b32 exec_lo, 0
    v_cndmask_b32 v212, v134, v210, vcc
    v_cndmask_b32 v213, v135, 0, vcc
    ds_write_b64 v191, v[212:213] offset:208
    v_cndmask_b32 v214, v150, v210, vcc
    v_cndmask_b32 v215, v151, 0, vcc
    ds_write_b64 v191, v[214:215] offset:4048
    s_mov_b32 exec_lo, -1
    v_mov_b32 v227, 0
    v_cvt_pk_bf16_f32 v16, 0, v16
    v_cvt_pk_bf16_f32 v17, 0, v17
    v_cvt_pk_bf16_f32 v18, 0, v18
    v_mfma_f32_16x16x32_bf16 v[56:59], v[76:79], v[126:129], 0
    v_cvt_pk_bf16_f32 v19, 0, v19
    v_cvt_pk_bf16_f32 v20, 0, v20
    v_cvt_pk_bf16_f32 v21, 0, v21
    v_cvt_pk_bf16_f32 v22, 0, v22
    v_mfma_f32_16x16x32_bf16 v[60:63], v[80:83], v[126:129], 0
    v_cvt_pk_bf16_f32 v23, 0, v23
    v_cvt_pk_bf16_f32 v24, 0, v24
    v_cvt_pk_bf16_f32 v25, 0, v25
    v_cvt_pk_bf16_f32 v26, 0, v26
    v_mfma_f32_16x16x32_bf16 v[64:67], v[84:87], v[126:129], 0
    v_cvt_pk_bf16_f32 v27, 0, v27
    v_cvt_pk_bf16_f32 v28, 0, v28
    v_cvt_pk_bf16_f32 v29, 0, v29
    v_cvt_pk_bf16_f32 v30, 0, v30
    v_mfma_f32_16x16x32_bf16 v[68:71], v[88:91], v[126:129], 0
    v_cvt_pk_bf16_f32 v31, 0, v31
    v_cvt_pk_bf16_f32 v32, 0, v32
    v_cvt_pk_bf16_f32 v33, 0, v33
    v_max3_f32 v228, v16, v17, v18
    v_mfma_f32_16x16x32_bf16 v[72:75], v[92:95], v[126:129], 0
    v_max3_f32 v229, v19, v20, v21
    v_max3_f32 v228, v228, v22, v23
    v_max3_f32 v229, v229, v24, v25
    v_max3_f32 v228, v228, v26, v27
    v_mfma_f32_16x16x32_bf16 v[56:59], v[96:99], v[134:137], v[56:59]
    v_max3_f32 v229, v229, v28, v29
    v_max3_f32 v228, v228, v30, v31
    v_max3_f32 v229, v229, v32, v33
    v_max_f32 v228, v228, v229
    v_mfma_f32_16x16x32_bf16 v[60:63], v[102:105], v[134:137], v[60:63]
    v_mul_f32 v228, s60, v228
    v_pk_fma_f32 v[16:17], v[16:17], s[60:61], v[228:229] op_sel_hi:[1,1,0] neg_lo:[0,0,1] neg_hi:[0,0,1]
    v_pk_fma_f32 v[18:19], v[18:19], s[60:61], v[228:229] op_sel_hi:[1,1,0] neg_lo:[0,0,1] neg_hi:[0,0,1]
    v_pk_fma_f32 v[20:21], v[20:21], s[60:61], v[228:229] op_sel_hi:[1,1,0] neg_lo:[0,0,1] neg_hi:[0,0,1]
    v_mfma_f32_16x16x32_bf16 v[64:67], v[108:111], v[134:137], v[64:67]
    v_pk_fma_f32 v[22:23], v[22:23], s[60:61], v[228:229] op_sel_hi:[1,1,0] neg_lo:[0,0,1] neg_hi:[0,0,1]
    v_pk_fma_f32 v[24:25], v[24:25], s[60:61], v[228:229] op_sel_hi:[1,1,0] neg_lo:[0,0,1] neg_hi:[0,0,1]
    v_pk_fma_f32 v[26:27], v[26:27], s[60:61], v[228:229] op_sel_hi:[1,1,0] neg_lo:[0,0,1] neg_hi:[0,0,1]
    v_pk_fma_f32 v[28:29], v[28:29], s[60:61], v[228:229] op_sel_hi:[1,1,0] neg_lo:[0,0,1] neg_hi:[0,0,1]
    v_mfma_f32_16x16x32_bf16 v[68:71], v[114:117], v[134:137], v[68:71]
    v_pk_fma_f32 v[30:31], v[30:31], s[60:61], v[228:229] op_sel_hi:[1,1,0] neg_lo:[0,0,1] neg_hi:[0,0,1]
    v_pk_fma_f32 v[32:33], v[32:33], s[60:61], v[228:229] op_sel_hi:[1,1,0] neg_lo:[0,0,1] neg_hi:[0,0,1]
    v_exp_f32 v16, v16
    v_exp_f32 v17, v17
    v_mfma_f32_16x16x32_bf16 v[72:75], v[120:123], v[134:137], v[72:75]
    v_exp_f32 v18, v18
    v_exp_f32 v19, v19
    v_exp_f32 v20, v20
    v_exp_f32 v21, v21
    v_mfma_f32_16x16x32_bf16 v[158:161], v[76:79], v[142:145], 0
    v_exp_f32 v22, v22
    v_exp_f32 v23, v23
    v_exp_f32 v24, v24
    v_exp_f32 v25, v25
    v_mfma_f32_16x16x32_bf16 v[162:165], v[80:83], v[142:145], 0
    v_exp_f32 v26, v26
    v_exp_f32 v27, v27
    v_exp_f32 v28, v28
    v_exp_f32 v29, v29
    v_mfma_f32_16x16x32_bf16 v[166:169], v[84:87], v[142:145], 0
    v_exp_f32 v30, v30
    v_exp_f32 v31, v31
    v_exp_f32 v32, v32
    v_exp_f32 v33, v33
    v_mfma_f32_16x16x32_bf16 v[170:173], v[88:91], v[142:145], 0
    v_pk_add_f32 v[228:229], v[16:17], v[18:19]
    v_pk_add_f32 v[218:219], v[20:21], v[22:23]
    v_pk_add_f32 v[228:229], v[228:229], v[24:25]
    v_pk_add_f32 v[218:219], v[218:219], v[26:27]
    v_mfma_f32_16x16x32_bf16 v[174:177], v[92:95], v[142:145], 0
    v_pk_add_f32 v[228:229], v[228:229], v[28:29]
    v_pk_add_f32 v[218:219], v[218:219], v[30:31]
    v_pk_add_f32 v[228:229], v[228:229], v[32:33]
    v_pk_add_f32 v[228:229], v[228:229], v[218:219]
    v_mfma_f32_16x16x32_bf16 v[158:161], v[96:99], v[150:153], v[158:161]
    v_add_f32 v228, v228, v229
    v_rcp_f32 v228, v228
    s_nop 0
    v_pk_mul_f32 v[16:17], v[16:17], v[228:229] op_sel_hi:[1,0]
    v_mfma_f32_16x16x32_bf16 v[162:165], v[102:105], v[150:153], v[162:165]
    v_pk_mul_f32 v[18:19], v[18:19], v[228:229] op_sel_hi:[1,0]
    v_pk_mul_f32 v[20:21], v[20:21], v[228:229] op_sel_hi:[1,0]
    v_pk_mul_f32 v[22:23], v[22:23], v[228:229] op_sel_hi:[1,0]
    v_pk_mul_f32 v[24:25], v[24:25], v[228:229] op_sel_hi:[1,0]
    v_mfma_f32_16x16x32_bf16 v[166:169], v[108:111], v[150:153], v[166:169]
    v_pk_mul_f32 v[26:27], v[26:27], v[228:229] op_sel_hi:[1,0]
    v_pk_mul_f32 v[28:29], v[28:29], v[228:229] op_sel_hi:[1,0]
    v_pk_mul_f32 v[30:31], v[30:31], v[228:229] op_sel_hi:[1,0]
    v_pk_mul_f32 v[32:33], v[32:33], v[228:229] op_sel_hi:[1,0]
    v_mfma_f32_16x16x32_bf16 v[170:173], v[114:117], v[150:153], v[170:173]
    v_cvt_pk_bf16_f32 v218, v16, v17
    v_cvt_pk_bf16_f32 v219, v18, v19
    v_cvt_pk_bf16_f32 v220, v20, v21
    v_cvt_pk_bf16_f32 v221, v22, v23
    v_mfma_f32_16x16x32_bf16 v[174:177], v[120:123], v[150:153], v[174:177]
    v_cvt_pk_bf16_f32 v222, v24, v25
    v_cvt_pk_bf16_f32 v223, v26, v27
    v_cvt_pk_bf16_f32 v224, v28, v29
    v_cvt_pk_bf16_f32 v225, v30, v31
    v_cvt_pk_bf16_f32 v226, v32, v33
    ds_write_b64 v192, v[218:219] offset:0
    ds_write_b64 v192, v[220:221] offset:8
    ds_write_b64 v192, v[222:223] offset:16
    ds_write_b64 v192, v[224:225] offset:24
    ds_write_b64 v193, v[226:227] offset:64
    s_waitcnt lgkmcnt(0)
    s_barrier
    ds_read_b64_tr_b16 v[84:85], v196 offset:0
    ds_read_b64_tr_b16 v[76:77], v194 offset:0
    ds_read_b64_tr_b16 v[80:81], v195 offset:0
    ds_read_b64_tr_b16 v[86:87], v196 offset:960
    ds_read_b64_tr_b16 v[78:79], v194 offset:960
    ds_read_b64_tr_b16 v[82:83], v195 offset:960
    ds_read_b64_tr_b16 v[96:97], v196 offset:15360
    ds_read_b64_tr_b16 v[88:89], v194 offset:15360
    ds_read_b64_tr_b16 v[92:93], v195 offset:15360
    ds_read_b64_tr_b16 v[98:99], v196 offset:16320
    ds_read_b64_tr_b16 v[90:91], v194 offset:16320
    ds_read_b64_tr_b16 v[94:95], v195 offset:16320
    ds_read_b64_tr_b16 v[108:109], v196 offset:30720
    ds_read_b64_tr_b16 v[100:101], v194 offset:30720
    ds_read_b64_tr_b16 v[104:105], v195 offset:30720
    ds_read_b64_tr_b16 v[110:111], v196 offset:31680
    ds_read_b64_tr_b16 v[102:103], v194 offset:31680
    ds_read_b64_tr_b16 v[106:107], v195 offset:31680
    ds_read_b64_tr_b16 v[120:121], v196 offset:46080
    ds_read_b64_tr_b16 v[112:113], v194 offset:46080
    ds_read_b64_tr_b16 v[116:117], v195 offset:46080
    ds_read_b64_tr_b16 v[122:123], v196 offset:47040
    ds_read_b64_tr_b16 v[114:115], v194 offset:47040
    ds_read_b64_tr_b16 v[118:119], v195 offset:47040
    v_cvt_pk_bf16_f32 v36, 0, v36
    v_cvt_pk_bf16_f32 v37, 0, v37
    v_cvt_pk_bf16_f32 v38, 0, v38
    v_cvt_pk_bf16_f32 v39, 0, v39
    v_cvt_pk_bf16_f32 v40, 0, v40
    v_cvt_pk_bf16_f32 v41, 0, v41
    v_cvt_pk_bf16_f32 v42, 0, v42
    v_cvt_pk_bf16_f32 v43, 0, v43
    v_cvt_pk_bf16_f32 v44, 0, v44
    v_cvt_pk_bf16_f32 v45, 0, v45
    v_cvt_pk_bf16_f32 v46, 0, v46
    v_cvt_pk_bf16_f32 v47, 0, v47
    v_cvt_pk_bf16_f32 v48, 0, v48
    v_cvt_pk_bf16_f32 v49, 0, v49
    v_cvt_pk_bf16_f32 v50, 0, v50
    v_cvt_pk_bf16_f32 v51, 0, v51
    v_cvt_pk_bf16_f32 v52, 0, v52
    v_cvt_pk_bf16_f32 v53, 0, v53
    v_max3_f32 v228, v36, v37, v38
    v_max3_f32 v229, v39, v40, v41
    v_max3_f32 v228, v228, v42, v43
    v_max3_f32 v229, v229, v44, v45
    v_max3_f32 v228, v228, v46, v47
    v_max3_f32 v229, v229, v48, v49
    v_max3_f32 v228, v228, v50, v51
    v_max3_f32 v229, v229, v52, v53
    v_max_f32 v228, v228, v229
    v_mul_f32 v228, s60, v228
    v_pk_fma_f32 v[36:37], v[36:37], s[60:61], v[228:229] op_sel_hi:[1,1,0] neg_lo:[0,0,1] neg_hi:[0,0,1]
    v_pk_fma_f32 v[38:39], v[38:39], s[60:61], v[228:229] op_sel_hi:[1,1,0] neg_lo:[0,0,1] neg_hi:[0,0,1]
    v_pk_fma_f32 v[40:41], v[40:41], s[60:61], v[228:229] op_sel_hi:[1,1,0] neg_lo:[0,0,1] neg_hi:[0,0,1]
    v_pk_fma_f32 v[42:43], v[42:43], s[60:61], v[228:229] op_sel_hi:[1,1,0] neg_lo:[0,0,1] neg_hi:[0,0,1]
    v_pk_fma_f32 v[44:45], v[44:45], s[60:61], v[228:229] op_sel_hi:[1,1,0] neg_lo:[0,0,1] neg_hi:[0,0,1]
    v_pk_fma_f32 v[46:47], v[46:47], s[60:61], v[228:229] op_sel_hi:[1,1,0] neg_lo:[0,0,1] neg_hi:[0,0,1]
    v_pk_fma_f32 v[48:49], v[48:49], s[60:61], v[228:229] op_sel_hi:[1,1,0] neg_lo:[0,0,1] neg_hi:[0,0,1]
    v_pk_fma_f32 v[50:51], v[50:51], s[60:61], v[228:229] op_sel_hi:[1,1,0] neg_lo:[0,0,1] neg_hi:[0,0,1]
    v_pk_fma_f32 v[52:53], v[52:53], s[60:61], v[228:229] op_sel_hi:[1,1,0] neg_lo:[0,0,1] neg_hi:[0,0,1]
    s_waitcnt lgkmcnt(0)
    v_exp_f32 v36, v36
    v_mfma_f32_16x16x32_bf16 v[178:181], v[76:79], v[84:87], 0
    v_exp_f32 v37, v37
    v_exp_f32 v38, v38
    v_exp_f32 v39, v39
    v_exp_f32 v40, v40
    v_exp_f32 v41, v41
    v_mfma_f32_16x16x32_bf16 v[182:185], v[80:83], v[84:87], 0
    v_exp_f32 v42, v42
    v_exp_f32 v43, v43
    v_exp_f32 v44, v44
    v_exp_f32 v45, v45
    v_exp_f32 v46, v46
    v_mfma_f32_16x16x32_bf16 v[178:181], v[88:91], v[96:99], v[178:181]
    v_exp_f32 v47, v47
    v_exp_f32 v48, v48
    v_exp_f32 v49, v49
    v_exp_f32 v50, v50
    v_exp_f32 v51, v51
    v_mfma_f32_16x16x32_bf16 v[182:185], v[92:95], v[96:99], v[182:185]
    v_exp_f32 v52, v52
    v_exp_f32 v53, v53
    v_pk_add_f32 v[228:229], v[36:37], v[38:39]
    v_pk_add_f32 v[218:219], v[40:41], v[42:43]
    v_pk_add_f32 v[228:229], v[228:229], v[44:45]
    v_mfma_f32_16x16x32_bf16 v[178:181], v[100:103], v[108:111], v[178:181]
    v_pk_add_f32 v[218:219], v[218:219], v[46:47]
    v_pk_add_f32 v[228:229], v[228:229], v[48:49]
    v_pk_add_f32 v[218:219], v[218:219], v[50:51]
    v_pk_add_f32 v[228:229], v[228:229], v[52:53]
    v_pk_add_f32 v[228:229], v[228:229], v[218:219]
    v_mfma_f32_16x16x32_bf16 v[182:185], v[104:107], v[108:111], v[182:185]
    v_add_f32 v228, v228, v229
    v_rcp_f32 v228, v228
    s_nop 0
    v_pk_mul_f32 v[36:37], v[36:37], v[228:229] op_sel_hi:[1,0]
    v_pk_mul_f32 v[38:39], v[38:39], v[228:229] op_sel_hi:[1,0]
    v_mfma_f32_16x16x32_bf16 v[178:181], v[112:115], v[120:123], v[178:181]
    v_pk_mul_f32 v[40:41], v[40:41], v[228:229] op_sel_hi:[1,0]
    v_pk_mul_f32 v[42:43], v[42:43], v[228:229] op_sel_hi:[1,0]
    v_pk_mul_f32 v[44:45], v[44:45], v[228:229] op_sel_hi:[1,0]
    v_pk_mul_f32 v[46:47], v[46:47], v[228:229] op_sel_hi:[1,0]
    v_pk_mul_f32 v[48:49], v[48:49], v[228:229] op_sel_hi:[1,0]
    v_mfma_f32_16x16x32_bf16 v[182:185], v[116:119], v[120:123], v[182:185]
    v_pk_mul_f32 v[50:51], v[50:51], v[228:229] op_sel_hi:[1,0]
    v_pk_mul_f32 v[52:53], v[52:53], v[228:229] op_sel_hi:[1,0]
    v_cvt_pk_bf16_f32 v218, v36, v37
    v_cvt_pk_bf16_f32 v219, v38, v39
    v_cvt_pk_bf16_f32 v220, v40, v41
    v_cvt_pk_bf16_f32 v221, v42, v43
    v_cvt_pk_bf16_f32 v222, v44, v45
    v_cvt_pk_bf16_f32 v223, v46, v47
    v_cvt_pk_bf16_f32 v224, v48, v49
    v_cvt_pk_bf16_f32 v225, v50, v51
    v_cvt_pk_bf16_f32 v226, v52, v53
    ds_write_b64 v192, v[218:219] offset:3840
    ds_write_b64 v192, v[220:221] offset:3848
    ds_write_b64 v192, v[222:223] offset:3856
    ds_write_b64 v192, v[224:225] offset:3864
    ds_write_b64 v193, v[226:227] offset:3904
    s_waitcnt lgkmcnt(0)
    s_barrier
    ds_read_b64_tr_b16 v[84:85], v196 offset:3840
    ds_read_b64_tr_b16 v[76:77], v194 offset:3840
    ds_read_b64_tr_b16 v[80:81], v195 offset:3840
    ds_read_b64_tr_b16 v[86:87], v196 offset:4800
    ds_read_b64_tr_b16 v[78:79], v194 offset:4800
    ds_read_b64_tr_b16 v[82:83], v195 offset:4800
    ds_read_b64_tr_b16 v[96:97], v196 offset:19200
    ds_read_b64_tr_b16 v[88:89], v194 offset:19200
    ds_read_b64_tr_b16 v[92:93], v195 offset:19200
    ds_read_b64_tr_b16 v[98:99], v196 offset:20160
    ds_read_b64_tr_b16 v[90:91], v194 offset:20160
    ds_read_b64_tr_b16 v[94:95], v195 offset:20160
    ds_read_b64_tr_b16 v[108:109], v196 offset:34560
    ds_read_b64_tr_b16 v[100:101], v194 offset:34560
    ds_read_b64_tr_b16 v[104:105], v195 offset:34560
    ds_read_b64_tr_b16 v[110:111], v196 offset:35520
    ds_read_b64_tr_b16 v[102:103], v194 offset:35520
    ds_read_b64_tr_b16 v[106:107], v195 offset:35520
    ds_read_b64_tr_b16 v[120:121], v196 offset:49920
    ds_read_b64_tr_b16 v[112:113], v194 offset:49920
    ds_read_b64_tr_b16 v[116:117], v195 offset:49920
    ds_read_b64_tr_b16 v[122:123], v196 offset:50880
    ds_read_b64_tr_b16 v[114:115], v194 offset:50880
    ds_read_b64_tr_b16 v[118:119], v195 offset:50880
    s_waitcnt lgkmcnt(15)
    v_mfma_f32_16x16x32_bf16 v[178:181], v[76:79], v[84:87], v[178:181]
    v_mfma_f32_16x16x32_bf16 v[182:185], v[80:83], v[84:87], v[182:185]
    s_waitcnt lgkmcnt(12)
    v_mfma_f32_16x16x32_bf16 v[178:181], v[88:91], v[96:99], v[178:181]
    v_mfma_f32_16x16x32_bf16 v[182:185], v[92:95], v[96:99], v[182:185]
    s_waitcnt lgkmcnt(6)
    v_mfma_f32_16x16x32_bf16 v[178:181], v[100:103], v[108:111], v[178:181]
    v_mfma_f32_16x16x32_bf16 v[182:185], v[104:107], v[108:111], v[182:185]
    s_waitcnt lgkmcnt(0)
    v_mfma_f32_16x16x32_bf16 v[178:181], v[112:115], v[120:123], v[178:181]
    v_mfma_f32_16x16x32_bf16 v[182:185], v[116:119], v[120:123], v[182:185]
    s_mul_i32 s9, s6, 16384
    s_waitcnt vmcnt(0)
    v_readfirstlane_b32 s72, v6
    v_readfirstlane_b32 s73, v7
    s_mov_b32 s11, 0
L_A_np:
    s_cmp_lg_u32 s72, 0
    s_cbranch_scc1 L_A_nd
    v_mov_b32 v8, 64
    buffer_load_dwordx2 v[6:7], v8, s[44:47], 0 offen sc1
    s_waitcnt vmcnt(0)
    v_readfirstlane_b32 s72, v6
    v_readfirstlane_b32 s73, v7
    s_add_u32 s11, s11, 1
    s_cmp_lt_u32 s11, 0x40000
    s_cbranch_scc1 L_A_np
L_A_nd:
    s_mul_i32 s9, s6, 16384
    buffer_store_dwordx4 v[178:181], v230, s[40:43], s9 offen offset:0 sc0 sc1
    buffer_store_dwordx4 v[182:185], v231, s[40:43], s9 offen offset:1024 sc0 sc1
    v_mov_b32 v33, 0
    v_mov_b32 v34, 0
    v_mov_b32 v35, 0
    v_mov_b32 v45, 0
    v_mov_b32 v46, 0
    v_mov_b32 v47, 0
    v_cvt_pk_bf16_f32 v56, 0, v56
    v_cvt_pk_bf16_f32 v57, 0, v57
    v_cvt_pk_bf16_f32 v58, 0, v58
    v_cvt_pk_bf16_f32 v59, 0, v59
    v_cvt_pk_bf16_f32 v60, 0, v60
    v_cvt_pk_bf16_f32 v61, 0, v61
    v_cvt_pk_bf16_f32 v62, 0, v62
    v_cvt_pk_bf16_f32 v63, 0, v63
    v_cvt_pk_bf16_f32 v64, 0, v64
    v_cvt_pk_bf16_f32 v65, 0, v65
    v_cvt_pk_bf16_f32 v66, 0, v66
    v_cvt_pk_bf16_f32 v67, 0, v67
    v_cvt_pk_bf16_f32 v68, 0, v68
    v_cvt_pk_bf16_f32 v69, 0, v69
    v_cvt_pk_bf16_f32 v70, 0, v70
    v_cvt_pk_bf16_f32 v71, 0, v71
    v_cvt_pk_bf16_f32 v72, 0, v72
    v_cvt_pk_bf16_f32 v73, 0, v73
    v_max3_f32 v228, v56, v57, v58
    v_max3_f32 v229, v59, v60, v61
    v_max3_f32 v228, v228, v62, v63
    v_max3_f32 v229, v229, v64, v65
    v_max3_f32 v228, v228, v66, v67
    v_max3_f32 v229, v229, v68, v69
    v_max3_f32 v228, v228, v70, v71
    v_max3_f32 v229, v229, v72, v73
    v_max_f32 v228, v228, v229
    v_mul_f32 v228, s60, v228
    v_pk_fma_f32 v[56:57], v[56:57], s[60:61], v[228:229] op_sel_hi:[1,1,0] neg_lo:[0,0,1] neg_hi:[0,0,1]
    v_pk_fma_f32 v[58:59], v[58:59], s[60:61], v[228:229] op_sel_hi:[1,1,0] neg_lo:[0,0,1] neg_hi:[0,0,1]
    v_pk_fma_f32 v[60:61], v[60:61], s[60:61], v[228:229] op_sel_hi:[1,1,0] neg_lo:[0,0,1] neg_hi:[0,0,1]
    v_pk_fma_f32 v[62:63], v[62:63], s[60:61], v[228:229] op_sel_hi:[1,1,0] neg_lo:[0,0,1] neg_hi:[0,0,1]
    v_pk_fma_f32 v[64:65], v[64:65], s[60:61], v[228:229] op_sel_hi:[1,1,0] neg_lo:[0,0,1] neg_hi:[0,0,1]
    v_pk_fma_f32 v[66:67], v[66:67], s[60:61], v[228:229] op_sel_hi:[1,1,0] neg_lo:[0,0,1] neg_hi:[0,0,1]
    v_pk_fma_f32 v[68:69], v[68:69], s[60:61], v[228:229] op_sel_hi:[1,1,0] neg_lo:[0,0,1] neg_hi:[0,0,1]
    v_pk_fma_f32 v[70:71], v[70:71], s[60:61], v[228:229] op_sel_hi:[1,1,0] neg_lo:[0,0,1] neg_hi:[0,0,1]
    v_pk_fma_f32 v[72:73], v[72:73], s[60:61], v[228:229] op_sel_hi:[1,1,0] neg_lo:[0,0,1] neg_hi:[0,0,1]
    v_exp_f32 v56, v56
    v_exp_f32 v57, v57
    v_exp_f32 v58, v58
    v_exp_f32 v59, v59
    v_exp_f32 v60, v60
    v_exp_f32 v61, v61
    v_exp_f32 v62, v62
    v_exp_f32 v63, v63
    v_exp_f32 v64, v64
    v_exp_f32 v65, v65
    v_exp_f32 v66, v66
    v_exp_f32 v67, v67
    v_exp_f32 v68, v68
    v_exp_f32 v69, v69
    v_exp_f32 v70, v70
    v_exp_f32 v71, v71
    v_exp_f32 v72, v72
    v_exp_f32 v73, v73
    v_pk_add_f32 v[228:229], v[56:57], v[58:59]
    v_pk_add_f32 v[24:25], v[60:61], v[62:63]
    v_pk_add_f32 v[228:229], v[228:229], v[64:65]
    v_pk_add_f32 v[24:25], v[24:25], v[66:67]
    v_pk_add_f32 v[228:229], v[228:229], v[68:69]
    v_pk_add_f32 v[24:25], v[24:25], v[70:71]
    v_pk_add_f32 v[228:229], v[228:229], v[72:73]
    v_pk_add_f32 v[228:229], v[228:229], v[24:25]
    v_add_f32 v228, v228, v229
    v_rcp_f32 v228, v228
    s_nop 0
    v_pk_mul_f32 v[56:57], v[56:57], v[228:229] op_sel_hi:[1,0]
    v_pk_mul_f32 v[58:59], v[58:59], v[228:229] op_sel_hi:[1,0]
    v_pk_mul_f32 v[60:61], v[60:61], v[228:229] op_sel_hi:[1,0]
    v_pk_mul_f32 v[62:63], v[62:63], v[228:229] op_sel_hi:[1,0]
    v_pk_mul_f32 v[64:65], v[64:65], v[228:229] op_sel_hi:[1,0]
    v_pk_mul_f32 v[66:67], v[66:67], v[228:229] op_sel_hi:[1,0]
    v_pk_mul_f32 v[68:69], v[68:69], v[228:229] op_sel_hi:[1,0]
    v_pk_mul_f32 v[70:71], v[70:71], v[228:229] op_sel_hi:[1,0]
    v_pk_mul_f32 v[72:73], v[72:73], v[228:229] op_sel_hi:[1,0]
    v_cvt_pk_bf16_f32 v24, v56, v57
    v_cvt_pk_bf16_f32 v25, v58, v59
    v_cvt_pk_bf16_f32 v26, v60, v61
    v_cvt_pk_bf16_f32 v27, v62, v63
    v_cvt_pk_bf16_f32 v28, v64, v65
    v_cvt_pk_bf16_f32 v29, v66, v67
    v_cvt_pk_bf16_f32 v30, v68, v69
    v_cvt_pk_bf16_f32 v31, v70, v71
    v_cvt_pk_bf16_f32 v32, v72, v73
    s_waitcnt vmcnt(0)
    s_lshl_b32 s9, s5, 3
    s_add_u32 s9, s9, s6
    s_lshl_b32 s9, s9, 4
    s_add_u32 s9, s9, s7
    s_lshl_b32 s9, s9, 3
    s_add_u32 s9, s9, s8
    s_lshl_b32 s9, s9, 8
    v_mov_b32 v210, s9
    s_mov_b64 exec, 1
    buffer_store_dwordx2 v[6:7], v210, s[76:79], 0 offen offset:0 sc0 sc1
    s_mov_b64 exec, -1
    s_cmp_eq_u32 s5, 0
    s_cselect_b64 s[22:23], s[22:23], s[56:57]
    s_mov_b32 s24, s22
    s_mov_b32 s25, s23
    s_mov_b32 s26, 663552
    s_mov_b32 s27, 0x00020000
    s_mov_b32 s28, s16
    s_mov_b32 s29, s17
    s_mov_b32 s30, 4718592
    s_mov_b32 s31, 0x00020000
    s_lshl_b32 s51, s8, 10
    s_mov_b32 s49, s65
    s_mov_b32 s48, 0
    s_add_u32 m0, s51, 81920
    s_nop 0
    buffer_load_dwordx4 v232, s[24:27], s48 offen lds
    s_mov_b32 s48, 0
    s_add_u32 m0, s51, 90112
    s_nop 0
    buffer_load_dwordx4 v233, s[24:27], s48 offen lds
    s_cmp_ge_u32 s8, 3
    s_cbranch_scc1 L_Ap_nd0
    s_mov_b32 s48, 0
    s_add_u32 m0, s51, 98304
    s_nop 0
    buffer_load_dwordx4 v234, s[24:27], s48 offen lds
L_Ap_nd0:
    s_mov_b32 s48, 82944
    s_add_u32 m0, s51, 101376
    s_nop 0
    buffer_load_dwordx4 v232, s[24:27], s48 offen lds
    s_mov_b32 s48, 82944
    s_add_u32 m0, s51, 109568
    s_nop 0
    buffer_load_dwordx4 v233, s[24:27], s48 offen lds
    s_cmp_ge_u32 s8, 3
    s_cbranch_scc1 L_Ap_nd1
    s_mov_b32 s48, 82944
    s_add_u32 m0, s51, 117760
    s_nop 0
    buffer_load_dwordx4 v234, s[24:27], s48 offen lds
L_Ap_nd1:
    s_mov_b32 s48, 165888
    s_add_u32 m0, s51, 120832
    s_nop 0
    buffer_load_dwordx4 v232, s[24:27], s48 offen lds
    s_mov_b32 s48, 165888
    s_add_u32 m0, s51, 129024
    s_nop 0
    buffer_load_dwordx4 v233, s[24:27], s48 offen lds
    s_cmp_ge_u32 s8, 3
    s_cbranch_scc1 L_Ap_nd2
    s_mov_b32 s48, 165888
    s_add_u32 m0, s51, 137216
    s_nop 0
    buffer_load_dwordx4 v234, s[24:27], s48 offen lds
L_Ap_nd2:
    s_mov_b32 s48, 248832
    s_add_u32 m0, s51, 140288
    s_nop 0
    buffer_load_dwordx4 v232, s[24:27], s48 offen lds
    s_mov_b32 s48, 248832
    s_add_u32 m0, s51, 148480
    s_nop 0
    buffer_load_dwordx4 v233, s[24:27], s48 offen lds
    s_cmp_ge_u32 s8, 3
    s_cbranch_scc1 L_Ap_nd3
    s_mov_b32 s48, 248832
    s_add_u32 m0, s51, 156672
    s_nop 0
    buffer_load_dwordx4 v234, s[24:27], s48 offen lds
L_Ap_nd3:
    v_cvt_pk_bf16_f32 v158, 0, v158
    v_cvt_pk_bf16_f32 v159, 0, v159
    v_cvt_pk_bf16_f32 v160, 0, v160
    v_cvt_pk_bf16_f32 v161, 0, v161
    v_cvt_pk_bf16_f32 v162, 0, v162
    v_cvt_pk_bf16_f32 v163, 0, v163
    v_cvt_pk_bf16_f32 v164, 0, v164
    v_cvt_pk_bf16_f32 v165, 0, v165
    v_cvt_pk_bf16_f32 v166, 0, v166
    v_cvt_pk_bf16_f32 v167, 0, v167
    v_cvt_pk_bf16_f32 v168, 0, v168
    v_cvt_pk_bf16_f32 v169, 0, v169
    v_cvt_pk_bf16_f32 v170, 0, v170
    v_cvt_pk_bf16_f32 v171, 0, v171
    v_cvt_pk_bf16_f32 v172, 0, v172
    v_cvt_pk_bf16_f32 v173, 0, v173
    v_cvt_pk_bf16_f32 v174, 0, v174
    v_cvt_pk_bf16_f32 v175, 0, v175
    v_max3_f32 v228, v158, v159, v160
    v_max3_f32 v229, v161, v162, v163
    v_max3_f32 v228, v228, v164, v165
    v_max3_f32 v229, v229, v166, v167
    v_max3_f32 v228, v228, v168, v169
    v_max3_f32 v229, v229, v170, v171
    v_max3_f32 v228, v228, v172, v173
    v_max3_f32 v229, v229, v174, v175
    v_max_f32 v228, v228, v229
    v_mul_f32 v228, s60, v228
    v_pk_fma_f32 v[158:159], v[158:159], s[60:61], v[228:229] op_sel_hi:[1,1,0] neg_lo:[0,0,1] neg_hi:[0,0,1]
    v_pk_fma_f32 v[160:161], v[160:161], s[60:61], v[228:229] op_sel_hi:[1,1,0] neg_lo:[0,0,1] neg_hi:[0,0,1]
    v_pk_fma_f32 v[162:163], v[162:163], s[60:61], v[228:229] op_sel_hi:[1,1,0] neg_lo:[0,0,1] neg_hi:[0,0,1]
    v_pk_fma_f32 v[164:165], v[164:165], s[60:61], v[228:229] op_sel_hi:[1,1,0] neg_lo:[0,0,1] neg_hi:[0,0,1]
    v_pk_fma_f32 v[166:167], v[166:167], s[60:61], v[228:229] op_sel_hi:[1,1,0] neg_lo:[0,0,1] neg_hi:[0,0,1]
    v_pk_fma_f32 v[168:169], v[168:169], s[60:61], v[228:229] op_sel_hi:[1,1,0] neg_lo:[0,0,1] neg_hi:[0,0,1]
    v_pk_fma_f32 v[170:171], v[170:171], s[60:61], v[228:229] op_sel_hi:[1,1,0] neg_lo:[0,0,1] neg_hi:[0,0,1]
    v_pk_fma_f32 v[172:173], v[172:173], s[60:61], v[228:229] op_sel_hi:[1,1,0] neg_lo:[0,0,1] neg_hi:[0,0,1]
    v_pk_fma_f32 v[174:175], v[174:175], s[60:61], v[228:229] op_sel_hi:[1,1,0] neg_lo:[0,0,1] neg_hi:[0,0,1]
    v_exp_f32 v158, v158
    v_exp_f32 v159, v159
    v_exp_f32 v160, v160
    v_exp_f32 v161, v161
    v_exp_f32 v162, v162
    v_exp_f32 v163, v163
    v_exp_f32 v164, v164
    v_exp_f32 v165, v165
    v_exp_f32 v166, v166
    v_exp_f32 v167, v167
    v_exp_f32 v168, v168
    v_exp_f32 v169, v169
    v_exp_f32 v170, v170
    v_exp_f32 v171, v171
    v_exp_f32 v172, v172
    v_exp_f32 v173, v173
    v_exp_f32 v174, v174
    v_exp_f32 v175, v175
    v_pk_add_f32 v[228:229], v[158:159], v[160:161]
    v_pk_add_f32 v[36:37], v[162:163], v[164:165]
    v_pk_add_f32 v[228:229], v[228:229], v[166:167]
    v_pk_add_f32 v[36:37], v[36:37], v[168:169]
    v_pk_add_f32 v[228:229], v[228:229], v[170:171]
    v_pk_add_f32 v[36:37], v[36:37], v[172:173]
    v_pk_add_f32 v[228:229], v[228:229], v[174:175]
    v_pk_add_f32 v[228:229], v[228:229], v[36:37]
    v_add_f32 v228, v228, v229
    v_rcp_f32 v228, v228
    s_nop 0
    v_pk_mul_f32 v[158:159], v[158:159], v[228:229] op_sel_hi:[1,0]
    v_pk_mul_f32 v[160:161], v[160:161], v[228:229] op_sel_hi:[1,0]
    v_pk_mul_f32 v[162:163], v[162:163], v[228:229] op_sel_hi:[1,0]
    v_pk_mul_f32 v[164:165], v[164:165], v[228:229] op_sel_hi:[1,0]
    v_pk_mul_f32 v[166:167], v[166:167], v[228:229] op_sel_hi:[1,0]
    v_pk_mul_f32 v[168:169], v[168:169], v[228:229] op_sel_hi:[1,0]
    v_pk_mul_f32 v[170:171], v[170:171], v[228:229] op_sel_hi:[1,0]
    v_pk_mul_f32 v[172:173], v[172:173], v[228:229] op_sel_hi:[1,0]
    v_pk_mul_f32 v[174:175], v[174:175], v[228:229] op_sel_hi:[1,0]
    v_cvt_pk_bf16_f32 v36, v158, v159
    v_cvt_pk_bf16_f32 v37, v160, v161
    v_cvt_pk_bf16_f32 v38, v162, v163
    v_cvt_pk_bf16_f32 v39, v164, v165
    v_cvt_pk_bf16_f32 v40, v166, v167
    v_cvt_pk_bf16_f32 v41, v168, v169
    v_cvt_pk_bf16_f32 v42, v170, v171
    v_cvt_pk_bf16_f32 v43, v172, v173
    v_cvt_pk_bf16_f32 v44, v174, v175
    s_barrier
    v_mov_b32 v210, 0
    v_mov_b32 v211, 0
    v_lshlrev_b32 v212, 3, v1
    ds_write_b64 v212, v[210:211] offset:3840
    ds_write_b64 v212, v[210:211] offset:3960
    v_and_b32 v214, 7, v1
    v_lshlrev_b32 v214, 4, v214
    v_add_u32 v214, s7, v214
    v_lshlrev_b32 v214, 3, v214
    v_add_u32 v214, s8, v214
    v_lshlrev_b32 v214, 8, v214
    s_mov_b32 s11, 0
L_A1_fp:
    buffer_load_dwordx2 v[216:217], v214, s[76:79], 0 offen offset:0 sc1
    s_waitcnt vmcnt(0)
    v_cmp_ne_u64 vcc, s[72:73], v[216:217]
    s_add_u32 s11, s11, 1
    s_cmp_eq_u64 vcc, 0
    s_cbranch_scc1 L_A1_fw
    s_cmp_lt_u32 s11, 0x40000
    s_cbranch_scc1 L_A1_fp
L_A1_fw:
    s_mov_b32 s9, 0
    buffer_load_dwordx4 v[76:79], v230, s[40:43], s9 offen sc1
    s_mov_b32 s9, 16384
    buffer_load_dwordx4 v[84:87], v230, s[40:43], s9 offen sc1
    s_mov_b32 s9, 32768
    buffer_load_dwordx4 v[92:95], v230, s[40:43], s9 offen sc1
    s_mov_b32 s9, 49152
    buffer_load_dwordx4 v[100:103], v230, s[40:43], s9 offen sc1
    s_mov_b32 s9, 65536
    buffer_load_dwordx4 v[108:111], v230, s[40:43], s9 offen sc1
    s_mov_b32 s9, 81920
    buffer_load_dwordx4 v[116:119], v230, s[40:43], s9 offen sc1
    s_mov_b32 s9, 98304
    buffer_load_dwordx4 v[124:127], v230, s[40:43], s9 offen sc1
    s_mov_b32 s9, 114688
    buffer_load_dwordx4 v[132:135], v230, s[40:43], s9 offen sc1
    s_cmp_ge_u32 s8, 5
    s_cbranch_scc1 L_A_pl1
    s_mov_b32 s9, 0
    buffer_load_dwordx4 v[80:83], v231, s[40:43], s9 offen offset:1024 sc1
    s_mov_b32 s9, 16384
    buffer_load_dwordx4 v[88:91], v231, s[40:43], s9 offen offset:1024 sc1
    s_mov_b32 s9, 32768
    buffer_load_dwordx4 v[96:99], v231, s[40:43], s9 offen offset:1024 sc1
    s_mov_b32 s9, 49152
    buffer_load_dwordx4 v[104:107], v231, s[40:43], s9 offen offset:1024 sc1
    s_mov_b32 s9, 65536
    buffer_load_dwordx4 v[112:115], v231, s[40:43], s9 offen offset:1024 sc1
    s_mov_b32 s9, 81920
    buffer_load_dwordx4 v[120:123], v231, s[40:43], s9 offen offset:1024 sc1
    s_mov_b32 s9, 98304
    buffer_load_dwordx4 v[128:131], v231, s[40:43], s9 offen offset:1024 sc1
    s_mov_b32 s9, 114688
    buffer_load_dwordx4 v[136:139], v231, s[40:43], s9 offen offset:1024 sc1
L_A_pl1:
    s_waitcnt vmcnt(0)
    v_pk_add_f32 v[76:77], v[76:77], v[84:85]
    v_pk_add_f32 v[78:79], v[78:79], v[86:87]
    v_pk_add_f32 v[80:81], v[80:81], v[88:89]
    v_pk_add_f32 v[82:83], v[82:83], v[90:91]
    v_pk_add_f32 v[76:77], v[76:77], v[92:93]
    v_pk_add_f32 v[78:79], v[78:79], v[94:95]
    v_pk_add_f32 v[80:81], v[80:81], v[96:97]
    v_pk_add_f32 v[82:83], v[82:83], v[98:99]
    v_pk_add_f32 v[76:77], v[76:77], v[100:101]
    v_pk_add_f32 v[78:79], v[78:79], v[102:103]
    v_pk_add_f32 v[80:81], v[80:81], v[104:105]
    v_pk_add_f32 v[82:83], v[82:83], v[106:107]
    v_pk_add_f32 v[76:77], v[76:77], v[108:109]
    v_pk_add_f32 v[78:79], v[78:79], v[110:111]
    v_pk_add_f32 v[80:81], v[80:81], v[112:113]
    v_pk_add_f32 v[82:83], v[82:83], v[114:115]
    v_pk_add_f32 v[76:77], v[76:77], v[116:117]
    v_pk_add_f32 v[78:79], v[78:79], v[118:119]
    v_pk_add_f32 v[80:81], v[80:81], v[120:121]
    v_pk_add_f32 v[82:83], v[82:83], v[122:123]
    v_pk_add_f32 v[76:77], v[76:77], v[124:125]
    v_pk_add_f32 v[78:79], v[78:79], v[126:127]
    v_pk_add_f32 v[80:81], v[80:81], v[128:129]
    v_pk_add_f32 v[82:83], v[82:83], v[130:131]
    v_pk_add_f32 v[76:77], v[76:77], v[132:133]
    v_pk_add_f32 v[78:79], v[78:79], v[134:135]
    v_pk_add_f32 v[80:81], v[80:81], v[136:137]
    v_pk_add_f32 v[82:83], v[82:83], v[138:139]
    v_cvt_pk_bf16_f32 v76, v76, 0
    v_cvt_pk_bf16_f32 v77, v77, 0
    v_cvt_pk_bf16_f32 v78, v78, 0
    v_cvt_pk_bf16_f32 v79, v79, 0
    v_cvt_pk_bf16_f32 v80, v80, 0
    v_cvt_pk_bf16_f32 v81, v81, 0
    v_cvt_pk_bf16_f32 v82, v82, 0
    v_cvt_pk_bf16_f32 v83, v83, 0
    ds_write_b16 v197, v76 offset:0
    ds_write_b16 v198, v77 offset:0
    ds_write_b16 v199, v78 offset:0
    ds_write_b16 v200, v79 offset:0
    ds_write_b16 v201, v80 offset:0
    ds_write_b16 v202, v81 offset:0
    ds_write_b16 v203, v82 offset:0
    ds_write_b16 v204, v83 offset:0
    ds_write_b16 v205, v80 offset:0
    s_waitcnt lgkmcnt(0)
    s_barrier
    ds_read_b64_tr_b16 v[76:77], v206 offset:0
    ds_read_b64_tr_b16 v[78:79], v206 offset:192
    ds_read_b64_tr_b16 v[80:81], v206 offset:384
    ds_read_b64_tr_b16 v[82:83], v206 offset:576
    ds_read_b64_tr_b16 v[84:85], v207 offset:0
    v_mov_b32 v86, 0
    v_mov_b32 v87, 0
    ds_read_b64_tr_b16 v[88:89], v206 offset:8
    ds_read_b64_tr_b16 v[90:91], v206 offset:200
    ds_read_b64_tr_b16 v[92:93], v206 offset:392
    ds_read_b64_tr_b16 v[94:95], v206 offset:584
    ds_read_b64_tr_b16 v[96:97], v207 offset:8
    v_mov_b32 v98, 0
    v_mov_b32 v99, 0
    ds_read_b64_tr_b16 v[100:101], v206 offset:16
    ds_read_b64_tr_b16 v[102:103], v206 offset:208
    ds_read_b64_tr_b16 v[104:105], v206 offset:400
    ds_read_b64_tr_b16 v[106:107], v206 offset:592
    ds_read_b64_tr_b16 v[108:109], v207 offset:16
    v_mov_b32 v110, 0
    v_mov_b32 v111, 0
    s_waitcnt lgkmcnt(0)
    v_mfma_f32_16x16x32_bf16 v[112:115], v[76:79], v[24:27], 0
    v_mfma_f32_16x16x32_bf16 v[116:119], v[88:91], v[24:27], 0
    v_mfma_f32_16x16x32_bf16 v[120:123], v[100:103], v[24:27], 0
    v_mfma_f32_16x16x32_bf16 v[112:115], v[80:83], v[28:31], v[112:115]
    v_mfma_f32_16x16x32_bf16 v[116:119], v[92:95], v[28:31], v[116:119]
    v_mfma_f32_16x16x32_bf16 v[120:123], v[104:107], v[28:31], v[120:123]
    v_mfma_f32_16x16x32_bf16 v[112:115], v[84:87], v[32:35], v[112:115]
    v_mfma_f32_16x16x32_bf16 v[116:119], v[96:99], v[32:35], v[116:119]
    v_mfma_f32_16x16x32_bf16 v[120:123], v[108:111], v[32:35], v[120:123]
    v_mfma_f32_16x16x32_bf16 v[124:127], v[76:79], v[36:39], 0
    v_mfma_f32_16x16x32_bf16 v[128:131], v[88:91], v[36:39], 0
    v_mfma_f32_16x16x32_bf16 v[132:135], v[100:103], v[36:39], 0
    v_mfma_f32_16x16x32_bf16 v[124:127], v[80:83], v[40:43], v[124:127]
    v_mfma_f32_16x16x32_bf16 v[128:131], v[92:95], v[40:43], v[128:131]
    v_mfma_f32_16x16x32_bf16 v[132:135], v[104:107], v[40:43], v[132:135]
    v_mfma_f32_16x16x32_bf16 v[124:127], v[84:87], v[44:47], v[124:127]
    v_mfma_f32_16x16x32_bf16 v[128:131], v[96:99], v[44:47], v[128:131]
    v_mfma_f32_16x16x32_bf16 v[132:135], v[108:111], v[44:47], v[132:135]
    s_nop 7
    v_cvt_pk_bf16_f32 v228, 0, v122
    v_add_f32 v228, 897988541, v228
    v_cvt_pk_bf16_f32 v228, 0, v228
    v_rcp_f32 v228, v228
    v_cvt_pk_bf16_f32 v112, 0, v112
    v_cvt_pk_bf16_f32 v113, 0, v113
    v_cvt_pk_bf16_f32 v114, 0, v114
    v_cvt_pk_bf16_f32 v115, 0, v115
    v_cvt_pk_bf16_f32 v116, 0, v116
    v_cvt_pk_bf16_f32 v117, 0, v117
    v_cvt_pk_bf16_f32 v118, 0, v118
    v_cvt_pk_bf16_f32 v119, 0, v119
    v_cvt_pk_bf16_f32 v120, 0, v120
    v_cvt_pk_bf16_f32 v121, 0, v121
    v_pk_mul_f32 v[112:113], v[112:113], v[228:229] op_sel_hi:[1,0]
    v_pk_mul_f32 v[114:115], v[114:115], v[228:229] op_sel_hi:[1,0]
    v_pk_mul_f32 v[116:117], v[116:117], v[228:229] op_sel_hi:[1,0]
    v_pk_mul_f32 v[118:119], v[118:119], v[228:229] op_sel_hi:[1,0]
    v_pk_mul_f32 v[120:121], v[120:121], v[228:229] op_sel_hi:[1,0]
    v_cvt_pk_bf16_f32 v218, v112, v113
    v_cvt_pk_bf16_f32 v219, v114, v115
    v_cvt_pk_bf16_f32 v220, v116, v117
    v_cvt_pk_bf16_f32 v221, v118, v119
    v_cvt_pk_bf16_f32 v222, v120, v121
    ds_write_b32 v208, v218 offset:0
    ds_write_b32 v208, v219 offset:4
    ds_write_b32 v208, v220 offset:8
    ds_write_b32 v208, v221 offset:12
    s_mov_b32 exec_hi, 0
    ds_write_b32 v208, v222 offset:16
    s_mov_b32 exec_hi, -1
    v_cvt_pk_bf16_f32 v228, 0, v134
    v_add_f32 v228, 897988541, v228
    v_cvt_pk_bf16_f32 v228, 0, v228
    v_rcp_f32 v228, v228
    v_cvt_pk_bf16_f32 v124, 0, v124
    v_cvt_pk_bf16_f32 v125, 0, v125
    v_cvt_pk_bf16_f32 v126, 0, v126
    v_cvt_pk_bf16_f32 v127, 0, v127
    v_cvt_pk_bf16_f32 v128, 0, v128
    v_cvt_pk_bf16_f32 v129, 0, v129
    v_cvt_pk_bf16_f32 v130, 0, v130
    v_cvt_pk_bf16_f32 v131, 0, v131
    v_cvt_pk_bf16_f32 v132, 0, v132
    v_cvt_pk_bf16_f32 v133, 0, v133
    v_pk_mul_f32 v[124:125], v[124:125], v[228:229] op_sel_hi:[1,0]
    v_pk_mul_f32 v[126:127], v[126:127], v[228:229] op_sel_hi:[1,0]
    v_pk_mul_f32 v[128:129], v[128:129], v[228:229] op_sel_hi:[1,0]
    v_pk_mul_f32 v[130:131], v[130:131], v[228:229] op_sel_hi:[1,0]
    v_pk_mul_f32 v[132:133], v[132:133], v[228:229] op_sel_hi:[1,0]
    v_cvt_pk_bf16_f32 v218, v124, v125
    v_cvt_pk_bf16_f32 v219, v126, v127
    v_cvt_pk_bf16_f32 v220, v128, v129
    v_cvt_pk_bf16_f32 v221, v130, v131
    v_cvt_pk_bf16_f32 v222, v132, v133
    ds_write_b32 v208, v218 offset:1280
    ds_write_b32 v208, v219 offset:1284
    ds_write_b32 v208, v220 offset:1288
    ds_write_b32 v208, v221 offset:1292
    s_mov_b32 exec_hi, 0
    ds_write_b32 v208, v222 offset:1296
    s_mov_b32 exec_hi, -1
    s_mul_i32 s9, s8, 2560
    v_lshlrev_b32 v9, 4, v1
    v_add_u32 v9, s9, v9
    v_add_u32 v8, 61440, v9
    s_lshl_b32 s9, s5, 3
    s_add_u32 s9, s9, s6
    s_lshl_b32 s9, s9, 4
    s_add_u32 s9, s9, s7
    s_mul_i32 s9, s9, 20480
    s_waitcnt lgkmcnt(0)
    ds_read_b128 v[76:79], v8 offset:0
    ds_read_b128 v[80:83], v8 offset:1024
    ds_read_b128 v[84:87], v8 offset:2048
    s_waitcnt lgkmcnt(1)
    buffer_store_dwordx4 v[76:79], v9, s[36:39], s9 offen offset:0 sc0 sc1
    buffer_store_dwordx4 v[80:83], v9, s[36:39], s9 offen offset:1024 sc0 sc1
    s_waitcnt lgkmcnt(0)
    s_mov_b32 exec_hi, 0
    buffer_store_dwordx4 v[84:87], v9, s[36:39], s9 offen offset:2048 sc0 sc1
    s_mov_b32 exec_hi, -1
    s_branch L_phase2
L_B:
    s_cmp_lt_u32 s8, 5
    s_cbranch_scc1 L_Bh
    s_add_u32 s48, s60, 0
    s_add_u32 m0, s51, 0
    s_nop 0
    buffer_load_dwordx4 v5, s[28:31], s48 offen lds
    s_add_u32 s48, s60, 13824
    s_add_u32 m0, s51, 960
    s_nop 0
    buffer_load_dwordx4 v5, s[28:31], s48 offen lds
    s_add_u32 s48, s61, 0
    s_add_u32 m0, s58, 15424
    s_nop 0
    buffer_load_dwordx4 v2, s[24:27], s48 offen lds
    s_add_u32 s48, s61, 9216
    s_add_u32 m0, s58, 16448
    s_nop 0
    buffer_load_dwordx4 v2, s[24:27], s48 offen lds
    s_add_u32 s48, s61, 18432
    s_add_u32 m0, s58, 17472
    s_nop 0
    buffer_load_dwordx4 v2, s[24:27], s48 offen lds
    s_add_u32 s48, s61, 27648
    s_add_u32 m0, s58, 18496
    s_nop 0
    buffer_load_dwordx4 v2, s[24:27], s48 offen lds
    s_mov_b64 s[56:57], s[68:69]
    s_mov_b64 s[16:17], s[70:71]
    s_mov_b32 s44, s52
    s_mov_b32 s45, s53
    s_mov_b32 s46, 256
    s_mov_b32 s47, 0x00020000
    s_mov_b32 s36, s54
    s_mov_b32 s37, s55
    s_mov_b32 s38, 5242880
    s_mov_b32 s39, 0x00020000
    s_add_u32 s76, s54, 7340032
    s_addc_u32 s77, s55, 0
    s_mov_b32 s78, 524288
    s_mov_b32 s79, 0x00020000
    v_lshl_add_u32 v16, v11, 3, v12
    v_mul_u32_u24 v16, 240, v16
    v_lshrrev_b32 v17, 1, v13
    v_lshl_add_u32 v17, v17, 6, v16
    v_and_b32 v18, 1, v13
    v_lshl_add_u32 v164, v18, 3, v17
    v_lshlrev_b32 v17, 3, v13
    v_add_u32 v17, 168, v17
    v_cmp_lt_u32 vcc, 1, v13
    v_mov_b32 v18, 232
    s_nop 0
    v_cndmask_b32 v17, v17, v18, vcc
    v_add_u32 v165, v16, v17
    s_and_b32 s9, s8, 1
    s_lshl_b32 s9, s9, 4
    s_and_b32 s11, s8, 2
    s_mul_i32 s11, s11, 48
    s_add_u32 s9, s9, s11
    s_add_u32 s9, s9, 32
    v_add_u32 v166, s9, v164
    s_cmp_eq_u32 s8, 4
    s_cselect_b64 vcc, -1, 0
    v_cndmask_b32 v166, v166, v165, vcc
    v_and_b32 v16, 7, v10
    v_xor_b32 v16, v16, v11
    v_lshlrev_b32 v16, 4, v16
    v_lshl_add_u32 v16, v10, 7, v16
    v_add_u32 v169, 15424, v16
    v_xor_b32 v17, 64, v16
    v_add_u32 v170, 15424, v17
    v_add_u32 v167, s58, v169
    v_add_u32 v168, s58, v170
    v_add_u32 v172, 50240, v164
    v_add_u32 v173, 50240, v165
    v_add_u32 v174, 50240, v166
    v_add_u32 v175, 50240, v167
    v_add_u32 v176, 50240, v168
    v_add_u32 v177, 50240, v169
    v_add_u32 v178, 50240, v170
    v_add_u32 v180, 100480, v164
    v_add_u32 v181, 100480, v165
    v_add_u32 v182, 100480, v166
    v_add_u32 v183, 100480, v167
    v_add_u32 v184, 100480, v168
    v_add_u32 v185, 100480, v169
    v_add_u32 v186, 100480, v170
    s_add_u32 s61, s61, 128
    s_add_u32 s60, s60, 221184
    s_cmp_eq_u32 s61, 1152
    s_cselect_b32 s61, 0, s61
    s_cselect_b32 s60, s50, s60
    s_add_u32 s48, s60, 0
    s_add_u32 m0, s51, 50240
    s_nop 0
    buffer_load_dwordx4 v5, s[28:31], s48 offen lds
    s_add_u32 s48, s60, 13824
    s_add_u32 m0, s51, 51200
    s_nop 0
    buffer_load_dwordx4 v5, s[28:31], s48 offen lds
    s_add_u32 s48, s61, 0
    s_add_u32 m0, s58, 65664
    s_nop 0
    buffer_load_dwordx4 v2, s[24:27], s48 offen lds
    s_add_u32 s48, s61, 9216
    s_add_u32 m0, s58, 66688
    s_nop 0
    buffer_load_dwordx4 v2, s[24:27], s48 offen lds
    s_add_u32 s48, s61, 18432
    s_add_u32 m0, s58, 67712
    s_nop 0
    buffer_load_dwordx4 v2, s[24:27], s48 offen lds
    s_add_u32 s48, s61, 27648
    s_add_u32 m0, s58, 68736
    s_nop 0
    buffer_load_dwordx4 v2, s[24:27], s48 offen lds
    s_lshl_b32 s9, s4, 3
    s_add_u32 s9, s9, s8
    s_bfe_u32 s10, s3, 0x10001
    s_lshl_b32 s10, s10, 8
    s_add_u32 s10, s10, s9
    s_mul_i32 s10, s10, 4608
    v_mov_b32 v19, 0x80000000
    v_mul_u32_u24 v16, 1152, v1
    v_cmp_lt_u32 vcc, 3, v1
    v_add_u32 v16, s10, v16
    s_mul_i32 s10, s9, 9
    v_cndmask_b32 v226, v16, v19, vcc
    s_lshr_b32 s10, s10, 1
    v_add_u32 v16, s10, v1
    v_mul_u32_u24 v17, 3641, v16
    v_lshrrev_b32 v17, 16, v17
    v_mul_u32_u24 v18, 18, v17
    v_sub_u32 v18, v16, v18
    v_mul_u32_u24 v16, 11, v18
    v_lshrrev_b32 v16, 6, v16
    v_mul_u32_u24 v20, 6, v16
    v_sub_u32 v18, v18, v20
    v_lshlrev_b32 v18, 7, v18
    v_min_u32 v18, 572, v18
    v_mul_u32_u24 v16, 1152, v16
    v_mul_u32_u24 v17, 3456, v17
    v_add3_u32 v18, v18, v16, v17
    s_and_b32 s10, s3, 1
    s_mul_i32 s10, s10, 576
    v_cmp_lt_u32 vcc, 4, v1
    v_add_u32 v18, s10, v18
    s_mul_i32 s10, s9, 21
    v_cndmask_b32 v227, v18, v19, vcc
    v_add_u32 v16, s10, v1
    v_cmp_lt_u32 vcc, 20, v1
    v_lshlrev_b32 v16, 7, v16
    s_cmp_eq_u32 s5, 0
    s_cselect_b64 s[72:73], s[22:23], s[56:57]
    v_cndmask_b32 v228, v16, v19, vcc
    s_mov_b32 s74, 663552
    s_mov_b32 s75, 0x00020000
    s_waitcnt vmcnt(6)
    s_barrier
    ds_read_b128 v[140:143], v167 offset:0
    ds_read_b128 v[144:147], v167 offset:2048
    ds_read_b64_tr_b16 v[76:77], v164 offset:0
    ds_read_b64_tr_b16 v[78:79], v164 offset:960
    ds_read_b64_tr_b16 v[80:81], v164 offset:16
    ds_read_b64_tr_b16 v[82:83], v164 offset:976
    ds_read_b64_tr_b16 v[84:85], v164 offset:32
    ds_read_b64_tr_b16 v[86:87], v164 offset:992
    ds_read_b64_tr_b16 v[88:89], v164 offset:48
    ds_read_b64_tr_b16 v[90:91], v164 offset:1008
    s_waitcnt lgkmcnt(6)
    v_mfma_f32_16x16x32_bf16 v[16:19], v[76:79], v[140:143], 0
    ds_read_b64_tr_b16 v[92:93], v164 offset:128
    s_add_u32 s61, s61, 128
    s_add_u32 s60, s60, 221184
    s_cmp_eq_u32 s61, 1152
    s_cselect_b32 s61, 0, s61
    s_cselect_b32 s60, s50, s60
    s_add_u32 s48, s60, 0
    s_add_u32 m0, s51, 100480
    s_nop 0
    buffer_load_dwordx4 v5, s[28:31], s48 offen lds
    v_mfma_f32_16x16x32_bf16 v[44:47], v[76:79], v[144:147], 0
    ds_read_b64_tr_b16 v[94:95], v164 offset:1088
    s_lshl_b32 s9, s8, 5
    s_add_u32 s9, s9, 16
    s_waitcnt lgkmcnt(6)
    v_mfma_f32_16x16x32_bf16 v[20:23], v[80:83], v[140:143], 0
    ds_read_b64_tr_b16 v[96:97], v164 offset:144
    v_mfma_f32_16x16x32_bf16 v[48:51], v[80:83], v[144:147], 0
    ds_read_b64_tr_b16 v[98:99], v164 offset:1104
    v_add_u32 v210, s9, v10
    v_mul_u32_u24 v210, 216, v210
    s_waitcnt lgkmcnt(6)
    v_mfma_f32_16x16x32_bf16 v[24:27], v[84:87], v[140:143], 0
    ds_read_b64_tr_b16 v[100:101], v165 offset:0
    v_mfma_f32_16x16x32_bf16 v[52:55], v[84:87], v[144:147], 0
    ds_read_b64_tr_b16 v[102:103], v165 offset:960
    s_add_u32 s48, s60, 13824
    s_add_u32 m0, s51, 101440
    s_nop 0
    buffer_load_dwordx4 v5, s[28:31], s48 offen lds
    v_lshl_add_u32 v187, v11, 3, v210
    v_min_u32 v211, 2, v11
    s_waitcnt lgkmcnt(6)
    v_mfma_f32_16x16x32_bf16 v[28:31], v[88:91], v[140:143], 0
    ds_read_b128 v[148:151], v168 offset:0
    v_mfma_f32_16x16x32_bf16 v[56:59], v[88:91], v[144:147], 0
    ds_read_b128 v[152:155], v168 offset:2048
    v_mul_u32_u24 v211, 72, v211
    v_add3_u32 v188, v210, v211, 64
    s_waitcnt lgkmcnt(6)
    v_mfma_f32_16x16x32_bf16 v[32:35], v[92:95], v[140:143], 0
    ds_read_b64_tr_b16 v[104:105], v164 offset:7680
    v_mfma_f32_16x16x32_bf16 v[60:63], v[92:95], v[144:147], 0
    ds_read_b64_tr_b16 v[106:107], v164 offset:8640
    s_add_u32 s48, s61, 0
    s_add_u32 m0, s58, 115904
    s_nop 0
    buffer_load_dwordx4 v2, s[24:27], s48 offen lds
    v_mul_u32_u24 v212, 216, v10
    s_and_b32 s9, s8, 1
    s_waitcnt lgkmcnt(6)
    v_mfma_f32_16x16x32_bf16 v[36:39], v[96:99], v[140:143], 0
    ds_read_b64_tr_b16 v[108:109], v164 offset:7696
    v_mfma_f32_16x16x32_bf16 v[64:67], v[96:99], v[144:147], 0
    ds_read_b64_tr_b16 v[110:111], v164 offset:8656
    s_lshl_b32 s9, s9, 5
    s_and_b32 s11, s8, 2
    s_waitcnt lgkmcnt(6)
    v_mfma_f32_16x16x32_bf16 v[40:43], v[100:103], v[140:143], 0
    ds_read_b64_tr_b16 v[112:113], v164 offset:7712
    v_mfma_f32_16x16x32_bf16 v[68:71], v[100:103], v[144:147], 0
    ds_read_b64_tr_b16 v[114:115], v164 offset:8672
    s_add_u32 s48, s61, 9216
    s_add_u32 m0, s58, 116928
    s_nop 0
    buffer_load_dwordx4 v2, s[24:27], s48 offen lds
    s_mul_i32 s11, s11, 36
    s_add_u32 s9, s9, s11
    s_waitcnt lgkmcnt(4)
    v_mfma_f32_16x16x32_bf16 v[16:19], v[104:107], v[148:151], v[16:19]
    ds_read_b64_tr_b16 v[116:117], v164 offset:7728
    v_mfma_f32_16x16x32_bf16 v[44:47], v[104:107], v[152:155], v[44:47]
    ds_read_b64_tr_b16 v[118:119], v164 offset:8688
    s_add_u32 s9, s9, 72
    v_lshl_add_u32 v213, v11, 3, v212
    s_waitcnt lgkmcnt(4)
    v_mfma_f32_16x16x32_bf16 v[20:23], v[108:111], v[148:151], v[20:23]
    ds_read_b64_tr_b16 v[120:121], v164 offset:7808
    v_mfma_f32_16x16x32_bf16 v[48:51], v[108:111], v[152:155], v[48:51]
    ds_read_b64_tr_b16 v[122:123], v164 offset:8768
    s_add_u32 s48, s61, 18432
    s_add_u32 m0, s58, 117952
    s_nop 0
    buffer_load_dwordx4 v2, s[24:27], s48 offen lds
    v_add_u32 v213, s9, v213
    v_add3_u32 v212, v212, v211, 64
    s_waitcnt lgkmcnt(4)
    v_mfma_f32_16x16x32_bf16 v[24:27], v[112:115], v[148:151], v[24:27]
    ds_read_b64_tr_b16 v[124:125], v164 offset:7824
    v_mfma_f32_16x16x32_bf16 v[52:55], v[112:115], v[152:155], v[52:55]
    ds_read_b64_tr_b16 v[126:127], v164 offset:8784
    s_cmp_eq_u32 s8, 4
    s_cselect_b64 vcc, -1, 0
    v_cndmask_b32 v189, v213, v212, vcc
    s_waitcnt lgkmcnt(4)
    v_mfma_f32_16x16x32_bf16 v[28:31], v[116:119], v[148:151], v[28:31]
    ds_read_b64_tr_b16 v[128:129], v165 offset:7680
    v_mfma_f32_16x16x32_bf16 v[56:59], v[116:119], v[152:155], v[56:59]
    ds_read_b64_tr_b16 v[130:131], v165 offset:8640
    s_add_u32 s48, s61, 27648
    s_add_u32 m0, s58, 118976
    s_nop 0
    buffer_load_dwordx4 v2, s[24:27], s48 offen lds
    v_and_b32 v210, 31, v1
    s_lshl_b32 s9, s8, 5
    s_waitcnt lgkmcnt(4)
    v_mfma_f32_16x16x32_bf16 v[32:35], v[120:123], v[148:151], v[32:35]
    v_mfma_f32_16x16x32_bf16 v[60:63], v[120:123], v[152:155], v[60:63]
    v_add_u32 v210, s9, v210
    v_lshrrev_b32 v211, 5, v1
    s_waitcnt lgkmcnt(2)
    v_mfma_f32_16x16x32_bf16 v[36:39], v[124:127], v[148:151], v[36:39]
    v_mfma_f32_16x16x32_bf16 v[64:67], v[124:127], v[152:155], v[64:67]
    v_add_u32 v212, 2, v210
    v_mul_u32_u24 v212, 216, v212
    s_waitcnt lgkmcnt(0)
    v_mfma_f32_16x16x32_bf16 v[40:43], v[128:131], v[148:151], v[40:43]
    v_mfma_f32_16x16x32_bf16 v[68:71], v[128:131], v[152:155], v[68:71]
    v_mad_u32_u24 v190, v211, 40, v212
    v_lshl_add_u32 v213, v211, 2, v212
    s_waitcnt vmcnt(6)
    s_barrier
    ds_read_b128 v[140:143], v175 offset:0
    ds_read_b128 v[144:147], v175 offset:2048
    ds_read_b64_tr_b16 v[76:77], v172 offset:0
    ds_read_b64_tr_b16 v[78:79], v172 offset:960
    ds_read_b64_tr_b16 v[80:81], v172 offset:16
    ds_read_b64_tr_b16 v[82:83], v172 offset:976
    ds_read_b64_tr_b16 v[84:85], v172 offset:32
    ds_read_b64_tr_b16 v[86:87], v172 offset:992
    ds_read_b64_tr_b16 v[88:89], v172 offset:48
    ds_read_b64_tr_b16 v[90:91], v172 offset:1008
    s_waitcnt lgkmcnt(6)
    v_mfma_f32_16x16x32_bf16 v[16:19], v[76:79], v[140:143], v[16:19]
    ds_read_b64_tr_b16 v[92:93], v172 offset:128
    s_add_u32 s61, s61, 128
    s_add_u32 s60, s60, 221184
    s_cmp_eq_u32 s61, 1152
    s_cselect_b32 s61, 0, s61
    s_cselect_b32 s60, s50, s60
    s_add_u32 s48, s60, 0
    s_add_u32 m0, s51, 0
    s_nop 0
    buffer_load_dwordx4 v5, s[28:31], s48 offen lds
    v_mfma_f32_16x16x32_bf16 v[44:47], v[76:79], v[144:147], v[44:47]
    ds_read_b64_tr_b16 v[94:95], v172 offset:1088
    v_add_u32 v191, 32, v213
    s_lshl_b32 s9, s6, 8
    s_waitcnt lgkmcnt(6)
    v_mfma_f32_16x16x32_bf16 v[20:23], v[80:83], v[140:143], v[20:23]
    ds_read_b64_tr_b16 v[96:97], v172 offset:144
    v_mfma_f32_16x16x32_bf16 v[48:51], v[80:83], v[144:147], v[48:51]
    ds_read_b64_tr_b16 v[98:99], v172 offset:1104
    v_add_u32 v192, s9, v210
    v_mul_u32_u24 v212, 80, v210
    s_waitcnt lgkmcnt(6)
    v_mfma_f32_16x16x32_bf16 v[24:27], v[84:87], v[140:143], v[24:27]
    ds_read_b64_tr_b16 v[100:101], v173 offset:0
    v_mfma_f32_16x16x32_bf16 v[52:55], v[84:87], v[144:147], v[52:55]
    ds_read_b64_tr_b16 v[102:103], v173 offset:960
    s_add_u32 s48, s60, 13824
    s_add_u32 m0, s51, 960
    s_nop 0
    buffer_load_dwordx4 v5, s[28:31], s48 offen lds
    v_add_u32 v212, 61440, v212
    v_mad_u32_u24 v193, v211, 40, v212
    s_waitcnt lgkmcnt(6)
    v_mfma_f32_16x16x32_bf16 v[28:31], v[88:91], v[140:143], v[28:31]
    ds_read_b128 v[148:151], v176 offset:0
    v_mfma_f32_16x16x32_bf16 v[56:59], v[88:91], v[144:147], v[56:59]
    ds_read_b128 v[152:155], v176 offset:2048
    v_lshl_add_u32 v213, v211, 2, v212
    v_add_u32 v194, 32, v213
    s_waitcnt lgkmcnt(6)
    v_mfma_f32_16x16x32_bf16 v[32:35], v[92:95], v[140:143], v[32:35]
    ds_read_b64_tr_b16 v[104:105], v172 offset:7680
    v_mfma_f32_16x16x32_bf16 v[60:63], v[92:95], v[144:147], v[60:63]
    ds_read_b64_tr_b16 v[106:107], v172 offset:8640
    s_add_u32 s48, s61, 0
    s_add_u32 m0, s58, 15424
    s_nop 0
    buffer_load_dwordx4 v2, s[24:27], s48 offen lds
    s_lshr_b32 s66, s8, 2
    s_add_u32 s65, s8, s66
    s_waitcnt lgkmcnt(6)
    v_mfma_f32_16x16x32_bf16 v[36:39], v[96:99], v[140:143], v[36:39]
    ds_read_b64_tr_b16 v[108:109], v172 offset:7696
    v_mfma_f32_16x16x32_bf16 v[64:67], v[96:99], v[144:147], v[64:67]
    ds_read_b64_tr_b16 v[110:111], v172 offset:8656
    s_and_b32 s65, s65, 3
    s_and_b32 s67, s7, 3
    s_waitcnt lgkmcnt(6)
    v_mfma_f32_16x16x32_bf16 v[40:43], v[100:103], v[140:143], v[40:43]
    ds_read_b64_tr_b16 v[112:113], v172 offset:7712
    v_mfma_f32_16x16x32_bf16 v[68:71], v[100:103], v[144:147], v[68:71]
    ds_read_b64_tr_b16 v[114:115], v172 offset:8672
    s_add_u32 s48, s61, 9216
    s_add_u32 m0, s58, 16448
    s_nop 0
    buffer_load_dwordx4 v2, s[24:27], s48 offen lds
    s_lshr_b32 s68, s7, 2
    s_mul_i32 s10, s67, 288
    s_waitcnt lgkmcnt(4)
    v_mfma_f32_16x16x32_bf16 v[16:19], v[104:107], v[148:151], v[16:19]
    ds_read_b64_tr_b16 v[116:117], v172 offset:7728
    v_mfma_f32_16x16x32_bf16 v[44:47], v[104:107], v[152:155], v[44:47]
    ds_read_b64_tr_b16 v[118:119], v172 offset:8688
    v_mov_b32 v216, 0x80000000
    s_lshl_b32 s9, s8, 6
    s_waitcnt lgkmcnt(4)
    v_mfma_f32_16x16x32_bf16 v[20:23], v[108:111], v[148:151], v[20:23]
    ds_read_b64_tr_b16 v[120:121], v172 offset:7808
    v_mfma_f32_16x16x32_bf16 v[48:51], v[108:111], v[152:155], v[48:51]
    ds_read_b64_tr_b16 v[122:123], v172 offset:8768
    s_add_u32 s48, s61, 18432
    s_add_u32 m0, s58, 17472
    s_nop 0
    buffer_load_dwordx4 v2, s[24:27], s48 offen lds
    s_add_u32 s9, s9, 0
    v_add_u32 v210, s9, v1
    s_waitcnt lgkmcnt(4)
    v_mfma_f32_16x16x32_bf16 v[24:27], v[112:115], v[148:151], v[24:27]
    ds_read_b64_tr_b16 v[124:125], v172 offset:7824
    v_mfma_f32_16x16x32_bf16 v[52:55], v[112:115], v[152:155], v[52:55]
    ds_read_b64_tr_b16 v[126:127], v172 offset:8784
    v_mul_u32_u24 v211, 1725, v210
    v_lshrrev_b32 v211, 18, v211
    s_waitcnt lgkmcnt(4)
    v_mfma_f32_16x16x32_bf16 v[28:31], v[116:119], v[148:151], v[28:31]
    ds_read_b64_tr_b16 v[128:129], v173 offset:7680
    v_mfma_f32_16x16x32_bf16 v[56:59], v[116:119], v[152:155], v[56:59]
    ds_read_b64_tr_b16 v[130:131], v173 offset:8640
    s_add_u32 s48, s61, 27648
    s_add_u32 m0, s58, 18496
    s_nop 0
    buffer_load_dwordx4 v2, s[24:27], s48 offen lds
    v_mul_u32_u24 v212, 152, v211
    v_sub_u32 v212, v210, v212
    s_waitcnt lgkmcnt(4)
    v_mfma_f32_16x16x32_bf16 v[32:35], v[120:123], v[148:151], v[32:35]
    v_mfma_f32_16x16x32_bf16 v[60:63], v[120:123], v[152:155], v[60:63]
    v_mul_u32_u24 v213, 3641, v212
    v_lshrrev_b32 v213, 16, v213
    s_waitcnt lgkmcnt(2)
    v_mfma_f32_16x16x32_bf16 v[36:39], v[124:127], v[148:151], v[36:39]
    v_mfma_f32_16x16x32_bf16 v[64:67], v[124:127], v[152:155], v[64:67]
    v_mul_u32_u24 v214, 18, v213
    v_sub_u32 v214, v212, v214
    s_waitcnt lgkmcnt(0)
    v_mfma_f32_16x16x32_bf16 v[40:43], v[128:131], v[148:151], v[40:43]
    v_mfma_f32_16x16x32_bf16 v[68:71], v[128:131], v[152:155], v[68:71]
    v_cmp_lt_u32 vcc, 143, v212
    v_lshl_add_u32 v213, v211, 3, v213
    s_waitcnt vmcnt(6)
    s_barrier
    ds_read_b128 v[140:143], v183 offset:0
    ds_read_b128 v[144:147], v183 offset:2048
    ds_read_b64_tr_b16 v[76:77], v180 offset:0
    ds_read_b64_tr_b16 v[78:79], v180 offset:960
    ds_read_b64_tr_b16 v[80:81], v180 offset:16
    ds_read_b64_tr_b16 v[82:83], v180 offset:976
    ds_read_b64_tr_b16 v[84:85], v180 offset:32
    ds_read_b64_tr_b16 v[86:87], v180 offset:992
    ds_read_b64_tr_b16 v[88:89], v180 offset:48
    ds_read_b64_tr_b16 v[90:91], v180 offset:1008
    s_waitcnt lgkmcnt(6)
    v_mfma_f32_16x16x32_bf16 v[16:19], v[76:79], v[140:143], v[16:19]
    ds_read_b64_tr_b16 v[92:93], v180 offset:128
    s_add_u32 s61, s61, 128
    s_add_u32 s60, s60, 221184
    s_cmp_eq_u32 s61, 1152
    s_cselect_b32 s61, 0, s61
    s_cselect_b32 s60, s50, s60
    s_add_u32 s48, s60, 0
    s_add_u32 m0, s51, 50240
    s_nop 0
    buffer_load_dwordx4 v5, s[28:31], s48 offen lds
    v_mfma_f32_16x16x32_bf16 v[44:47], v[76:79], v[144:147], v[44:47]
    ds_read_b64_tr_b16 v[94:95], v180 offset:1088
    v_lshlrev_b32 v214, 4, v214
    v_add_u32 v214, s10, v214
    s_waitcnt lgkmcnt(6)
    v_mfma_f32_16x16x32_bf16 v[20:23], v[80:83], v[140:143], v[20:23]
    ds_read_b64_tr_b16 v[96:97], v180 offset:144
    v_mfma_f32_16x16x32_bf16 v[48:51], v[80:83], v[144:147], v[48:51]
    ds_read_b64_tr_b16 v[98:99], v180 offset:1104
    v_lshrrev_b32 v215, 5, v213
    v_lshl_add_u32 v215, v215, 2, v213
    s_waitcnt lgkmcnt(6)
    v_mfma_f32_16x16x32_bf16 v[24:27], v[84:87], v[140:143], v[24:27]
    ds_read_b64_tr_b16 v[100:101], v181 offset:0
    v_mfma_f32_16x16x32_bf16 v[52:55], v[84:87], v[144:147], v[52:55]
    ds_read_b64_tr_b16 v[102:103], v181 offset:960
    s_add_u32 s48, s60, 13824
    s_add_u32 m0, s51, 51200
    s_nop 0
    buffer_load_dwordx4 v5, s[28:31], s48 offen lds
    v_mul_u32_u24 v215, 1152, v215
    v_add_u32 v215, v215, v214
    s_waitcnt lgkmcnt(6)
    v_mfma_f32_16x16x32_bf16 v[28:31], v[88:91], v[140:143], v[28:31]
    ds_read_b128 v[148:151], v184 offset:0
    v_mfma_f32_16x16x32_bf16 v[56:59], v[88:91], v[144:147], v[56:59]
    ds_read_b128 v[152:155], v184 offset:2048
    v_cndmask_b32 v232, v215, v216, vcc
    v_lshrrev_b32 v215, 2, v213
    s_waitcnt lgkmcnt(6)
    v_mfma_f32_16x16x32_bf16 v[32:35], v[92:95], v[140:143], v[32:35]
    ds_read_b64_tr_b16 v[104:105], v180 offset:7680
    v_mfma_f32_16x16x32_bf16 v[60:63], v[92:95], v[144:147], v[60:63]
    ds_read_b64_tr_b16 v[106:107], v180 offset:8640
    s_add_u32 s48, s61, 0
    s_add_u32 m0, s58, 65664
    s_nop 0
    buffer_load_dwordx4 v2, s[24:27], s48 offen lds
    v_mul_u32_u24 v215, 36, v215
    v_and_b32 v213, 3, v213
    s_waitcnt lgkmcnt(6)
    v_mfma_f32_16x16x32_bf16 v[36:39], v[96:99], v[140:143], v[36:39]
    ds_read_b64_tr_b16 v[108:109], v180 offset:7696
    v_mfma_f32_16x16x32_bf16 v[64:67], v[96:99], v[144:147], v[64:67]
    ds_read_b64_tr_b16 v[110:111], v180 offset:8656
    v_add3_u32 v215, v215, v213, 32
    v_mul_u32_u24 v215, 1152, v215
    s_waitcnt lgkmcnt(6)
    v_mfma_f32_16x16x32_bf16 v[40:43], v[100:103], v[140:143], v[40:43]
    ds_read_b64_tr_b16 v[112:113], v180 offset:7712
    v_mfma_f32_16x16x32_bf16 v[68:71], v[100:103], v[144:147], v[68:71]
    ds_read_b64_tr_b16 v[114:115], v180 offset:8672
    s_add_u32 s48, s61, 9216
    s_add_u32 m0, s58, 66688
    s_nop 0
    buffer_load_dwordx4 v2, s[24:27], s48 offen lds
    v_add_u32 v215, v215, v214
    v_cndmask_b32 v235, v215, v216, vcc
    s_waitcnt lgkmcnt(4)
    v_mfma_f32_16x16x32_bf16 v[16:19], v[104:107], v[148:151], v[16:19]
    ds_read_b64_tr_b16 v[116:117], v180 offset:7728
    v_mfma_f32_16x16x32_bf16 v[44:47], v[104:107], v[152:155], v[44:47]
    ds_read_b64_tr_b16 v[118:119], v180 offset:8688
    s_lshl_b32 s9, s8, 6
    s_add_u32 s9, s9, 512
    s_waitcnt lgkmcnt(4)
    v_mfma_f32_16x16x32_bf16 v[20:23], v[108:111], v[148:151], v[20:23]
    ds_read_b64_tr_b16 v[120:121], v180 offset:7808
    v_mfma_f32_16x16x32_bf16 v[48:51], v[108:111], v[152:155], v[48:51]
    ds_read_b64_tr_b16 v[122:123], v180 offset:8768
    s_add_u32 s48, s61, 18432
    s_add_u32 m0, s58, 67712
    s_nop 0
    buffer_load_dwordx4 v2, s[24:27], s48 offen lds
    v_add_u32 v210, s9, v1
    v_mul_u32_u24 v211, 1725, v210
    s_waitcnt lgkmcnt(4)
    v_mfma_f32_16x16x32_bf16 v[24:27], v[112:115], v[148:151], v[24:27]
    ds_read_b64_tr_b16 v[124:125], v180 offset:7824
    v_mfma_f32_16x16x32_bf16 v[52:55], v[112:115], v[152:155], v[52:55]
    ds_read_b64_tr_b16 v[126:127], v180 offset:8784
    v_lshrrev_b32 v211, 18, v211
    v_mul_u32_u24 v212, 152, v211
    s_waitcnt lgkmcnt(4)
    v_mfma_f32_16x16x32_bf16 v[28:31], v[116:119], v[148:151], v[28:31]
    ds_read_b64_tr_b16 v[128:129], v181 offset:7680
    v_mfma_f32_16x16x32_bf16 v[56:59], v[116:119], v[152:155], v[56:59]
    ds_read_b64_tr_b16 v[130:131], v181 offset:8640
    s_add_u32 s48, s61, 27648
    s_add_u32 m0, s58, 68736
    s_nop 0
    buffer_load_dwordx4 v2, s[24:27], s48 offen lds
    v_sub_u32 v212, v210, v212
    v_mul_u32_u24 v213, 3641, v212
    s_waitcnt lgkmcnt(4)
    v_mfma_f32_16x16x32_bf16 v[32:35], v[120:123], v[148:151], v[32:35]
    v_mfma_f32_16x16x32_bf16 v[60:63], v[120:123], v[152:155], v[60:63]
    v_lshrrev_b32 v213, 16, v213
    v_mul_u32_u24 v214, 18, v213
    s_waitcnt lgkmcnt(2)
    v_mfma_f32_16x16x32_bf16 v[36:39], v[124:127], v[148:151], v[36:39]
    v_mfma_f32_16x16x32_bf16 v[64:67], v[124:127], v[152:155], v[64:67]
    v_sub_u32 v214, v212, v214
    v_cmp_lt_u32 vcc, 143, v212
    s_waitcnt lgkmcnt(0)
    v_mfma_f32_16x16x32_bf16 v[40:43], v[128:131], v[148:151], v[40:43]
    v_mfma_f32_16x16x32_bf16 v[68:71], v[128:131], v[152:155], v[68:71]
    v_lshl_add_u32 v213, v211, 3, v213
    v_lshlrev_b32 v214, 4, v214
    s_waitcnt vmcnt(6)
    s_barrier
    ds_read_b128 v[140:143], v167 offset:0
    ds_read_b128 v[144:147], v167 offset:2048
    ds_read_b64_tr_b16 v[76:77], v164 offset:0
    ds_read_b64_tr_b16 v[78:79], v164 offset:960
    ds_read_b64_tr_b16 v[80:81], v164 offset:16
    ds_read_b64_tr_b16 v[82:83], v164 offset:976
    ds_read_b64_tr_b16 v[84:85], v164 offset:32
    ds_read_b64_tr_b16 v[86:87], v164 offset:992
    ds_read_b64_tr_b16 v[88:89], v164 offset:48
    ds_read_b64_tr_b16 v[90:91], v164 offset:1008
    s_waitcnt lgkmcnt(6)
    v_mfma_f32_16x16x32_bf16 v[16:19], v[76:79], v[140:143], v[16:19]
    ds_read_b64_tr_b16 v[92:93], v164 offset:128
    s_add_u32 s61, s61, 128
    s_add_u32 s60, s60, 221184
    s_cmp_eq_u32 s61, 1152
    s_cselect_b32 s61, 0, s61
    s_cselect_b32 s60, s50, s60
    s_add_u32 s48, s60, 0
    s_add_u32 m0, s51, 100480
    s_nop 0
    buffer_load_dwordx4 v5, s[28:31], s48 offen lds
    v_mfma_f32_16x16x32_bf16 v[44:47], v[76:79], v[144:147], v[44:47]
    ds_read_b64_tr_b16 v[94:95], v164 offset:1088
    v_add_u32 v214, s10, v214
    v_lshrrev_b32 v215, 5, v213
    s_waitcnt lgkmcnt(6)
    v_mfma_f32_16x16x32_bf16 v[20:23], v[80:83], v[140:143], v[20:23]
    ds_read_b64_tr_b16 v[96:97], v164 offset:144
    v_mfma_f32_16x16x32_bf16 v[48:51], v[80:83], v[144:147], v[48:51]
    ds_read_b64_tr_b16 v[98:99], v164 offset:1104
    v_lshl_add_u32 v215, v215, 2, v213
    v_mul_u32_u24 v215, 1152, v215
    s_waitcnt lgkmcnt(6)
    v_mfma_f32_16x16x32_bf16 v[24:27], v[84:87], v[140:143], v[24:27]
    ds_read_b64_tr_b16 v[100:101], v165 offset:0
    s_add_u32 s48, s60, 13824
    s_add_u32 m0, s51, 101440
    s_nop 0
    buffer_load_dwordx4 v5, s[28:31], s48 offen lds
    v_mfma_f32_16x16x32_bf16 v[52:55], v[84:87], v[144:147], v[52:55]
    ds_read_b64_tr_b16 v[102:103], v165 offset:960
    v_add_u32 v215, v215, v214
    v_cndmask_b32 v233, v215, v216, vcc
    s_waitcnt lgkmcnt(6)
    v_mfma_f32_16x16x32_bf16 v[28:31], v[88:91], v[140:143], v[28:31]
    ds_read_b128 v[148:151], v168 offset:0
    v_mfma_f32_16x16x32_bf16 v[56:59], v[88:91], v[144:147], v[56:59]
    ds_read_b128 v[152:155], v168 offset:2048
    v_lshrrev_b32 v215, 2, v213
    v_mul_u32_u24 v215, 36, v215
    s_waitcnt lgkmcnt(6)
    v_mfma_f32_16x16x32_bf16 v[32:35], v[92:95], v[140:143], v[32:35]
    ds_read_b64_tr_b16 v[104:105], v164 offset:7680
    s_add_u32 s48, s61, 0
    s_add_u32 m0, s58, 115904
    s_nop 0
    buffer_load_dwordx4 v2, s[24:27], s48 offen lds
    v_mfma_f32_16x16x32_bf16 v[60:63], v[92:95], v[144:147], v[60:63]
    ds_read_b64_tr_b16 v[106:107], v164 offset:8640
    v_and_b32 v213, 3, v213
    v_add3_u32 v215, v215, v213, 32
    s_waitcnt lgkmcnt(6)
    v_mfma_f32_16x16x32_bf16 v[36:39], v[96:99], v[140:143], v[36:39]
    ds_read_b64_tr_b16 v[108:109], v164 offset:7696
    v_mfma_f32_16x16x32_bf16 v[64:67], v[96:99], v[144:147], v[64:67]
    ds_read_b64_tr_b16 v[110:111], v164 offset:8656
    s_add_u32 s48, s61, 9216
    s_add_u32 m0, s58, 116928
    s_nop 0
    buffer_load_dwordx4 v2, s[24:27], s48 offen lds
    v_mul_u32_u24 v215, 1152, v215
    v_add_u32 v215, v215, v214
    s_waitcnt lgkmcnt(6)
    v_mfma_f32_16x16x32_bf16 v[40:43], v[100:103], v[140:143], v[40:43]
    ds_read_b64_tr_b16 v[112:113], v164 offset:7712
    v_mfma_f32_16x16x32_bf16 v[68:71], v[100:103], v[144:147], v[68:71]
    ds_read_b64_tr_b16 v[114:115], v164 offset:8672
    v_cndmask_b32 v236, v215, v216, vcc
    s_lshl_b32 s9, s8, 6
    s_waitcnt lgkmcnt(4)
    v_mfma_f32_16x16x32_bf16 v[16:19], v[104:107], v[148:151], v[16:19]
    ds_read_b64_tr_b16 v[116:117], v164 offset:7728
    v_mfma_f32_16x16x32_bf16 v[44:47], v[104:107], v[152:155], v[44:47]
    ds_read_b64_tr_b16 v[118:119], v164 offset:8688
    s_add_u32 s48, s61, 18432
    s_add_u32 m0, s58, 117952
    s_nop 0
    buffer_load_dwordx4 v2, s[24:27], s48 offen lds
    s_add_u32 s9, s9, 1024
    v_add_u32 v210, s9, v1
    s_waitcnt lgkmcnt(4)
    v_mfma_f32_16x16x32_bf16 v[20:23], v[108:111], v[148:151], v[20:23]
    ds_read_b64_tr_b16 v[120:121], v164 offset:7808
    v_mfma_f32_16x16x32_bf16 v[48:51], v[108:111], v[152:155], v[48:51]
    ds_read_b64_tr_b16 v[122:123], v164 offset:8768
    v_mul_u32_u24 v211, 1725, v210
    v_lshrrev_b32 v211, 18, v211
    s_waitcnt lgkmcnt(4)
    v_mfma_f32_16x16x32_bf16 v[24:27], v[112:115], v[148:151], v[24:27]
    ds_read_b64_tr_b16 v[124:125], v164 offset:7824
    s_add_u32 s48, s61, 27648
    s_add_u32 m0, s58, 118976
    s_nop 0
    buffer_load_dwordx4 v2, s[24:27], s48 offen lds
    v_mfma_f32_16x16x32_bf16 v[52:55], v[112:115], v[152:155], v[52:55]
    ds_read_b64_tr_b16 v[126:127], v164 offset:8784
    v_mul_u32_u24 v212, 152, v211
    v_sub_u32 v212, v210, v212
    s_waitcnt lgkmcnt(4)
    v_mfma_f32_16x16x32_bf16 v[28:31], v[116:119], v[148:151], v[28:31]
    ds_read_b64_tr_b16 v[128:129], v165 offset:7680
    v_mfma_f32_16x16x32_bf16 v[56:59], v[116:119], v[152:155], v[56:59]
    ds_read_b64_tr_b16 v[130:131], v165 offset:8640
    v_mul_u32_u24 v213, 3641, v212
    v_lshrrev_b32 v213, 16, v213
    s_waitcnt lgkmcnt(4)
    v_mfma_f32_16x16x32_bf16 v[32:35], v[120:123], v[148:151], v[32:35]
    s_nop 0
    buffer_load_dword v229, v228, s[72:75], 0 offen
    v_mfma_f32_16x16x32_bf16 v[60:63], v[120:123], v[152:155], v[60:63]
    v_mul_u32_u24 v214, 18, v213
    v_sub_u32 v214, v212, v214
    s_waitcnt lgkmcnt(2)
    v_mfma_f32_16x16x32_bf16 v[36:39], v[124:127], v[148:151], v[36:39]
    v_mfma_f32_16x16x32_bf16 v[64:67], v[124:127], v[152:155], v[64:67]
    v_cmp_lt_u32 vcc, 143, v212
    v_lshl_add_u32 v213, v211, 3, v213
    s_waitcnt lgkmcnt(0)
    v_mfma_f32_16x16x32_bf16 v[40:43], v[128:131], v[148:151], v[40:43]
    v_mfma_f32_16x16x32_bf16 v[68:71], v[128:131], v[152:155], v[68:71]
    v_lshlrev_b32 v214, 4, v214
    v_add_u32 v214, s10, v214
    s_waitcnt vmcnt(7)
    s_barrier
    ds_read_b128 v[140:143], v175 offset:0
    ds_read_b128 v[144:147], v175 offset:2048
    ds_read_b64_tr_b16 v[76:77], v172 offset:0
    ds_read_b64_tr_b16 v[78:79], v172 offset:960
    ds_read_b64_tr_b16 v[80:81], v172 offset:16
    ds_read_b64_tr_b16 v[82:83], v172 offset:976
    ds_read_b64_tr_b16 v[84:85], v172 offset:32
    ds_read_b64_tr_b16 v[86:87], v172 offset:992
    ds_read_b64_tr_b16 v[88:89], v172 offset:48
    ds_read_b64_tr_b16 v[90:91], v172 offset:1008
    s_waitcnt lgkmcnt(6)
    v_mfma_f32_16x16x32_bf16 v[16:19], v[76:79], v[140:143], v[16:19]
    ds_read_b64_tr_b16 v[92:93], v172 offset:128
    s_add_u32 s61, s61, 128
    s_add_u32 s60, s60, 221184
    s_cmp_eq_u32 s61, 1152
    s_cselect_b32 s61, 0, s61
    s_cselect_b32 s60, s50, s60
    s_add_u32 s48, s60, 0
    s_add_u32 m0, s51, 0
    s_nop 0
    buffer_load_dwordx4 v5, s[28:31], s48 offen lds
    v_mfma_f32_16x16x32_bf16 v[44:47], v[76:79], v[144:147], v[44:47]
    ds_read_b64_tr_b16 v[94:95], v172 offset:1088
    v_lshrrev_b32 v215, 5, v213
    v_lshl_add_u32 v215, v215, 2, v213
    s_waitcnt lgkmcnt(6)
    v_mfma_f32_16x16x32_bf16 v[20:23], v[80:83], v[140:143], v[20:23]
    ds_read_b64_tr_b16 v[96:97], v172 offset:144
    v_mfma_f32_16x16x32_bf16 v[48:51], v[80:83], v[144:147], v[48:51]
    ds_read_b64_tr_b16 v[98:99], v172 offset:1104
    v_mul_u32_u24 v215, 1152, v215
    v_add_u32 v215, v215, v214
    s_waitcnt lgkmcnt(6)
    v_mfma_f32_16x16x32_bf16 v[24:27], v[84:87], v[140:143], v[24:27]
    ds_read_b64_tr_b16 v[100:101], v173 offset:0
    v_mfma_f32_16x16x32_bf16 v[52:55], v[84:87], v[144:147], v[52:55]
    ds_read_b64_tr_b16 v[102:103], v173 offset:960
    s_add_u32 s48, s60, 13824
    s_add_u32 m0, s51, 960
    s_nop 0
    buffer_load_dwordx4 v5, s[28:31], s48 offen lds
    v_cndmask_b32 v234, v215, v216, vcc
    v_lshrrev_b32 v215, 2, v213
    s_waitcnt lgkmcnt(6)
    v_mfma_f32_16x16x32_bf16 v[28:31], v[88:91], v[140:143], v[28:31]
    ds_read_b128 v[148:151], v176 offset:0
    v_mfma_f32_16x16x32_bf16 v[56:59], v[88:91], v[144:147], v[56:59]
    ds_read_b128 v[152:155], v176 offset:2048
    v_mul_u32_u24 v215, 36, v215
    v_and_b32 v213, 3, v213
    s_waitcnt lgkmcnt(6)
    v_mfma_f32_16x16x32_bf16 v[32:35], v[92:95], v[140:143], v[32:35]
    ds_read_b64_tr_b16 v[104:105], v172 offset:7680
    v_mfma_f32_16x16x32_bf16 v[60:63], v[92:95], v[144:147], v[60:63]
    ds_read_b64_tr_b16 v[106:107], v172 offset:8640
    s_add_u32 s48, s61, 0
    s_add_u32 m0, s58, 15424
    s_nop 0
    buffer_load_dwordx4 v2, s[24:27], s48 offen lds
    v_add3_u32 v215, v215, v213, 32
    v_mul_u32_u24 v215, 1152, v215
    s_waitcnt lgkmcnt(6)
    v_mfma_f32_16x16x32_bf16 v[36:39], v[96:99], v[140:143], v[36:39]
    ds_read_b64_tr_b16 v[108:109], v172 offset:7696
    v_mfma_f32_16x16x32_bf16 v[64:67], v[96:99], v[144:147], v[64:67]
    ds_read_b64_tr_b16 v[110:111], v172 offset:8656
    v_add_u32 v215, v215, v214
    v_cndmask_b32 v237, v215, v216, vcc
    s_waitcnt lgkmcnt(6)
    v_mfma_f32_16x16x32_bf16 v[40:43], v[100:103], v[140:143], v[40:43]
    ds_read_b64_tr_b16 v[112:113], v172 offset:7712
    v_mfma_f32_16x16x32_bf16 v[68:71], v[100:103], v[144:147], v[68:71]
    ds_read_b64_tr_b16 v[114:115], v172 offset:8672
    s_add_u32 s48, s61, 9216
    s_add_u32 m0, s58, 16448
    s_nop 0
    buffer_load_dwordx4 v2, s[24:27], s48 offen lds
    v_mul_u32_u24 v210, 2432, v11
    v_mul_u32_u24 v211, 288, v12
    s_waitcnt lgkmcnt(4)
    v_mfma_f32_16x16x32_bf16 v[16:19], v[104:107], v[148:151], v[16:19]
    ds_read_b64_tr_b16 v[116:117], v172 offset:7728
    v_mfma_f32_16x16x32_bf16 v[44:47], v[104:107], v[152:155], v[44:47]
    ds_read_b64_tr_b16 v[118:119], v172 offset:8688
    v_lshlrev_b32 v212, 3, v13
    v_add3_u32 v211, v210, v211, v212
    s_waitcnt lgkmcnt(4)
    v_mfma_f32_16x16x32_bf16 v[20:23], v[108:111], v[148:151], v[20:23]
    ds_read_b64_tr_b16 v[120:121], v172 offset:7808
    v_mfma_f32_16x16x32_bf16 v[48:51], v[108:111], v[152:155], v[48:51]
    ds_read_b64_tr_b16 v[122:123], v172 offset:8768
    s_add_u32 s48, s61, 18432
    s_add_u32 m0, s58, 17472
    s_nop 0
    buffer_load_dwordx4 v2, s[24:27], s48 offen lds
    s_lshl_b32 s9, s65, 6
    s_add_u32 s9, s9, 81920
    s_waitcnt lgkmcnt(4)
    v_mfma_f32_16x16x32_bf16 v[24:27], v[112:115], v[148:151], v[24:27]
    ds_read_b64_tr_b16 v[124:125], v172 offset:7824
    v_mfma_f32_16x16x32_bf16 v[52:55], v[112:115], v[152:155], v[52:55]
    ds_read_b64_tr_b16 v[126:127], v172 offset:8784
    v_add_u32 v238, s9, v211
    v_add_u32 v239, 82176, v211
    s_waitcnt lgkmcnt(4)
    v_mfma_f32_16x16x32_bf16 v[28:31], v[116:119], v[148:151], v[28:31]
    ds_read_b64_tr_b16 v[128:129], v173 offset:7680
    v_mfma_f32_16x16x32_bf16 v[56:59], v[116:119], v[152:155], v[56:59]
    ds_read_b64_tr_b16 v[130:131], v173 offset:8640
    s_add_u32 s48, s61, 27648
    s_add_u32 m0, s58, 18496
    s_nop 0
    buffer_load_dwordx4 v2, s[24:27], s48 offen lds
    v_add_u32 v240, 19456, v238
    v_add_u32 v241, 19456, v239
    s_waitcnt lgkmcnt(4)
    v_mfma_f32_16x16x32_bf16 v[32:35], v[120:123], v[148:151], v[32:35]
    v_mfma_f32_16x16x32_bf16 v[60:63], v[120:123], v[152:155], v[60:63]
    v_add_u32 v242, 38912, v238
    v_add_u32 v243, 38912, v239
    s_waitcnt lgkmcnt(2)
    v_mfma_f32_16x16x32_bf16 v[36:39], v[124:127], v[148:151], v[36:39]
    v_mfma_f32_16x16x32_bf16 v[64:67], v[124:127], v[152:155], v[64:67]
    v_add_u32 v244, 58368, v238
    v_add_u32 v245, 58368, v239
    s_waitcnt lgkmcnt(0)
    v_mfma_f32_16x16x32_bf16 v[40:43], v[128:131], v[148:151], v[40:43]
    v_mfma_f32_16x16x32_bf16 v[68:71], v[128:131], v[152:155], v[68:71]
    s_lshl_b32 s9, s66, 5
    v_add_u32 v210, s9, v10
    s_waitcnt vmcnt(7)
    s_barrier
    ds_read_b128 v[140:143], v183 offset:0
    ds_read_b128 v[144:147], v183 offset:2048
    ds_read_b64_tr_b16 v[76:77], v180 offset:0
    ds_read_b64_tr_b16 v[78:79], v180 offset:960
    ds_read_b64_tr_b16 v[80:81], v180 offset:16
    ds_read_b64_tr_b16 v[82:83], v180 offset:976
    ds_read_b64_tr_b16 v[84:85], v180 offset:32
    ds_read_b64_tr_b16 v[86:87], v180 offset:992
    ds_read_b64_tr_b16 v[88:89], v180 offset:48
    ds_read_b64_tr_b16 v[90:91], v180 offset:1008
    s_waitcnt lgkmcnt(6)
    v_mfma_f32_16x16x32_bf16 v[16:19], v[76:79], v[140:143], v[16:19]
    ds_read_b64_tr_b16 v[92:93], v180 offset:128
    s_add_u32 s61, s61, 128
    s_add_u32 s60, s60, 221184
    s_cmp_eq_u32 s61, 1152
    s_cselect_b32 s61, 0, s61
    s_cselect_b32 s60, s50, s60
    s_add_u32 s48, s60, 0
    s_add_u32 m0, s51, 50240
    s_nop 0
    buffer_load_dwordx4 v5, s[28:31], s48 offen lds
    v_mfma_f32_16x16x32_bf16 v[44:47], v[76:79], v[144:147], v[44:47]
    ds_read_b64_tr_b16 v[94:95], v180 offset:1088
    v_mul_u32_u24 v211, 80, v210
    v_lshl_add_u32 v246, v11, 4, v211
    s_waitcnt lgkmcnt(6)
    v_mfma_f32_16x16x32_bf16 v[20:23], v[80:83], v[140:143], v[20:23]
    ds_read_b64_tr_b16 v[96:97], v180 offset:144
    v_mfma_f32_16x16x32_bf16 v[48:51], v[80:83], v[144:147], v[48:51]
    ds_read_b64_tr_b16 v[98:99], v180 offset:1104
    v_mul_u32_u24 v212, 10240, v11
    v_add3_u32 v247, v211, v212, 64
    s_waitcnt lgkmcnt(6)
    v_mfma_f32_16x16x32_bf16 v[24:27], v[84:87], v[140:143], v[24:27]
    ds_read_b64_tr_b16 v[100:101], v181 offset:0
    v_mfma_f32_16x16x32_bf16 v[52:55], v[84:87], v[144:147], v[52:55]
    ds_read_b64_tr_b16 v[102:103], v181 offset:960
    s_add_u32 s48, s60, 13824
    s_add_u32 m0, s51, 51200
    s_nop 0
    buffer_load_dwordx4 v5, s[28:31], s48 offen lds
    v_mul_u32_u24 v211, 304, v210
    v_lshl_add_u32 v211, v11, 3, v211
    s_waitcnt lgkmcnt(6)
    v_mfma_f32_16x16x32_bf16 v[28:31], v[88:91], v[140:143], v[28:31]
    ds_read_b128 v[148:151], v184 offset:0
    v_mfma_f32_16x16x32_bf16 v[56:59], v[88:91], v[144:147], v[56:59]
    ds_read_b128 v[152:155], v184 offset:2048
    s_lshl_b32 s9, s65, 6
    v_add_u32 v248, s9, v211
    s_waitcnt lgkmcnt(6)
    v_mfma_f32_16x16x32_bf16 v[32:35], v[92:95], v[140:143], v[32:35]
    ds_read_b64_tr_b16 v[104:105], v180 offset:7680
    v_mfma_f32_16x16x32_bf16 v[60:63], v[92:95], v[144:147], v[60:63]
    ds_read_b64_tr_b16 v[106:107], v180 offset:8640
    s_add_u32 s48, s61, 0
    s_add_u32 m0, s58, 65664
    s_nop 0
    buffer_load_dwordx4 v2, s[24:27], s48 offen lds
    s_lshl_b32 s10, s6, 2
    s_add_u32 s10, s10, s68
    s_waitcnt lgkmcnt(6)
    v_mfma_f32_16x16x32_bf16 v[36:39], v[96:99], v[140:143], v[36:39]
    ds_read_b64_tr_b16 v[108:109], v180 offset:7696
    v_mfma_f32_16x16x32_bf16 v[64:67], v[96:99], v[144:147], v[64:67]
    ds_read_b64_tr_b16 v[110:111], v180 offset:8656
    s_mul_i32 s10, s10, 147456
    s_mul_i32 s9, s5, 1152
    s_waitcnt lgkmcnt(6)
    v_mfma_f32_16x16x32_bf16 v[40:43], v[100:103], v[140:143], v[40:43]
    ds_read_b64_tr_b16 v[112:113], v180 offset:7712
    v_mfma_f32_16x16x32_bf16 v[68:71], v[100:103], v[144:147], v[68:71]
    ds_read_b64_tr_b16 v[114:115], v180 offset:8672
    s_add_u32 s48, s61, 9216
    s_add_u32 m0, s58, 66688
    s_nop 0
    buffer_load_dwordx4 v2, s[24:27], s48 offen lds
    s_add_u32 s10, s10, s9
    s_mul_i32 s9, s67, 288
    s_waitcnt lgkmcnt(4)
    v_mfma_f32_16x16x32_bf16 v[16:19], v[104:107], v[148:151], v[16:19]
    ds_read_b64_tr_b16 v[116:117], v180 offset:7728
    v_mfma_f32_16x16x32_bf16 v[44:47], v[104:107], v[152:155], v[44:47]
    ds_read_b64_tr_b16 v[118:119], v180 offset:8688
    s_add_u32 s10, s10, s9
    s_lshl_b32 s9, s8, 6
    s_waitcnt lgkmcnt(4)
    v_mfma_f32_16x16x32_bf16 v[20:23], v[108:111], v[148:151], v[20:23]
    ds_read_b64_tr_b16 v[120:121], v180 offset:7808
    v_mfma_f32_16x16x32_bf16 v[48:51], v[108:111], v[152:155], v[48:51]
    ds_read_b64_tr_b16 v[122:123], v180 offset:8768
    s_add_u32 s48, s61, 18432
    s_add_u32 m0, s58, 67712
    s_nop 0
    buffer_load_dwordx4 v2, s[24:27], s48 offen lds
    s_add_u32 s9, s9, 0
    v_add_u32 v210, s9, v1
    s_waitcnt lgkmcnt(4)
    v_mfma_f32_16x16x32_bf16 v[24:27], v[112:115], v[148:151], v[24:27]
    ds_read_b64_tr_b16 v[124:125], v180 offset:7824
    v_mfma_f32_16x16x32_bf16 v[52:55], v[112:115], v[152:155], v[52:55]
    ds_read_b64_tr_b16 v[126:127], v180 offset:8784
    v_mul_u32_u24 v211, 3641, v210
    v_lshrrev_b32 v211, 16, v211
    s_waitcnt lgkmcnt(4)
    v_mfma_f32_16x16x32_bf16 v[28:31], v[116:119], v[148:151], v[28:31]
    ds_read_b64_tr_b16 v[128:129], v181 offset:7680
    v_mfma_f32_16x16x32_bf16 v[56:59], v[116:119], v[152:155], v[56:59]
    ds_read_b64_tr_b16 v[130:131], v181 offset:8640
    s_add_u32 s48, s61, 27648
    s_add_u32 m0, s58, 68736
    s_nop 0
    buffer_load_dwordx4 v2, s[24:27], s48 offen lds
    v_mul_u32_u24 v212, 18, v211
    v_sub_u32 v212, v210, v212
    s_waitcnt lgkmcnt(4)
    v_mfma_f32_16x16x32_bf16 v[32:35], v[120:123], v[148:151], v[32:35]
    v_mfma_f32_16x16x32_bf16 v[60:63], v[120:123], v[152:155], v[60:63]
    v_lshlrev_b32 v212, 4, v212
    v_mul_u32_u24 v213, 304, v211
    s_waitcnt lgkmcnt(2)
    v_mfma_f32_16x16x32_bf16 v[36:39], v[124:127], v[148:151], v[36:39]
    v_mfma_f32_16x16x32_bf16 v[64:67], v[124:127], v[152:155], v[64:67]
    v_add_u32 v249, v213, v212
    v_mul_u32_u24 v213, 2304, v211
    s_waitcnt lgkmcnt(0)
    v_mfma_f32_16x16x32_bf16 v[40:43], v[128:131], v[148:151], v[40:43]
    v_mfma_f32_16x16x32_bf16 v[68:71], v[128:131], v[152:155], v[68:71]
    v_add3_u32 v252, v213, v212, s10
    s_lshl_b32 s9, s8, 6
    s_waitcnt vmcnt(6)
    s_barrier
    ds_read_b128 v[140:143], v167 offset:0
    ds_read_b128 v[144:147], v167 offset:2048
    ds_read_b64_tr_b16 v[76:77], v164 offset:0
    ds_read_b64_tr_b16 v[78:79], v164 offset:960
    ds_read_b64_tr_b16 v[80:81], v164 offset:16
    ds_read_b64_tr_b16 v[82:83], v164 offset:976
    ds_read_b64_tr_b16 v[84:85], v164 offset:32
    ds_read_b64_tr_b16 v[86:87], v164 offset:992
    ds_read_b64_tr_b16 v[88:89], v164 offset:48
    ds_read_b64_tr_b16 v[90:91], v164 offset:1008
    s_waitcnt lgkmcnt(6)
    v_mfma_f32_16x16x32_bf16 v[16:19], v[76:79], v[140:143], v[16:19]
    ds_read_b64_tr_b16 v[92:93], v164 offset:128
    s_add_u32 s61, s61, 128
    s_add_u32 s60, s60, 221184
    s_cmp_eq_u32 s61, 1152
    s_cselect_b32 s61, 0, s61
    s_cselect_b32 s60, s50, s60
    s_add_u32 s48, s60, 0
    s_add_u32 m0, s51, 100480
    s_nop 0
    buffer_load_dwordx4 v5, s[28:31], s48 offen lds
    v_mfma_f32_16x16x32_bf16 v[44:47], v[76:79], v[144:147], v[44:47]
    ds_read_b64_tr_b16 v[94:95], v164 offset:1088
    s_add_u32 s9, s9, 512
    v_add_u32 v210, s9, v1
    s_waitcnt lgkmcnt(6)
    v_mfma_f32_16x16x32_bf16 v[20:23], v[80:83], v[140:143], v[20:23]
    ds_read_b64_tr_b16 v[96:97], v164 offset:144
    v_mfma_f32_16x16x32_bf16 v[48:51], v[80:83], v[144:147], v[48:51]
    ds_read_b64_tr_b16 v[98:99], v164 offset:1104
    v_mul_u32_u24 v211, 3641, v210
    v_lshrrev_b32 v211, 16, v211
    s_waitcnt lgkmcnt(6)
    v_mfma_f32_16x16x32_bf16 v[24:27], v[84:87], v[140:143], v[24:27]
    ds_read_b64_tr_b16 v[100:101], v165 offset:0
    v_mfma_f32_16x16x32_bf16 v[52:55], v[84:87], v[144:147], v[52:55]
    ds_read_b64_tr_b16 v[102:103], v165 offset:960
    s_add_u32 s48, s60, 13824
    s_add_u32 m0, s51, 101440
    s_nop 0
    buffer_load_dwordx4 v5, s[28:31], s48 offen lds
    v_mul_u32_u24 v212, 18, v211
    v_sub_u32 v212, v210, v212
    s_waitcnt lgkmcnt(6)
    v_mfma_f32_16x16x32_bf16 v[28:31], v[88:91], v[140:143], v[28:31]
    ds_read_b128 v[148:151], v168 offset:0
    v_mfma_f32_16x16x32_bf16 v[56:59], v[88:91], v[144:147], v[56:59]
    ds_read_b128 v[152:155], v168 offset:2048
    v_lshlrev_b32 v212, 4, v212
    v_mul_u32_u24 v213, 304, v211
    s_waitcnt lgkmcnt(6)
    v_mfma_f32_16x16x32_bf16 v[32:35], v[92:95], v[140:143], v[32:35]
    ds_read_b64_tr_b16 v[104:105], v164 offset:7680
    v_mfma_f32_16x16x32_bf16 v[60:63], v[92:95], v[144:147], v[60:63]
    ds_read_b64_tr_b16 v[106:107], v164 offset:8640
    s_add_u32 s48, s61, 0
    s_add_u32 m0, s58, 115904
    s_nop 0
    buffer_load_dwordx4 v2, s[24:27], s48 offen lds
    v_add_u32 v250, v213, v212
    v_mul_u32_u24 v213, 2304, v211
    s_waitcnt lgkmcnt(6)
    v_mfma_f32_16x16x32_bf16 v[36:39], v[96:99], v[140:143], v[36:39]
    ds_read_b64_tr_b16 v[108:109], v164 offset:7696
    v_mfma_f32_16x16x32_bf16 v[64:67], v[96:99], v[144:147], v[64:67]
    ds_read_b64_tr_b16 v[110:111], v164 offset:8656
    v_add3_u32 v253, v213, v212, s10
    s_lshl_b32 s9, s8, 6
    s_waitcnt lgkmcnt(6)
    v_mfma_f32_16x16x32_bf16 v[40:43], v[100:103], v[140:143], v[40:43]
    ds_read_b64_tr_b16 v[112:113], v164 offset:7712
    v_mfma_f32_16x16x32_bf16 v[68:71], v[100:103], v[144:147], v[68:71]
    ds_read_b64_tr_b16 v[114:115], v164 offset:8672
    s_add_u32 s48, s61, 9216
    s_add_u32 m0, s58, 116928
    s_nop 0
    buffer_load_dwordx4 v2, s[24:27], s48 offen lds
    s_add_u32 s9, s9, 1024
    v_add_u32 v210, s9, v1
    s_waitcnt lgkmcnt(4)
    v_mfma_f32_16x16x32_bf16 v[16:19], v[104:107], v[148:151], v[16:19]
    ds_read_b64_tr_b16 v[116:117], v164 offset:7728
    v_mfma_f32_16x16x32_bf16 v[44:47], v[104:107], v[152:155], v[44:47]
    ds_read_b64_tr_b16 v[118:119], v164 offset:8688
    v_mul_u32_u24 v211, 3641, v210
    v_lshrrev_b32 v211, 16, v211
    s_waitcnt lgkmcnt(4)
    v_mfma_f32_16x16x32_bf16 v[20:23], v[108:111], v[148:151], v[20:23]
    ds_read_b64_tr_b16 v[120:121], v164 offset:7808
    v_mfma_f32_16x16x32_bf16 v[48:51], v[108:111], v[152:155], v[48:51]
    ds_read_b64_tr_b16 v[122:123], v164 offset:8768
    s_add_u32 s48, s61, 18432
    s_add_u32 m0, s58, 117952
    s_nop 0
    buffer_load_dwordx4 v2, s[24:27], s48 offen lds
    v_mul_u32_u24 v212, 18, v211
    v_sub_u32 v212, v210, v212
    s_waitcnt lgkmcnt(4)
    v_mfma_f32_16x16x32_bf16 v[24:27], v[112:115], v[148:151], v[24:27]
    ds_read_b64_tr_b16 v[124:125], v164 offset:7824
    v_mfma_f32_16x16x32_bf16 v[52:55], v[112:115], v[152:155], v[52:55]
    ds_read_b64_tr_b16 v[126:127], v164 offset:8784
    v_lshlrev_b32 v212, 4, v212
    v_mul_u32_u24 v213, 304, v211
    s_waitcnt lgkmcnt(4)
    v_mfma_f32_16x16x32_bf16 v[28:31], v[116:119], v[148:151], v[28:31]
    ds_read_b64_tr_b16 v[128:129], v165 offset:7680
    v_mfma_f32_16x16x32_bf16 v[56:59], v[116:119], v[152:155], v[56:59]
    ds_read_b64_tr_b16 v[130:131], v165 offset:8640
    s_add_u32 s48, s61, 27648
    s_add_u32 m0, s58, 118976
    s_nop 0
    buffer_load_dwordx4 v2, s[24:27], s48 offen lds
    v_add_u32 v251, v213, v212
    v_mul_u32_u24 v213, 2304, v211
    s_waitcnt lgkmcnt(4)
    v_mfma_f32_16x16x32_bf16 v[32:35], v[120:123], v[148:151], v[32:35]
    v_mfma_f32_16x16x32_bf16 v[60:63], v[120:123], v[152:155], v[60:63]
    v_add3_u32 v254, v213, v212, s10
    s_lshl_b32 s9, s5, 3
    s_waitcnt lgkmcnt(2)
    v_mfma_f32_16x16x32_bf16 v[36:39], v[124:127], v[148:151], v[36:39]
    v_mfma_f32_16x16x32_bf16 v[64:67], v[124:127], v[152:155], v[64:67]
    s_add_u32 s9, s9, s6
    s_lshl_b32 s9, s9, 3
    s_waitcnt lgkmcnt(0)
    v_mfma_f32_16x16x32_bf16 v[40:43], v[128:131], v[148:151], v[40:43]
    v_mfma_f32_16x16x32_bf16 v[68:71], v[128:131], v[152:155], v[68:71]
    s_add_u32 s9, s9, s8
    s_mul_i32 s9, s9, 40960
    s_waitcnt vmcnt(6)
    s_barrier
    ds_read_b128 v[140:143], v175 offset:0
    ds_read_b128 v[144:147], v175 offset:2048
    ds_read_b64_tr_b16 v[76:77], v172 offset:0
    ds_read_b64_tr_b16 v[78:79], v172 offset:960
    ds_read_b64_tr_b16 v[80:81], v172 offset:16
    ds_read_b64_tr_b16 v[82:83], v172 offset:976
    ds_read_b64_tr_b16 v[84:85], v172 offset:32
    ds_read_b64_tr_b16 v[86:87], v172 offset:992
    ds_read_b64_tr_b16 v[88:89], v172 offset:48
    ds_read_b64_tr_b16 v[90:91], v172 offset:1008
    s_waitcnt lgkmcnt(6)
    v_mfma_f32_16x16x32_bf16 v[16:19], v[76:79], v[140:143], v[16:19]
    ds_read_b64_tr_b16 v[92:93], v172 offset:128
    v_mov_b32 v8, 64
    s_nop 0
    buffer_load_dwordx2 v[6:7], v8, s[44:47], 0 offen sc1
    v_mfma_f32_16x16x32_bf16 v[44:47], v[76:79], v[144:147], v[44:47]
    ds_read_b64_tr_b16 v[94:95], v172 offset:1088
    s_mul_i32 s10, s68, 5120
    s_add_u32 s9, s9, s10
    s_waitcnt lgkmcnt(6)
    v_mfma_f32_16x16x32_bf16 v[20:23], v[80:83], v[140:143], v[20:23]
    ds_read_b64_tr_b16 v[96:97], v172 offset:144
    v_mfma_f32_16x16x32_bf16 v[48:51], v[80:83], v[144:147], v[48:51]
    ds_read_b64_tr_b16 v[98:99], v172 offset:1104
    v_lshlrev_b32 v210, 4, v1
    v_add_u32 v255, s9, v210
    s_waitcnt lgkmcnt(6)
    v_mfma_f32_16x16x32_bf16 v[24:27], v[84:87], v[140:143], v[24:27]
    ds_read_b64_tr_b16 v[100:101], v173 offset:0
    v_mfma_f32_16x16x32_bf16 v[52:55], v[84:87], v[144:147], v[52:55]
    ds_read_b64_tr_b16 v[102:103], v173 offset:960
    s_waitcnt lgkmcnt(6)
    v_mfma_f32_16x16x32_bf16 v[28:31], v[88:91], v[140:143], v[28:31]
    ds_read_b128 v[148:151], v176 offset:0
    v_mfma_f32_16x16x32_bf16 v[56:59], v[88:91], v[144:147], v[56:59]
    ds_read_b128 v[152:155], v176 offset:2048
    s_waitcnt lgkmcnt(6)
    v_mfma_f32_16x16x32_bf16 v[32:35], v[92:95], v[140:143], v[32:35]
    ds_read_b64_tr_b16 v[104:105], v172 offset:7680
    v_mfma_f32_16x16x32_bf16 v[60:63], v[92:95], v[144:147], v[60:63]
    ds_read_b64_tr_b16 v[106:107], v172 offset:8640
    s_waitcnt lgkmcnt(6)
    v_mfma_f32_16x16x32_bf16 v[36:39], v[96:99], v[140:143], v[36:39]
    ds_read_b64_tr_b16 v[108:109], v172 offset:7696
    v_mfma_f32_16x16x32_bf16 v[64:67], v[96:99], v[144:147], v[64:67]
    ds_read_b64_tr_b16 v[110:111], v172 offset:8656
    s_waitcnt lgkmcnt(6)
    v_mfma_f32_16x16x32_bf16 v[40:43], v[100:103], v[140:143], v[40:43]
    ds_read_b64_tr_b16 v[112:113], v172 offset:7712
    v_mfma_f32_16x16x32_bf16 v[68:71], v[100:103], v[144:147], v[68:71]
    ds_read_b64_tr_b16 v[114:115], v172 offset:8672
    s_waitcnt lgkmcnt(4)
    v_mfma_f32_16x16x32_bf16 v[16:19], v[104:107], v[148:151], v[16:19]
    ds_read_b64_tr_b16 v[116:117], v172 offset:7728
    v_mfma_f32_16x16x32_bf16 v[44:47], v[104:107], v[152:155], v[44:47]
    ds_read_b64_tr_b16 v[118:119], v172 offset:8688
    s_waitcnt lgkmcnt(4)
    v_mfma_f32_16x16x32_bf16 v[20:23], v[108:111], v[148:151], v[20:23]
    ds_read_b64_tr_b16 v[120:121], v172 offset:7808
    v_mfma_f32_16x16x32_bf16 v[48:51], v[108:111], v[152:155], v[48:51]
    ds_read_b64_tr_b16 v[122:123], v172 offset:8768
    s_waitcnt lgkmcnt(4)
    v_mfma_f32_16x16x32_bf16 v[24:27], v[112:115], v[148:151], v[24:27]
    ds_read_b64_tr_b16 v[124:125], v172 offset:7824
    v_mfma_f32_16x16x32_bf16 v[52:55], v[112:115], v[152:155], v[52:55]
    ds_read_b64_tr_b16 v[126:127], v172 offset:8784
    s_waitcnt lgkmcnt(4)
    v_mfma_f32_16x16x32_bf16 v[28:31], v[116:119], v[148:151], v[28:31]
    ds_read_b64_tr_b16 v[128:129], v173 offset:7680
    v_mfma_f32_16x16x32_bf16 v[56:59], v[116:119], v[152:155], v[56:59]
    ds_read_b64_tr_b16 v[130:131], v173 offset:8640
    s_waitcnt lgkmcnt(4)
    v_mfma_f32_16x16x32_bf16 v[32:35], v[120:123], v[148:151], v[32:35]
    v_mfma_f32_16x16x32_bf16 v[60:63], v[120:123], v[152:155], v[60:63]
    s_waitcnt lgkmcnt(2)
    v_mfma_f32_16x16x32_bf16 v[36:39], v[124:127], v[148:151], v[36:39]
    v_mfma_f32_16x16x32_bf16 v[64:67], v[124:127], v[152:155], v[64:67]
    s_waitcnt lgkmcnt(0)
    v_mfma_f32_16x16x32_bf16 v[40:43], v[128:131], v[148:151], v[40:43]
    v_mfma_f32_16x16x32_bf16 v[68:71], v[128:131], v[152:155], v[68:71]
    s_waitcnt vmcnt(1)
    s_barrier
    ds_read_b128 v[140:143], v183 offset:0
    ds_read_b128 v[144:147], v183 offset:2048
    ds_read_b64_tr_b16 v[76:77], v180 offset:0
    ds_read_b64_tr_b16 v[78:79], v180 offset:960
    ds_read_b64_tr_b16 v[80:81], v180 offset:16
    ds_read_b64_tr_b16 v[82:83], v180 offset:976
    ds_read_b64_tr_b16 v[84:85], v180 offset:32
    ds_read_b64_tr_b16 v[86:87], v180 offset:992
    ds_read_b64_tr_b16 v[88:89], v180 offset:48
    ds_read_b64_tr_b16 v[90:91], v180 offset:1008
    s_waitcnt lgkmcnt(6)
    v_mfma_f32_16x16x32_bf16 v[16:19], v[76:79], v[140:143], v[16:19]
    ds_read_b64_tr_b16 v[92:93], v180 offset:128
    v_mfma_f32_16x16x32_bf16 v[44:47], v[76:79], v[144:147], v[44:47]
    ds_read_b64_tr_b16 v[94:95], v180 offset:1088
    s_waitcnt lgkmcnt(6)
    v_mfma_f32_16x16x32_bf16 v[20:23], v[80:83], v[140:143], v[20:23]
    ds_read_b64_tr_b16 v[96:97], v180 offset:144
    v_mfma_f32_16x16x32_bf16 v[48:51], v[80:83], v[144:147], v[48:51]
    ds_read_b64_tr_b16 v[98:99], v180 offset:1104
    s_waitcnt lgkmcnt(6)
    v_mfma_f32_16x16x32_bf16 v[24:27], v[84:87], v[140:143], v[24:27]
    ds_read_b64_tr_b16 v[100:101], v181 offset:0
    v_mfma_f32_16x16x32_bf16 v[52:55], v[84:87], v[144:147], v[52:55]
    ds_read_b64_tr_b16 v[102:103], v181 offset:960
    s_waitcnt lgkmcnt(6)
    v_mfma_f32_16x16x32_bf16 v[28:31], v[88:91], v[140:143], v[28:31]
    ds_read_b128 v[148:151], v184 offset:0
    v_mfma_f32_16x16x32_bf16 v[56:59], v[88:91], v[144:147], v[56:59]
    ds_read_b128 v[152:155], v184 offset:2048
    s_waitcnt lgkmcnt(6)
    v_mfma_f32_16x16x32_bf16 v[32:35], v[92:95], v[140:143], v[32:35]
    ds_read_b64_tr_b16 v[104:105], v180 offset:7680
    v_mfma_f32_16x16x32_bf16 v[60:63], v[92:95], v[144:147], v[60:63]
    ds_read_b64_tr_b16 v[106:107], v180 offset:8640
    s_waitcnt lgkmcnt(6)
    v_mfma_f32_16x16x32_bf16 v[36:39], v[96:99], v[140:143], v[36:39]
    ds_read_b64_tr_b16 v[108:109], v180 offset:7696
    v_mfma_f32_16x16x32_bf16 v[64:67], v[96:99], v[144:147], v[64:67]
    ds_read_b64_tr_b16 v[110:111], v180 offset:8656
    s_waitcnt lgkmcnt(6)
    v_mfma_f32_16x16x32_bf16 v[40:43], v[100:103], v[140:143], v[40:43]
    ds_read_b64_tr_b16 v[112:113], v180 offset:7712
    v_mfma_f32_16x16x32_bf16 v[68:71], v[100:103], v[144:147], v[68:71]
    ds_read_b64_tr_b16 v[114:115], v180 offset:8672
    s_waitcnt lgkmcnt(4)
    v_mfma_f32_16x16x32_bf16 v[16:19], v[104:107], v[148:151], v[16:19]
    ds_read_b64_tr_b16 v[116:117], v180 offset:7728
    v_mfma_f32_16x16x32_bf16 v[44:47], v[104:107], v[152:155], v[44:47]
    ds_read_b64_tr_b16 v[118:119], v180 offset:8688
    s_waitcnt lgkmcnt(4)
    v_mfma_f32_16x16x32_bf16 v[20:23], v[108:111], v[148:151], v[20:23]
    ds_read_b64_tr_b16 v[120:121], v180 offset:7808
    v_mfma_f32_16x16x32_bf16 v[48:51], v[108:111], v[152:155], v[48:51]
    ds_read_b64_tr_b16 v[122:123], v180 offset:8768
    s_waitcnt lgkmcnt(4)
    v_mfma_f32_16x16x32_bf16 v[24:27], v[112:115], v[148:151], v[24:27]
    ds_read_b64_tr_b16 v[124:125], v180 offset:7824
    v_mfma_f32_16x16x32_bf16 v[52:55], v[112:115], v[152:155], v[52:55]
    ds_read_b64_tr_b16 v[126:127], v180 offset:8784
    s_waitcnt lgkmcnt(4)
    v_mfma_f32_16x16x32_bf16 v[28:31], v[116:119], v[148:151], v[28:31]
    ds_read_b64_tr_b16 v[128:129], v181 offset:7680
    v_mfma_f32_16x16x32_bf16 v[56:59], v[116:119], v[152:155], v[56:59]
    ds_read_b64_tr_b16 v[130:131], v181 offset:8640
    s_waitcnt lgkmcnt(4)
    v_mfma_f32_16x16x32_bf16 v[32:35], v[120:123], v[148:151], v[32:35]
    v_mfma_f32_16x16x32_bf16 v[60:63], v[120:123], v[152:155], v[60:63]
    s_waitcnt lgkmcnt(2)
    v_mfma_f32_16x16x32_bf16 v[36:39], v[124:127], v[148:151], v[36:39]
    v_mfma_f32_16x16x32_bf16 v[64:67], v[124:127], v[152:155], v[64:67]
    s_waitcnt lgkmcnt(0)
    v_mfma_f32_16x16x32_bf16 v[40:43], v[128:131], v[148:151], v[40:43]
    v_mfma_f32_16x16x32_bf16 v[68:71], v[128:131], v[152:155], v[68:71]
    s_branch L_Bepi
L_Bh:
    s_add_u32 s48, s60, 0
    s_add_u32 m0, s51, 0
    s_nop 0
    buffer_load_dwordx4 v5, s[28:31], s48 offen lds
    s_add_u32 s48, s60, 13824
    s_add_u32 m0, s51, 960
    s_nop 0
    buffer_load_dwordx4 v5, s[28:31], s48 offen lds
    s_add_u32 s48, s61, 0
    s_add_u32 m0, s58, 15424
    s_nop 0
    buffer_load_dwordx4 v2, s[24:27], s48 offen lds
    s_add_u32 s48, s61, 9216
    s_add_u32 m0, s58, 16448
    s_nop 0
    buffer_load_dwordx4 v2, s[24:27], s48 offen lds
    s_add_u32 s48, s61, 18432
    s_add_u32 m0, s58, 17472
    s_nop 0
    buffer_load_dwordx4 v2, s[24:27], s48 offen lds
    s_add_u32 s48, s61, 27648
    s_add_u32 m0, s58, 18496
    s_nop 0
    buffer_load_dwordx4 v2, s[24:27], s48 offen lds
    s_mov_b32 s48, s61
    s_add_u32 m0, s59, 15424
    s_nop 0
    buffer_load_dwordx4 v4, s[24:27], s48 offen lds
    s_mov_b64 s[56:57], s[68:69]
    s_mov_b64 s[16:17], s[70:71]
    s_mov_b32 s44, s52
    s_mov_b32 s45, s53
    s_mov_b32 s46, 256
    s_mov_b32 s47, 0x00020000
    s_mov_b32 s36, s54
    s_mov_b32 s37, s55
    s_mov_b32 s38, 5242880
    s_mov_b32 s39, 0x00020000
    s_add_u32 s76, s54, 7340032
    s_addc_u32 s77, s55, 0
    s_mov_b32 s78, 524288
    s_mov_b32 s79, 0x00020000
    v_lshl_add_u32 v16, v11, 3, v12
    v_mul_u32_u24 v16, 240, v16
    v_lshrrev_b32 v17, 1, v13
    v_lshl_add_u32 v17, v17, 6, v16
    v_and_b32 v18, 1, v13
    v_lshl_add_u32 v164, v18, 3, v17
    v_lshlrev_b32 v17, 3, v13
    v_add_u32 v17, 168, v17
    v_cmp_lt_u32 vcc, 1, v13
    v_mov_b32 v18, 232
    s_nop 0
    v_cndmask_b32 v17, v17, v18, vcc
    v_add_u32 v165, v16, v17
    s_and_b32 s9, s8, 1
    s_lshl_b32 s9, s9, 4
    s_and_b32 s11, s8, 2
    s_mul_i32 s11, s11, 48
    s_add_u32 s9, s9, s11
    s_add_u32 s9, s9, 32
    v_add_u32 v166, s9, v164
    s_cmp_eq_u32 s8, 4
    s_cselect_b64 vcc, -1, 0
    v_cndmask_b32 v166, v166, v165, vcc
    v_and_b32 v16, 7, v10
    v_xor_b32 v16, v16, v11
    v_lshlrev_b32 v16, 4, v16
    v_lshl_add_u32 v16, v10, 7, v16
    v_add_u32 v169, 15424, v16
    v_xor_b32 v17, 64, v16
    v_add_u32 v170, 15424, v17
    v_add_u32 v167, s58, v169
    v_add_u32 v168, s58, v170
    v_add_u32 v172, 50240, v164
    v_add_u32 v173, 50240, v165
    v_add_u32 v174, 50240, v166
    v_add_u32 v175, 50240, v167
    v_add_u32 v176, 50240, v168
    v_add_u32 v177, 50240, v169
    v_add_u32 v178, 50240, v170
    v_add_u32 v180, 100480, v164
    v_add_u32 v181, 100480, v165
    v_add_u32 v182, 100480, v166
    v_add_u32 v183, 100480, v167
    v_add_u32 v184, 100480, v168
    v_add_u32 v185, 100480, v169
    v_add_u32 v186, 100480, v170
    s_add_u32 s61, s61, 128
    s_add_u32 s60, s60, 221184
    s_cmp_eq_u32 s61, 1152
    s_cselect_b32 s61, 0, s61
    s_cselect_b32 s60, s50, s60
    s_add_u32 s48, s60, 0
    s_add_u32 m0, s51, 50240
    s_nop 0
    buffer_load_dwordx4 v5, s[28:31], s48 offen lds
    s_add_u32 s48, s60, 13824
    s_add_u32 m0, s51, 51200
    s_nop 0
    buffer_load_dwordx4 v5, s[28:31], s48 offen lds
    s_add_u32 s48, s61, 0
    s_add_u32 m0, s58, 65664
    s_nop 0
    buffer_load_dwordx4 v2, s[24:27], s48 offen lds
    s_add_u32 s48, s61, 9216
    s_add_u32 m0, s58, 66688
    s_nop 0
    buffer_load_dwordx4 v2, s[24:27], s48 offen lds
    s_add_u32 s48, s61, 18432
    s_add_u32 m0, s58, 67712
    s_nop 0
    buffer_load_dwordx4 v2, s[24:27], s48 offen lds
    s_add_u32 s48, s61, 27648
    s_add_u32 m0, s58, 68736
    s_nop 0
    buffer_load_dwordx4 v2, s[24:27], s48 offen lds
    s_mov_b32 s48, s61
    s_add_u32 m0, s59, 65664
    s_nop 0
    buffer_load_dwordx4 v4, s[24:27], s48 offen lds
    s_lshl_b32 s9, s4, 3
    s_add_u32 s9, s9, s8
    s_bfe_u32 s10, s3, 0x10001
    s_lshl_b32 s10, s10, 8
    s_add_u32 s10, s10, s9
    s_mul_i32 s10, s10, 4608
    v_mov_b32 v19, 0x80000000
    v_mul_u32_u24 v16, 1152, v1
    v_cmp_lt_u32 vcc, 3, v1
    v_add_u32 v16, s10, v16
    s_mul_i32 s10, s9, 9
    v_cndmask_b32 v226, v16, v19, vcc
    s_lshr_b32 s10, s10, 1
    v_add_u32 v16, s10, v1
    v_mul_u32_u24 v17, 3641, v16
    v_lshrrev_b32 v17, 16, v17
    v_mul_u32_u24 v18, 18, v17
    v_sub_u32 v18, v16, v18
    v_mul_u32_u24 v16, 11, v18
    v_lshrrev_b32 v16, 6, v16
    v_mul_u32_u24 v20, 6, v16
    v_sub_u32 v18, v18, v20
    v_lshlrev_b32 v18, 7, v18
    v_min_u32 v18, 572, v18
    v_mul_u32_u24 v16, 1152, v16
    v_mul_u32_u24 v17, 3456, v17
    v_add3_u32 v18, v18, v16, v17
    s_and_b32 s10, s3, 1
    s_mul_i32 s10, s10, 576
    v_cmp_lt_u32 vcc, 4, v1
    v_add_u32 v18, s10, v18
    s_mul_i32 s10, s9, 21
    v_cndmask_b32 v227, v18, v19, vcc
    v_add_u32 v16, s10, v1
    v_cmp_lt_u32 vcc, 20, v1
    v_lshlrev_b32 v16, 7, v16
    s_cmp_eq_u32 s5, 0
    s_cselect_b64 s[72:73], s[22:23], s[56:57]
    v_cndmask_b32 v228, v16, v19, vcc
    s_mov_b32 s74, 663552
    s_mov_b32 s75, 0x00020000
    s_waitcnt vmcnt(7)
    s_barrier
    ds_read_b128 v[140:143], v167 offset:0
    ds_read_b128 v[144:147], v167 offset:2048
    ds_read_b128 v[156:159], v169
    ds_read_b64_tr_b16 v[76:77], v164 offset:0
    ds_read_b64_tr_b16 v[78:79], v164 offset:960
    ds_read_b64_tr_b16 v[80:81], v164 offset:16
    ds_read_b64_tr_b16 v[82:83], v164 offset:976
    ds_read_b64_tr_b16 v[84:85], v164 offset:32
    ds_read_b64_tr_b16 v[86:87], v164 offset:992
    ds_read_b64_tr_b16 v[88:89], v164 offset:48
    ds_read_b64_tr_b16 v[90:91], v164 offset:1008
    s_waitcnt lgkmcnt(6)
    v_mfma_f32_16x16x32_bf16 v[16:19], v[76:79], v[140:143], 0
    ds_read_b64_tr_b16 v[92:93], v164 offset:128
    s_add_u32 s61, s61, 128
    s_add_u32 s60, s60, 221184
    s_cmp_eq_u32 s61, 1152
    s_cselect_b32 s61, 0, s61
    s_cselect_b32 s60, s50, s60
    s_add_u32 s48, s60, 0
    s_add_u32 m0, s51, 100480
    s_nop 0
    buffer_load_dwordx4 v5, s[28:31], s48 offen lds
    v_mfma_f32_16x16x32_bf16 v[44:47], v[76:79], v[144:147], 0
    ds_read_b64_tr_b16 v[94:95], v164 offset:1088
    s_lshl_b32 s9, s8, 5
    s_add_u32 s9, s9, 16
    s_waitcnt lgkmcnt(6)
    v_mfma_f32_16x16x32_bf16 v[20:23], v[80:83], v[140:143], 0
    ds_read_b64_tr_b16 v[96:97], v164 offset:144
    v_mfma_f32_16x16x32_bf16 v[48:51], v[80:83], v[144:147], 0
    ds_read_b64_tr_b16 v[98:99], v164 offset:1104
    v_add_u32 v210, s9, v10
    v_mul_u32_u24 v210, 216, v210
    s_waitcnt lgkmcnt(6)
    v_mfma_f32_16x16x32_bf16 v[24:27], v[84:87], v[140:143], 0
    ds_read_b64_tr_b16 v[100:101], v165 offset:0
    s_add_u32 s48, s60, 13824
    s_add_u32 m0, s51, 101440
    s_nop 0
    buffer_load_dwordx4 v5, s[28:31], s48 offen lds
    v_mfma_f32_16x16x32_bf16 v[52:55], v[84:87], v[144:147], 0
    ds_read_b64_tr_b16 v[102:103], v165 offset:960
    v_lshl_add_u32 v187, v11, 3, v210
    v_min_u32 v211, 2, v11
    s_waitcnt lgkmcnt(6)
    v_mfma_f32_16x16x32_bf16 v[28:31], v[88:91], v[140:143], 0
    ds_read_b64_tr_b16 v[132:133], v166 offset:0
    v_mfma_f32_16x16x32_bf16 v[56:59], v[88:91], v[144:147], 0
    ds_read_b64_tr_b16 v[134:135], v166 offset:960
    v_mul_u32_u24 v211, 72, v211
    v_add3_u32 v188, v210, v211, 64
    s_waitcnt lgkmcnt(6)
    v_mfma_f32_16x16x32_bf16 v[32:35], v[92:95], v[140:143], 0
    ds_read_b128 v[148:151], v168 offset:0
    s_add_u32 s48, s61, 0
    s_add_u32 m0, s58, 115904
    s_nop 0
    buffer_load_dwordx4 v2, s[24:27], s48 offen lds
    v_mfma_f32_16x16x32_bf16 v[60:63], v[92:95], v[144:147], 0
    ds_read_b128 v[152:155], v168 offset:2048
    v_mul_u32_u24 v212, 216, v10
    s_and_b32 s9, s8, 1
    s_waitcnt lgkmcnt(6)
    v_mfma_f32_16x16x32_bf16 v[36:39], v[96:99], v[140:143], 0
    ds_read_b128 v[160:163], v170
    v_mfma_f32_16x16x32_bf16 v[64:67], v[96:99], v[144:147], 0
    ds_read_b64_tr_b16 v[104:105], v164 offset:7680
    s_lshl_b32 s9, s9, 5
    s_and_b32 s11, s8, 2
    s_waitcnt lgkmcnt(6)
    v_mfma_f32_16x16x32_bf16 v[40:43], v[100:103], v[140:143], 0
    ds_read_b64_tr_b16 v[106:107], v164 offset:8640
    s_add_u32 s48, s61, 9216
    s_add_u32 m0, s58, 116928
    s_nop 0
    buffer_load_dwordx4 v2, s[24:27], s48 offen lds
    v_mfma_f32_16x16x32_bf16 v[68:71], v[100:103], v[144:147], 0
    ds_read_b64_tr_b16 v[108:109], v164 offset:7696
    s_mul_i32 s11, s11, 36
    s_add_u32 s9, s9, s11
    s_waitcnt lgkmcnt(6)
    v_mfma_f32_16x16x32_bf16 v[72:75], v[132:135], v[156:159], 0
    ds_read_b64_tr_b16 v[110:111], v164 offset:8656
    s_waitcnt lgkmcnt(2)
    v_mfma_f32_16x16x32_bf16 v[16:19], v[104:107], v[148:151], v[16:19]
    ds_read_b64_tr_b16 v[112:113], v164 offset:7712
    s_add_u32 s9, s9, 72
    v_lshl_add_u32 v213, v11, 3, v212
    v_mfma_f32_16x16x32_bf16 v[44:47], v[104:107], v[152:155], v[44:47]
    ds_read_b64_tr_b16 v[114:115], v164 offset:8672
    s_add_u32 s48, s61, 18432
    s_add_u32 m0, s58, 117952
    s_nop 0
    buffer_load_dwordx4 v2, s[24:27], s48 offen lds
    s_waitcnt lgkmcnt(2)
    v_mfma_f32_16x16x32_bf16 v[20:23], v[108:111], v[148:151], v[20:23]
    ds_read_b64_tr_b16 v[116:117], v164 offset:7728
    v_add_u32 v213, s9, v213
    v_add3_u32 v212, v212, v211, 64
    v_mfma_f32_16x16x32_bf16 v[48:51], v[108:111], v[152:155], v[48:51]
    ds_read_b64_tr_b16 v[118:119], v164 offset:8688
    s_waitcnt lgkmcnt(2)
    v_mfma_f32_16x16x32_bf16 v[24:27], v[112:115], v[148:151], v[24:27]
    ds_read_b64_tr_b16 v[120:121], v164 offset:7808
    s_cmp_eq_u32 s8, 4
    s_cselect_b64 vcc, -1, 0
    v_cndmask_b32 v189, v213, v212, vcc
    v_mfma_f32_16x16x32_bf16 v[52:55], v[112:115], v[152:155], v[52:55]
    ds_read_b64_tr_b16 v[122:123], v164 offset:8768
    s_add_u32 s48, s61, 27648
    s_add_u32 m0, s58, 118976
    s_nop 0
    buffer_load_dwordx4 v2, s[24:27], s48 offen lds
    s_waitcnt lgkmcnt(2)
    v_mfma_f32_16x16x32_bf16 v[28:31], v[116:119], v[148:151], v[28:31]
    ds_read_b64_tr_b16 v[124:125], v164 offset:7824
    v_and_b32 v210, 31, v1
    s_lshl_b32 s9, s8, 5
    v_mfma_f32_16x16x32_bf16 v[56:59], v[116:119], v[152:155], v[56:59]
    ds_read_b64_tr_b16 v[126:127], v164 offset:8784
    s_waitcnt lgkmcnt(2)
    v_mfma_f32_16x16x32_bf16 v[32:35], v[120:123], v[148:151], v[32:35]
    ds_read_b64_tr_b16 v[128:129], v165 offset:7680
    v_add_u32 v210, s9, v210
    v_lshrrev_b32 v211, 5, v1
    v_mfma_f32_16x16x32_bf16 v[60:63], v[120:123], v[152:155], v[60:63]
    ds_read_b64_tr_b16 v[130:131], v165 offset:8640
    s_mov_b32 s48, s61
    s_add_u32 m0, s59, 115904
    s_nop 0
    buffer_load_dwordx4 v4, s[24:27], s48 offen lds
    s_waitcnt lgkmcnt(2)
    v_mfma_f32_16x16x32_bf16 v[36:39], v[124:127], v[148:151], v[36:39]
    ds_read_b64_tr_b16 v[136:137], v166 offset:7680
    v_add_u32 v212, 2, v210
    v_mul_u32_u24 v212, 216, v212
    v_mfma_f32_16x16x32_bf16 v[64:67], v[124:127], v[152:155], v[64:67]
    ds_read_b64_tr_b16 v[138:139], v166 offset:8640
    s_waitcnt lgkmcnt(2)
    v_mfma_f32_16x16x32_bf16 v[40:43], v[128:131], v[148:151], v[40:43]
    v_mad_u32_u24 v190, v211, 40, v212
    v_lshl_add_u32 v213, v211, 2, v212
    v_mfma_f32_16x16x32_bf16 v[68:71], v[128:131], v[152:155], v[68:71]
    s_waitcnt lgkmcnt(0)
    v_mfma_f32_16x16x32_bf16 v[72:75], v[136:139], v[160:163], v[72:75]
    v_add_u32 v191, 32, v213
    s_lshl_b32 s9, s6, 8
    s_waitcnt vmcnt(7)
    s_barrier
    ds_read_b128 v[140:143], v175 offset:0
    ds_read_b128 v[144:147], v175 offset:2048
    ds_read_b128 v[156:159], v177
    ds_read_b64_tr_b16 v[76:77], v172 offset:0
    ds_read_b64_tr_b16 v[78:79], v172 offset:960
    ds_read_b64_tr_b16 v[80:81], v172 offset:16
    ds_read_b64_tr_b16 v[82:83], v172 offset:976
    ds_read_b64_tr_b16 v[84:85], v172 offset:32
    ds_read_b64_tr_b16 v[86:87], v172 offset:992
    ds_read_b64_tr_b16 v[88:89], v172 offset:48
    ds_read_b64_tr_b16 v[90:91], v172 offset:1008
    s_waitcnt lgkmcnt(6)
    v_mfma_f32_16x16x32_bf16 v[16:19], v[76:79], v[140:143], v[16:19]
    ds_read_b64_tr_b16 v[92:93], v172 offset:128
    s_add_u32 s61, s61, 128
    s_add_u32 s60, s60, 221184
    s_cmp_eq_u32 s61, 1152
    s_cselect_b32 s61, 0, s61
    s_cselect_b32 s60, s50, s60
    s_add_u32 s48, s60, 0
    s_add_u32 m0, s51, 0
    s_nop 0
    buffer_load_dwordx4 v5, s[28:31], s48 offen lds
    v_mfma_f32_16x16x32_bf16 v[44:47], v[76:79], v[144:147], v[44:47]
    ds_read_b64_tr_b16 v[94:95], v172 offset:1088
    v_add_u32 v192, s9, v210
    v_mul_u32_u24 v212, 80, v210
    s_waitcnt lgkmcnt(6)
    v_mfma_f32_16x16x32_bf16 v[20:23], v[80:83], v[140:143], v[20:23]
    ds_read_b64_tr_b16 v[96:97], v172 offset:144
    v_mfma_f32_16x16x32_bf16 v[48:51], v[80:83], v[144:147], v[48:51]
    ds_read_b64_tr_b16 v[98:99], v172 offset:1104
    v_add_u32 v212, 61440, v212
    v_mad_u32_u24 v193, v211, 40, v212
    s_waitcnt lgkmcnt(6)
    v_mfma_f32_16x16x32_bf16 v[24:27], v[84:87], v[140:143], v[24:27]
    ds_read_b64_tr_b16 v[100:101], v173 offset:0
    s_add_u32 s48, s60, 13824
    s_add_u32 m0, s51, 960
    s_nop 0
    buffer_load_dwordx4 v5, s[28:31], s48 offen lds
    v_mfma_f32_16x16x32_bf16 v[52:55], v[84:87], v[144:147], v[52:55]
    ds_read_b64_tr_b16 v[102:103], v173 offset:960
    v_lshl_add_u32 v213, v211, 2, v212
    v_add_u32 v194, 32, v213
    s_waitcnt lgkmcnt(6)
    v_mfma_f32_16x16x32_bf16 v[28:31], v[88:91], v[140:143], v[28:31]
    ds_read_b64_tr_b16 v[132:133], v174 offset:0
    v_mfma_f32_16x16x32_bf16 v[56:59], v[88:91], v[144:147], v[56:59]
    ds_read_b64_tr_b16 v[134:135], v174 offset:960
    s_lshr_b32 s66, s8, 2
    s_add_u32 s65, s8, s66
    s_waitcnt lgkmcnt(6)
    v_mfma_f32_16x16x32_bf16 v[32:35], v[92:95], v[140:143], v[32:35]
    ds_read_b128 v[148:151], v176 offset:0
    s_add_u32 s48, s61, 0
    s_add_u32 m0, s58, 15424
    s_nop 0
    buffer_load_dwordx4 v2, s[24:27], s48 offen lds
    v_mfma_f32_16x16x32_bf16 v[60:63], v[92:95], v[144:147], v[60:63]
    ds_read_b128 v[152:155], v176 offset:2048
    s_and_b32 s65, s65, 3
    s_and_b32 s67, s7, 3
    s_waitcnt lgkmcnt(6)
    v_mfma_f32_16x16x32_bf16 v[36:39], v[96:99], v[140:143], v[36:39]
    ds_read_b128 v[160:163], v178
    v_mfma_f32_16x16x32_bf16 v[64:67], v[96:99], v[144:147], v[64:67]
    ds_read_b64_tr_b16 v[104:105], v172 offset:7680
    s_lshr_b32 s68, s7, 2
    s_mul_i32 s10, s67, 288
    s_waitcnt lgkmcnt(6)
    v_mfma_f32_16x16x32_bf16 v[40:43], v[100:103], v[140:143], v[40:43]
    ds_read_b64_tr_b16 v[106:107], v172 offset:8640
    s_add_u32 s48, s61, 9216
    s_add_u32 m0, s58, 16448
    s_nop 0
    buffer_load_dwordx4 v2, s[24:27], s48 offen lds
    v_mfma_f32_16x16x32_bf16 v[68:71], v[100:103], v[144:147], v[68:71]
    ds_read_b64_tr_b16 v[108:109], v172 offset:7696
    v_mov_b32 v216, 0x80000000
    s_lshl_b32 s9, s8, 6
    s_waitcnt lgkmcnt(6)
    v_mfma_f32_16x16x32_bf16 v[72:75], v[132:135], v[156:159], v[72:75]
    ds_read_b64_tr_b16 v[110:111], v172 offset:8656
    s_waitcnt lgkmcnt(2)
    v_mfma_f32_16x16x32_bf16 v[16:19], v[104:107], v[148:151], v[16:19]
    ds_read_b64_tr_b16 v[112:113], v172 offset:7712
    s_add_u32 s9, s9, 0
    v_add_u32 v210, s9, v1
    v_mfma_f32_16x16x32_bf16 v[44:47], v[104:107], v[152:155], v[44:47]
    ds_read_b64_tr_b16 v[114:115], v172 offset:8672
    s_add_u32 s48, s61, 18432
    s_add_u32 m0, s58, 17472
    s_nop 0
    buffer_load_dwordx4 v2, s[24:27], s48 offen lds
    s_waitcnt lgkmcnt(2)
    v_mfma_f32_16x16x32_bf16 v[20:23], v[108:111], v[148:151], v[20:23]
    ds_read_b64_tr_b16 v[116:117], v172 offset:7728
    v_mul_u32_u24 v211, 1725, v210
    v_lshrrev_b32 v211, 18, v211
    v_mfma_f32_16x16x32_bf16 v[48:51], v[108:111], v[152:155], v[48:51]
    ds_read_b64_tr_b16 v[118:119], v172 offset:8688
    s_waitcnt lgkmcnt(2)
    v_mfma_f32_16x16x32_bf16 v[24:27], v[112:115], v[148:151], v[24:27]
    ds_read_b64_tr_b16 v[120:121], v172 offset:7808
    v_mul_u32_u24 v212, 152, v211
    v_sub_u32 v212, v210, v212
    v_mfma_f32_16x16x32_bf16 v[52:55], v[112:115], v[152:155], v[52:55]
    ds_read_b64_tr_b16 v[122:123], v172 offset:8768
    s_add_u32 s48, s61, 27648
    s_add_u32 m0, s58, 18496
    s_nop 0
    buffer_load_dwordx4 v2, s[24:27], s48 offen lds
    s_waitcnt lgkmcnt(2)
    v_mfma_f32_16x16x32_bf16 v[28:31], v[116:119], v[148:151], v[28:31]
    ds_read_b64_tr_b16 v[124:125], v172 offset:7824
    v_mul_u32_u24 v213, 3641, v212
    v_lshrrev_b32 v213, 16, v213
    v_mfma_f32_16x16x32_bf16 v[56:59], v[116:119], v[152:155], v[56:59]
    ds_read_b64_tr_b16 v[126:127], v172 offset:8784
    s_waitcnt lgkmcnt(2)
    v_mfma_f32_16x16x32_bf16 v[32:35], v[120:123], v[148:151], v[32:35]
    ds_read_b64_tr_b16 v[128:129], v173 offset:7680
    v_mul_u32_u24 v214, 18, v213
    v_sub_u32 v214, v212, v214
    v_mfma_f32_16x16x32_bf16 v[60:63], v[120:123], v[152:155], v[60:63]
    ds_read_b64_tr_b16 v[130:131], v173 offset:8640
    s_mov_b32 s48, s61
    s_add_u32 m0, s59, 15424
    s_nop 0
    buffer_load_dwordx4 v4, s[24:27], s48 offen lds
    s_waitcnt lgkmcnt(2)
    v_mfma_f32_16x16x32_bf16 v[36:39], v[124:127], v[148:151], v[36:39]
    ds_read_b64_tr_b16 v[136:137], v174 offset:7680
    v_cmp_lt_u32 vcc, 143, v212
    v_lshl_add_u32 v213, v211, 3, v213
    v_mfma_f32_16x16x32_bf16 v[64:67], v[124:127], v[152:155], v[64:67]
    ds_read_b64_tr_b16 v[138:139], v174 offset:8640
    s_waitcnt lgkmcnt(2)
    v_mfma_f32_16x16x32_bf16 v[40:43], v[128:131], v[148:151], v[40:43]
    v_lshlrev_b32 v214, 4, v214
    v_add_u32 v214, s10, v214
    v_mfma_f32_16x16x32_bf16 v[68:71], v[128:131], v[152:155], v[68:71]
    s_waitcnt lgkmcnt(0)
    v_mfma_f32_16x16x32_bf16 v[72:75], v[136:139], v[160:163], v[72:75]
    v_lshrrev_b32 v215, 5, v213
    v_lshl_add_u32 v215, v215, 2, v213
    s_waitcnt vmcnt(7)
    s_barrier
    ds_read_b128 v[140:143], v183 offset:0
    ds_read_b128 v[144:147], v183 offset:2048
    ds_read_b128 v[156:159], v185
    ds_read_b64_tr_b16 v[76:77], v180 offset:0
    ds_read_b64_tr_b16 v[78:79], v180 offset:960
    ds_read_b64_tr_b16 v[80:81], v180 offset:16
    ds_read_b64_tr_b16 v[82:83], v180 offset:976
    ds_read_b64_tr_b16 v[84:85], v180 offset:32
    ds_read_b64_tr_b16 v[86:87], v180 offset:992
    ds_read_b64_tr_b16 v[88:89], v180 offset:48
    ds_read_b64_tr_b16 v[90:91], v180 offset:1008
    s_waitcnt lgkmcnt(6)
    v_mfma_f32_16x16x32_bf16 v[16:19], v[76:79], v[140:143], v[16:19]
    ds_read_b64_tr_b16 v[92:93], v180 offset:128
    s_add_u32 s61, s61, 128
    s_add_u32 s60, s60, 221184
    s_cmp_eq_u32 s61, 1152
    s_cselect_b32 s61, 0, s61
    s_cselect_b32 s60, s50, s60
    s_add_u32 s48, s60, 0
    s_add_u32 m0, s51, 50240
    s_nop 0
    buffer_load_dwordx4 v5, s[28:31], s48 offen lds
    v_mfma_f32_16x16x32_bf16 v[44:47], v[76:79], v[144:147], v[44:47]
    ds_read_b64_tr_b16 v[94:95], v180 offset:1088
    v_mul_u32_u24 v215, 1152, v215
    v_add_u32 v215, v215, v214
    s_waitcnt lgkmcnt(6)
    v_mfma_f32_16x16x32_bf16 v[20:23], v[80:83], v[140:143], v[20:23]
    ds_read_b64_tr_b16 v[96:97], v180 offset:144
    v_mfma_f32_16x16x32_bf16 v[48:51], v[80:83], v[144:147], v[48:51]
    ds_read_b64_tr_b16 v[98:99], v180 offset:1104
    v_cndmask_b32 v232, v215, v216, vcc
    v_lshrrev_b32 v215, 2, v213
    s_waitcnt lgkmcnt(6)
    v_mfma_f32_16x16x32_bf16 v[24:27], v[84:87], v[140:143], v[24:27]
    ds_read_b64_tr_b16 v[100:101], v181 offset:0
    s_add_u32 s48, s60, 13824
    s_add_u32 m0, s51, 51200
    s_nop 0
    buffer_load_dwordx4 v5, s[28:31], s48 offen lds
    v_mfma_f32_16x16x32_bf16 v[52:55], v[84:87], v[144:147], v[52:55]
    ds_read_b64_tr_b16 v[102:103], v181 offset:960
    v_mul_u32_u24 v215, 36, v215
    v_and_b32 v213, 3, v213
    s_waitcnt lgkmcnt(6)
    v_mfma_f32_16x16x32_bf16 v[28:31], v[88:91], v[140:143], v[28:31]
    ds_read_b64_tr_b16 v[132:133], v182 offset:0
    v_mfma_f32_16x16x32_bf16 v[56:59], v[88:91], v[144:147], v[56:59]
    ds_read_b64_tr_b16 v[134:135], v182 offset:960
    v_add3_u32 v215, v215, v213, 32
    v_mul_u32_u24 v215, 1152, v215
    s_waitcnt lgkmcnt(6)
    v_mfma_f32_16x16x32_bf16 v[32:35], v[92:95], v[140:143], v[32:35]
    ds_read_b128 v[148:151], v184 offset:0
    s_add_u32 s48, s61, 0
    s_add_u32 m0, s58, 65664
    s_nop 0
    buffer_load_dwordx4 v2, s[24:27], s48 offen lds
    v_mfma_f32_16x16x32_bf16 v[60:63], v[92:95], v[144:147], v[60:63]
    ds_read_b128 v[152:155], v184 offset:2048
    v_add_u32 v215, v215, v214
    v_cndmask_b32 v235, v215, v216, vcc
    s_waitcnt lgkmcnt(6)
    v_mfma_f32_16x16x32_bf16 v[36:39], v[96:99], v[140:143], v[36:39]
    ds_read_b128 v[160:163], v186
    v_mfma_f32_16x16x32_bf16 v[64:67], v[96:99], v[144:147], v[64:67]
    ds_read_b64_tr_b16 v[104:105], v180 offset:7680
    s_lshl_b32 s9, s8, 6
    s_add_u32 s9, s9, 512
    s_waitcnt lgkmcnt(6)
    v_mfma_f32_16x16x32_bf16 v[40:43], v[100:103], v[140:143], v[40:43]
    ds_read_b64_tr_b16 v[106:107], v180 offset:8640
    s_add_u32 s48, s61, 9216
    s_add_u32 m0, s58, 66688
    s_nop 0
    buffer_load_dwordx4 v2, s[24:27], s48 offen lds
    v_mfma_f32_16x16x32_bf16 v[68:71], v[100:103], v[144:147], v[68:71]
    ds_read_b64_tr_b16 v[108:109], v180 offset:7696
    v_add_u32 v210, s9, v1
    v_mul_u32_u24 v211, 1725, v210
    s_waitcnt lgkmcnt(6)
    v_mfma_f32_16x16x32_bf16 v[72:75], v[132:135], v[156:159], v[72:75]
    ds_read_b64_tr_b16 v[110:111], v180 offset:8656
    s_waitcnt lgkmcnt(2)
    v_mfma_f32_16x16x32_bf16 v[16:19], v[104:107], v[148:151], v[16:19]
    ds_read_b64_tr_b16 v[112:113], v180 offset:7712
    v_lshrrev_b32 v211, 18, v211
    v_mul_u32_u24 v212, 152, v211
    v_mfma_f32_16x16x32_bf16 v[44:47], v[104:107], v[152:155], v[44:47]
    ds_read_b64_tr_b16 v[114:115], v180 offset:8672
    s_add_u32 s48, s61, 18432
    s_add_u32 m0, s58, 67712
    s_nop 0
    buffer_load_dwordx4 v2, s[24:27], s48 offen lds
    s_waitcnt lgkmcnt(2)
    v_mfma_f32_16x16x32_bf16 v[20:23], v[108:111], v[148:151], v[20:23]
    ds_read_b64_tr_b16 v[116:117], v180 offset:7728
    v_sub_u32 v212, v210, v212
    v_mul_u32_u24 v213, 3641, v212
    v_mfma_f32_16x16x32_bf16 v[48:51], v[108:111], v[152:155], v[48:51]
    ds_read_b64_tr_b16 v[118:119], v180 offset:8688
    s_waitcnt lgkmcnt(2)
    v_mfma_f32_16x16x32_bf16 v[24:27], v[112:115], v[148:151], v[24:27]
    ds_read_b64_tr_b16 v[120:121], v180 offset:7808
    v_lshrrev_b32 v213, 16, v213
    v_mul_u32_u24 v214, 18, v213
    v_mfma_f32_16x16x32_bf16 v[52:55], v[112:115], v[152:155], v[52:55]
    ds_read_b64_tr_b16 v[122:123], v180 offset:8768
    s_add_u32 s48, s61, 27648
    s_add_u32 m0, s58, 68736
    s_nop 0
    buffer_load_dwordx4 v2, s[24:27], s48 offen lds
    s_waitcnt lgkmcnt(2)
    v_mfma_f32_16x16x32_bf16 v[28:31], v[116:119], v[148:151], v[28:31]
    ds_read_b64_tr_b16 v[124:125], v180 offset:7824
    v_sub_u32 v214, v212, v214
    v_cmp_lt_u32 vcc, 143, v212
    v_mfma_f32_16x16x32_bf16 v[56:59], v[116:119], v[152:155], v[56:59]
    ds_read_b64_tr_b16 v[126:127], v180 offset:8784
    s_waitcnt lgkmcnt(2)
    v_mfma_f32_16x16x32_bf16 v[32:35], v[120:123], v[148:151], v[32:35]
    ds_read_b64_tr_b16 v[128:129], v181 offset:7680
    v_lshl_add_u32 v213, v211, 3, v213
    v_lshlrev_b32 v214, 4, v214
    v_mfma_f32_16x16x32_bf16 v[60:63], v[120:123], v[152:155], v[60:63]
    ds_read_b64_tr_b16 v[130:131], v181 offset:8640
    s_mov_b32 s48, s61
    s_add_u32 m0, s59, 65664
    s_nop 0
    buffer_load_dwordx4 v4, s[24:27], s48 offen lds
    s_waitcnt lgkmcnt(2)
    v_mfma_f32_16x16x32_bf16 v[36:39], v[124:127], v[148:151], v[36:39]
    ds_read_b64_tr_b16 v[136:137], v182 offset:7680
    v_add_u32 v214, s10, v214
    v_lshrrev_b32 v215, 5, v213
    v_mfma_f32_16x16x32_bf16 v[64:67], v[124:127], v[152:155], v[64:67]
    ds_read_b64_tr_b16 v[138:139], v182 offset:8640
    s_waitcnt lgkmcnt(2)
    v_mfma_f32_16x16x32_bf16 v[40:43], v[128:131], v[148:151], v[40:43]
    v_lshl_add_u32 v215, v215, 2, v213
    v_mul_u32_u24 v215, 1152, v215
    v_mfma_f32_16x16x32_bf16 v[68:71], v[128:131], v[152:155], v[68:71]
    s_waitcnt lgkmcnt(0)
    v_mfma_f32_16x16x32_bf16 v[72:75], v[136:139], v[160:163], v[72:75]
    v_add_u32 v215, v215, v214
    v_cndmask_b32 v233, v215, v216, vcc
    s_waitcnt vmcnt(7)
    s_barrier
    ds_read_b128 v[140:143], v167 offset:0
    ds_read_b128 v[144:147], v167 offset:2048
    ds_read_b128 v[156:159], v169
    ds_read_b64_tr_b16 v[76:77], v164 offset:0
    ds_read_b64_tr_b16 v[78:79], v164 offset:960
    ds_read_b64_tr_b16 v[80:81], v164 offset:16
    ds_read_b64_tr_b16 v[82:83], v164 offset:976
    ds_read_b64_tr_b16 v[84:85], v164 offset:32
    ds_read_b64_tr_b16 v[86:87], v164 offset:992
    ds_read_b64_tr_b16 v[88:89], v164 offset:48
    ds_read_b64_tr_b16 v[90:91], v164 offset:1008
    s_waitcnt lgkmcnt(6)
    v_mfma_f32_16x16x32_bf16 v[16:19], v[76:79], v[140:143], v[16:19]
    ds_read_b64_tr_b16 v[92:93], v164 offset:128
    s_add_u32 s61, s61, 128
    s_add_u32 s60, s60, 221184
    s_cmp_eq_u32 s61, 1152
    s_cselect_b32 s61, 0, s61
    s_cselect_b32 s60, s50, s60
    s_add_u32 s48, s60, 0
    s_add_u32 m0, s51, 100480
    s_nop 0
    buffer_load_dwordx4 v5, s[28:31], s48 offen lds
    v_mfma_f32_16x16x32_bf16 v[44:47], v[76:79], v[144:147], v[44:47]
    ds_read_b64_tr_b16 v[94:95], v164 offset:1088
    v_lshrrev_b32 v215, 2, v213
    v_mul_u32_u24 v215, 36, v215
    s_waitcnt lgkmcnt(6)
    v_mfma_f32_16x16x32_bf16 v[20:23], v[80:83], v[140:143], v[20:23]
    ds_read_b64_tr_b16 v[96:97], v164 offset:144
    v_mfma_f32_16x16x32_bf16 v[48:51], v[80:83], v[144:147], v[48:51]
    ds_read_b64_tr_b16 v[98:99], v164 offset:1104
    v_and_b32 v213, 3, v213
    v_add3_u32 v215, v215, v213, 32
    s_waitcnt lgkmcnt(6)
    v_mfma_f32_16x16x32_bf16 v[24:27], v[84:87], v[140:143], v[24:27]
    ds_read_b64_tr_b16 v[100:101], v165 offset:0
    s_add_u32 s48, s60, 13824
    s_add_u32 m0, s51, 101440
    s_nop 0
    buffer_load_dwordx4 v5, s[28:31], s48 offen lds
    v_mfma_f32_16x16x32_bf16 v[52:55], v[84:87], v[144:147], v[52:55]
    ds_read_b64_tr_b16 v[102:103], v165 offset:960
    v_mul_u32_u24 v215, 1152, v215
    v_add_u32 v215, v215, v214
    s_waitcnt lgkmcnt(6)
    v_mfma_f32_16x16x32_bf16 v[28:31], v[88:91], v[140:143], v[28:31]
    ds_read_b64_tr_b16 v[132:133], v166 offset:0
    v_mfma_f32_16x16x32_bf16 v[56:59], v[88:91], v[144:147], v[56:59]
    ds_read_b64_tr_b16 v[134:135], v166 offset:960
    s_add_u32 s48, s61, 0
    s_add_u32 m0, s58, 115904
    s_nop 0
    buffer_load_dwordx4 v2, s[24:27], s48 offen lds
    v_cndmask_b32 v236, v215, v216, vcc
    s_lshl_b32 s9, s8, 6
    s_waitcnt lgkmcnt(6)
    v_mfma_f32_16x16x32_bf16 v[32:35], v[92:95], v[140:143], v[32:35]
    ds_read_b128 v[148:151], v168 offset:0
    v_mfma_f32_16x16x32_bf16 v[60:63], v[92:95], v[144:147], v[60:63]
    ds_read_b128 v[152:155], v168 offset:2048
    s_add_u32 s9, s9, 1024
    v_add_u32 v210, s9, v1
    s_waitcnt lgkmcnt(6)
    v_mfma_f32_16x16x32_bf16 v[36:39], v[96:99], v[140:143], v[36:39]
    ds_read_b128 v[160:163], v170
    v_mfma_f32_16x16x32_bf16 v[64:67], v[96:99], v[144:147], v[64:67]
    ds_read_b64_tr_b16 v[104:105], v164 offset:7680
    s_add_u32 s48, s61, 9216
    s_add_u32 m0, s58, 116928
    s_nop 0
    buffer_load_dwordx4 v2, s[24:27], s48 offen lds
    v_mul_u32_u24 v211, 1725, v210
    v_lshrrev_b32 v211, 18, v211
    s_waitcnt lgkmcnt(6)
    v_mfma_f32_16x16x32_bf16 v[40:43], v[100:103], v[140:143], v[40:43]
    ds_read_b64_tr_b16 v[106:107], v164 offset:8640
    v_mfma_f32_16x16x32_bf16 v[68:71], v[100:103], v[144:147], v[68:71]
    ds_read_b64_tr_b16 v[108:109], v164 offset:7696
    v_mul_u32_u24 v212, 152, v211
    v_sub_u32 v212, v210, v212
    s_waitcnt lgkmcnt(6)
    v_mfma_f32_16x16x32_bf16 v[72:75], v[132:135], v[156:159], v[72:75]
    ds_read_b64_tr_b16 v[110:111], v164 offset:8656
    s_add_u32 s48, s61, 18432
    s_add_u32 m0, s58, 117952
    s_nop 0
    buffer_load_dwordx4 v2, s[24:27], s48 offen lds
    s_waitcnt lgkmcnt(2)
    v_mfma_f32_16x16x32_bf16 v[16:19], v[104:107], v[148:151], v[16:19]
    ds_read_b64_tr_b16 v[112:113], v164 offset:7712
    v_mul_u32_u24 v213, 3641, v212
    v_lshrrev_b32 v213, 16, v213
    v_mfma_f32_16x16x32_bf16 v[44:47], v[104:107], v[152:155], v[44:47]
    ds_read_b64_tr_b16 v[114:115], v164 offset:8672
    s_waitcnt lgkmcnt(2)
    v_mfma_f32_16x16x32_bf16 v[20:23], v[108:111], v[148:151], v[20:23]
    ds_read_b64_tr_b16 v[116:117], v164 offset:7728
    s_add_u32 s48, s61, 27648
    s_add_u32 m0, s58, 118976
    s_nop 0
    buffer_load_dwordx4 v2, s[24:27], s48 offen lds
    v_mul_u32_u24 v214, 18, v213
    v_sub_u32 v214, v212, v214
    v_mfma_f32_16x16x32_bf16 v[48:51], v[108:111], v[152:155], v[48:51]
    ds_read_b64_tr_b16 v[118:119], v164 offset:8688
    s_waitcnt lgkmcnt(2)
    v_mfma_f32_16x16x32_bf16 v[24:27], v[112:115], v[148:151], v[24:27]
    ds_read_b64_tr_b16 v[120:121], v164 offset:7808
    v_cmp_lt_u32 vcc, 143, v212
    v_lshl_add_u32 v213, v211, 3, v213
    v_mfma_f32_16x16x32_bf16 v[52:55], v[112:115], v[152:155], v[52:55]
    ds_read_b64_tr_b16 v[122:123], v164 offset:8768
    s_waitcnt lgkmcnt(2)
    v_mfma_f32_16x16x32_bf16 v[28:31], v[116:119], v[148:151], v[28:31]
    ds_read_b64_tr_b16 v[124:125], v164 offset:7824
    s_mov_b32 s48, s61
    s_add_u32 m0, s59, 115904
    s_nop 0
    buffer_load_dwordx4 v4, s[24:27], s48 offen lds
    v_lshlrev_b32 v214, 4, v214
    v_add_u32 v214, s10, v214
    v_mfma_f32_16x16x32_bf16 v[56:59], v[116:119], v[152:155], v[56:59]
    ds_read_b64_tr_b16 v[126:127], v164 offset:8784
    s_waitcnt lgkmcnt(2)
    v_mfma_f32_16x16x32_bf16 v[32:35], v[120:123], v[148:151], v[32:35]
    ds_read_b64_tr_b16 v[128:129], v165 offset:7680
    v_lshrrev_b32 v215, 5, v213
    v_lshl_add_u32 v215, v215, 2, v213
    v_mfma_f32_16x16x32_bf16 v[60:63], v[120:123], v[152:155], v[60:63]
    ds_read_b64_tr_b16 v[130:131], v165 offset:8640
    s_nop 0
    buffer_load_dword v229, v228, s[72:75], 0 offen
    s_waitcnt lgkmcnt(2)
    v_mfma_f32_16x16x32_bf16 v[36:39], v[124:127], v[148:151], v[36:39]
    ds_read_b64_tr_b16 v[136:137], v166 offset:7680
    v_mul_u32_u24 v215, 1152, v215
    v_add_u32 v215, v215, v214
    v_mfma_f32_16x16x32_bf16 v[64:67], v[124:127], v[152:155], v[64:67]
    ds_read_b64_tr_b16 v[138:139], v166 offset:8640
    s_waitcnt lgkmcnt(2)
    v_mfma_f32_16x16x32_bf16 v[40:43], v[128:131], v[148:151], v[40:43]
    v_cndmask_b32 v234, v215, v216, vcc
    v_lshrrev_b32 v215, 2, v213
    v_mfma_f32_16x16x32_bf16 v[68:71], v[128:131], v[152:155], v[68:71]
    s_waitcnt lgkmcnt(0)
    v_mfma_f32_16x16x32_bf16 v[72:75], v[136:139], v[160:163], v[72:75]
    v_mul_u32_u24 v215, 36, v215
    v_and_b32 v213, 3, v213
    s_waitcnt vmcnt(8)
    s_barrier
    ds_read_b128 v[140:143], v175 offset:0
    ds_read_b128 v[144:147], v175 offset:2048
    ds_read_b128 v[156:159], v177
    ds_read_b64_tr_b16 v[76:77], v172 offset:0
    ds_read_b64_tr_b16 v[78:79], v172 offset:960
    ds_read_b64_tr_b16 v[80:81], v172 offset:16
    ds_read_b64_tr_b16 v[82:83], v172 offset:976
    ds_read_b64_tr_b16 v[84:85], v172 offset:32
    ds_read_b64_tr_b16 v[86:87], v172 offset:992
    ds_read_b64_tr_b16 v[88:89], v172 offset:48
    ds_read_b64_tr_b16 v[90:91], v172 offset:1008
    s_waitcnt lgkmcnt(6)
    v_mfma_f32_16x16x32_bf16 v[16:19], v[76:79], v[140:143], v[16:19]
    ds_read_b64_tr_b16 v[92:93], v172 offset:128
    s_add_u32 s61, s61, 128
    s_add_u32 s60, s60, 221184
    s_cmp_eq_u32 s61, 1152
    s_cselect_b32 s61, 0, s61
    s_cselect_b32 s60, s50, s60
    s_add_u32 s48, s60, 0
    s_add_u32 m0, s51, 0
    s_nop 0
    buffer_load_dwordx4 v5, s[28:31], s48 offen lds
    v_mfma_f32_16x16x32_bf16 v[44:47], v[76:79], v[144:147], v[44:47]
    ds_read_b64_tr_b16 v[94:95], v172 offset:1088
    v_add3_u32 v215, v215, v213, 32
    v_mul_u32_u24 v215, 1152, v215
    s_waitcnt lgkmcnt(6)
    v_mfma_f32_16x16x32_bf16 v[20:23], v[80:83], v[140:143], v[20:23]
    ds_read_b64_tr_b16 v[96:97], v172 offset:144
    v_mfma_f32_16x16x32_bf16 v[48:51], v[80:83], v[144:147], v[48:51]
    ds_read_b64_tr_b16 v[98:99], v172 offset:1104
    v_add_u32 v215, v215, v214
    v_cndmask_b32 v237, v215, v216, vcc
    s_waitcnt lgkmcnt(6)
    v_mfma_f32_16x16x32_bf16 v[24:27], v[84:87], v[140:143], v[24:27]
    ds_read_b64_tr_b16 v[100:101], v173 offset:0
    s_add_u32 s48, s60, 13824
    s_add_u32 m0, s51, 960
    s_nop 0
    buffer_load_dwordx4 v5, s[28:31], s48 offen lds
    v_mfma_f32_16x16x32_bf16 v[52:55], v[84:87], v[144:147], v[52:55]
    ds_read_b64_tr_b16 v[102:103], v173 offset:960
    v_mul_u32_u24 v210, 2432, v11
    v_mul_u32_u24 v211, 288, v12
    s_waitcnt lgkmcnt(6)
    v_mfma_f32_16x16x32_bf16 v[28:31], v[88:91], v[140:143], v[28:31]
    ds_read_b64_tr_b16 v[132:133], v174 offset:0
    v_mfma_f32_16x16x32_bf16 v[56:59], v[88:91], v[144:147], v[56:59]
    ds_read_b64_tr_b16 v[134:135], v174 offset:960
    v_lshlrev_b32 v212, 3, v13
    v_add3_u32 v211, v210, v211, v212
    s_waitcnt lgkmcnt(6)
    v_mfma_f32_16x16x32_bf16 v[32:35], v[92:95], v[140:143], v[32:35]
    ds_read_b128 v[148:151], v176 offset:0
    s_add_u32 s48, s61, 0
    s_add_u32 m0, s58, 15424
    s_nop 0
    buffer_load_dwordx4 v2, s[24:27], s48 offen lds
    v_mfma_f32_16x16x32_bf16 v[60:63], v[92:95], v[144:147], v[60:63]
    ds_read_b128 v[152:155], v176 offset:2048
    s_lshl_b32 s9, s65, 6
    s_add_u32 s9, s9, 81920
    s_waitcnt lgkmcnt(6)
    v_mfma_f32_16x16x32_bf16 v[36:39], v[96:99], v[140:143], v[36:39]
    ds_read_b128 v[160:163], v178
    v_mfma_f32_16x16x32_bf16 v[64:67], v[96:99], v[144:147], v[64:67]
    ds_read_b64_tr_b16 v[104:105], v172 offset:7680
    v_add_u32 v238, s9, v211
    v_add_u32 v239, 82176, v211
    s_waitcnt lgkmcnt(6)
    v_mfma_f32_16x16x32_bf16 v[40:43], v[100:103], v[140:143], v[40:43]
    ds_read_b64_tr_b16 v[106:107], v172 offset:8640
    s_add_u32 s48, s61, 9216
    s_add_u32 m0, s58, 16448
    s_nop 0
    buffer_load_dwordx4 v2, s[24:27], s48 offen lds
    v_mfma_f32_16x16x32_bf16 v[68:71], v[100:103], v[144:147], v[68:71]
    ds_read_b64_tr_b16 v[108:109], v172 offset:7696
    v_add_u32 v240, 19456, v238
    v_add_u32 v241, 19456, v239
    s_waitcnt lgkmcnt(6)
    v_mfma_f32_16x16x32_bf16 v[72:75], v[132:135], v[156:159], v[72:75]
    ds_read_b64_tr_b16 v[110:111], v172 offset:8656
    s_waitcnt lgkmcnt(2)
    v_mfma_f32_16x16x32_bf16 v[16:19], v[104:107], v[148:151], v[16:19]
    ds_read_b64_tr_b16 v[112:113], v172 offset:7712
    v_add_u32 v242, 38912, v238
    v_add_u32 v243, 38912, v239
    v_mfma_f32_16x16x32_bf16 v[44:47], v[104:107], v[152:155], v[44:47]
    ds_read_b64_tr_b16 v[114:115], v172 offset:8672
    s_add_u32 s48, s61, 18432
    s_add_u32 m0, s58, 17472
    s_nop 0
    buffer_load_dwordx4 v2, s[24:27], s48 offen lds
    s_waitcnt lgkmcnt(2)
    v_mfma_f32_16x16x32_bf16 v[20:23], v[108:111], v[148:151], v[20:23]
    ds_read_b64_tr_b16 v[116:117], v172 offset:7728
    v_add_u32 v244, 58368, v238
    v_add_u32 v245, 58368, v239
    v_mfma_f32_16x16x32_bf16 v[48:51], v[108:111], v[152:155], v[48:51]
    ds_read_b64_tr_b16 v[118:119], v172 offset:8688
    s_waitcnt lgkmcnt(2)
    v_mfma_f32_16x16x32_bf16 v[24:27], v[112:115], v[148:151], v[24:27]
    ds_read_b64_tr_b16 v[120:121], v172 offset:7808
    s_lshl_b32 s9, s66, 5
    v_add_u32 v210, s9, v10
    v_mfma_f32_16x16x32_bf16 v[52:55], v[112:115], v[152:155], v[52:55]
    ds_read_b64_tr_b16 v[122:123], v172 offset:8768
    s_add_u32 s48, s61, 27648
    s_add_u32 m0, s58, 18496
    s_nop 0
    buffer_load_dwordx4 v2, s[24:27], s48 offen lds
    s_waitcnt lgkmcnt(2)
    v_mfma_f32_16x16x32_bf16 v[28:31], v[116:119], v[148:151], v[28:31]
    ds_read_b64_tr_b16 v[124:125], v172 offset:7824
    v_mul_u32_u24 v211, 80, v210
    v_lshl_add_u32 v246, v11, 4, v211
    v_mfma_f32_16x16x32_bf16 v[56:59], v[116:119], v[152:155], v[56:59]
    ds_read_b64_tr_b16 v[126:127], v172 offset:8784
    s_waitcnt lgkmcnt(2)
    v_mfma_f32_16x16x32_bf16 v[32:35], v[120:123], v[148:151], v[32:35]
    ds_read_b64_tr_b16 v[128:129], v173 offset:7680
    v_mul_u32_u24 v212, 10240, v11
    v_add3_u32 v247, v211, v212, 64
    v_mfma_f32_16x16x32_bf16 v[60:63], v[120:123], v[152:155], v[60:63]
    ds_read_b64_tr_b16 v[130:131], v173 offset:8640
    s_mov_b32 s48, s61
    s_add_u32 m0, s59, 15424
    s_nop 0
    buffer_load_dwordx4 v4, s[24:27], s48 offen lds
    s_waitcnt lgkmcnt(2)
    v_mfma_f32_16x16x32_bf16 v[36:39], v[124:127], v[148:151], v[36:39]
    ds_read_b64_tr_b16 v[136:137], v174 offset:7680
    v_mul_u32_u24 v211, 304, v210
    v_lshl_add_u32 v211, v11, 3, v211
    v_mfma_f32_16x16x32_bf16 v[64:67], v[124:127], v[152:155], v[64:67]
    ds_read_b64_tr_b16 v[138:139], v174 offset:8640
    s_waitcnt lgkmcnt(2)
    v_mfma_f32_16x16x32_bf16 v[40:43], v[128:131], v[148:151], v[40:43]
    s_lshl_b32 s9, s65, 6
    v_add_u32 v248, s9, v211
    v_mfma_f32_16x16x32_bf16 v[68:71], v[128:131], v[152:155], v[68:71]
    s_waitcnt lgkmcnt(0)
    v_mfma_f32_16x16x32_bf16 v[72:75], v[136:139], v[160:163], v[72:75]
    s_lshl_b32 s10, s6, 2
    s_add_u32 s10, s10, s68
    s_waitcnt vmcnt(8)
    s_barrier
    ds_read_b128 v[140:143], v183 offset:0
    ds_read_b128 v[144:147], v183 offset:2048
    ds_read_b128 v[156:159], v185
    ds_read_b64_tr_b16 v[76:77], v180 offset:0
    ds_read_b64_tr_b16 v[78:79], v180 offset:960
    ds_read_b64_tr_b16 v[80:81], v180 offset:16
    ds_read_b64_tr_b16 v[82:83], v180 offset:976
    ds_read_b64_tr_b16 v[84:85], v180 offset:32
    ds_read_b64_tr_b16 v[86:87], v180 offset:992
    ds_read_b64_tr_b16 v[88:89], v180 offset:48
    ds_read_b64_tr_b16 v[90:91], v180 offset:1008
    s_waitcnt lgkmcnt(6)
    v_mfma_f32_16x16x32_bf16 v[16:19], v[76:79], v[140:143], v[16:19]
    ds_read_b64_tr_b16 v[92:93], v180 offset:128
    s_add_u32 s61, s61, 128
    s_add_u32 s60, s60, 221184
    s_cmp_eq_u32 s61, 1152
    s_cselect_b32 s61, 0, s61
    s_cselect_b32 s60, s50, s60
    s_add_u32 s48, s60, 0
    s_add_u32 m0, s51, 50240
    s_nop 0
    buffer_load_dwordx4 v5, s[28:31], s48 offen lds
    v_mfma_f32_16x16x32_bf16 v[44:47], v[76:79], v[144:147], v[44:47]
    ds_read_b64_tr_b16 v[94:95], v180 offset:1088
    s_mul_i32 s10, s10, 147456
    s_mul_i32 s9, s5, 1152
    s_waitcnt lgkmcnt(6)
    v_mfma_f32_16x16x32_bf16 v[20:23], v[80:83], v[140:143], v[20:23]
    ds_read_b64_tr_b16 v[96:97], v180 offset:144
    v_mfma_f32_16x16x32_bf16 v[48:51], v[80:83], v[144:147], v[48:51]
    ds_read_b64_tr_b16 v[98:99], v180 offset:1104
    s_add_u32 s10, s10, s9
    s_mul_i32 s9, s67, 288
    s_waitcnt lgkmcnt(6)
    v_mfma_f32_16x16x32_bf16 v[24:27], v[84:87], v[140:143], v[24:27]
    ds_read_b64_tr_b16 v[100:101], v181 offset:0
    s_add_u32 s48, s60, 13824
    s_add_u32 m0, s51, 51200
    s_nop 0
    buffer_load_dwordx4 v5, s[28:31], s48 offen lds
    v_mfma_f32_16x16x32_bf16 v[52:55], v[84:87], v[144:147], v[52:55]
    ds_read_b64_tr_b16 v[102:103], v181 offset:960
    s_add_u32 s10, s10, s9
    s_lshl_b32 s9, s8, 6
    s_waitcnt lgkmcnt(6)
    v_mfma_f32_16x16x32_bf16 v[28:31], v[88:91], v[140:143], v[28:31]
    ds_read_b64_tr_b16 v[132:133], v182 offset:0
    v_mfma_f32_16x16x32_bf16 v[56:59], v[88:91], v[144:147], v[56:59]
    ds_read_b64_tr_b16 v[134:135], v182 offset:960
    s_add_u32 s9, s9, 0
    v_add_u32 v210, s9, v1
    s_waitcnt lgkmcnt(6)
    v_mfma_f32_16x16x32_bf16 v[32:35], v[92:95], v[140:143], v[32:35]
    ds_read_b128 v[148:151], v184 offset:0
    s_add_u32 s48, s61, 0
    s_add_u32 m0, s58, 65664
    s_nop 0
    buffer_load_dwordx4 v2, s[24:27], s48 offen lds
    v_mfma_f32_16x16x32_bf16 v[60:63], v[92:95], v[144:147], v[60:63]
    ds_read_b128 v[152:155], v184 offset:2048
    v_mul_u32_u24 v211, 3641, v210
    v_lshrrev_b32 v211, 16, v211
    s_waitcnt lgkmcnt(6)
    v_mfma_f32_16x16x32_bf16 v[36:39], v[96:99], v[140:143], v[36:39]
    ds_read_b128 v[160:163], v186
    v_mfma_f32_16x16x32_bf16 v[64:67], v[96:99], v[144:147], v[64:67]
    ds_read_b64_tr_b16 v[104:105], v180 offset:7680
    v_mul_u32_u24 v212, 18, v211
    v_sub_u32 v212, v210, v212
    s_waitcnt lgkmcnt(6)
    v_mfma_f32_16x16x32_bf16 v[40:43], v[100:103], v[140:143], v[40:43]
    ds_read_b64_tr_b16 v[106:107], v180 offset:8640
    s_add_u32 s48, s61, 9216
    s_add_u32 m0, s58, 66688
    s_nop 0
    buffer_load_dwordx4 v2, s[24:27], s48 offen lds
    v_mfma_f32_16x16x32_bf16 v[68:71], v[100:103], v[144:147], v[68:71]
    ds_read_b64_tr_b16 v[108:109], v180 offset:7696
    v_lshlrev_b32 v212, 4, v212
    v_mul_u32_u24 v213, 304, v211
    s_waitcnt lgkmcnt(6)
    v_mfma_f32_16x16x32_bf16 v[72:75], v[132:135], v[156:159], v[72:75]
    ds_read_b64_tr_b16 v[110:111], v180 offset:8656
    s_waitcnt lgkmcnt(2)
    v_mfma_f32_16x16x32_bf16 v[16:19], v[104:107], v[148:151], v[16:19]
    ds_read_b64_tr_b16 v[112:113], v180 offset:7712
    v_add_u32 v249, v213, v212
    v_mul_u32_u24 v213, 2304, v211
    v_mfma_f32_16x16x32_bf16 v[44:47], v[104:107], v[152:155], v[44:47]
    ds_read_b64_tr_b16 v[114:115], v180 offset:8672
    s_add_u32 s48, s61, 18432
    s_add_u32 m0, s58, 67712
    s_nop 0
    buffer_load_dwordx4 v2, s[24:27], s48 offen lds
    s_waitcnt lgkmcnt(2)
    v_mfma_f32_16x16x32_bf16 v[20:23], v[108:111], v[148:151], v[20:23]
    ds_read_b64_tr_b16 v[116:117], v180 offset:7728
    v_add3_u32 v252, v213, v212, s10
    s_lshl_b32 s9, s8, 6
    v_mfma_f32_16x16x32_bf16 v[48:51], v[108:111], v[152:155], v[48:51]
    ds_read_b64_tr_b16 v[118:119], v180 offset:8688
    s_waitcnt lgkmcnt(2)
    v_mfma_f32_16x16x32_bf16 v[24:27], v[112:115], v[148:151], v[24:27]
    ds_read_b64_tr_b16 v[120:121], v180 offset:7808
    s_add_u32 s9, s9, 512
    v_add_u32 v210, s9, v1
    v_mfma_f32_16x16x32_bf16 v[52:55], v[112:115], v[152:155], v[52:55]
    ds_read_b64_tr_b16 v[122:123], v180 offset:8768
    s_add_u32 s48, s61, 27648
    s_add_u32 m0, s58, 68736
    s_nop 0
    buffer_load_dwordx4 v2, s[24:27], s48 offen lds
    s_waitcnt lgkmcnt(2)
    v_mfma_f32_16x16x32_bf16 v[28:31], v[116:119], v[148:151], v[28:31]
    ds_read_b64_tr_b16 v[124:125], v180 offset:7824
    v_mul_u32_u24 v211, 3641, v210
    v_lshrrev_b32 v211, 16, v211
    v_mfma_f32_16x16x32_bf16 v[56:59], v[116:119], v[152:155], v[56:59]
    ds_read_b64_tr_b16 v[126:127], v180 offset:8784
    s_waitcnt lgkmcnt(2)
    v_mfma_f32_16x16x32_bf16 v[32:35], v[120:123], v[148:151], v[32:35]
    ds_read_b64_tr_b16 v[128:129], v181 offset:7680
    v_mul_u32_u24 v212, 18, v211
    v_sub_u32 v212, v210, v212
    v_mfma_f32_16x16x32_bf16 v[60:63], v[120:123], v[152:155], v[60:63]
    ds_read_b64_tr_b16 v[130:131], v181 offset:8640
    s_mov_b32 s48, s61
    s_add_u32 m0, s59, 65664
    s_nop 0
    buffer_load_dwordx4 v4, s[24:27], s48 offen lds
    s_waitcnt lgkmcnt(2)
    v_mfma_f32_16x16x32_bf16 v[36:39], v[124:127], v[148:151], v[36:39]
    ds_read_b64_tr_b16 v[136:137], v182 offset:7680
    v_lshlrev_b32 v212, 4, v212
    v_mul_u32_u24 v213, 304, v211
    v_mfma_f32_16x16x32_bf16 v[64:67], v[124:127], v[152:155], v[64:67]
    ds_read_b64_tr_b16 v[138:139], v182 offset:8640
    s_waitcnt lgkmcnt(2)
    v_mfma_f32_16x16x32_bf16 v[40:43], v[128:131], v[148:151], v[40:43]
    v_add_u32 v250, v213, v212
    v_mul_u32_u24 v213, 2304, v211
    v_mfma_f32_16x16x32_bf16 v[68:71], v[128:131], v[152:155], v[68:71]
    s_waitcnt lgkmcnt(0)
    v_mfma_f32_16x16x32_bf16 v[72:75], v[136:139], v[160:163], v[72:75]
    v_add3_u32 v253, v213, v212, s10
    s_lshl_b32 s9, s8, 6
    s_waitcnt vmcnt(7)
    s_barrier
    ds_read_b128 v[140:143], v167 offset:0
    ds_read_b128 v[144:147], v167 offset:2048
    ds_read_b128 v[156:159], v169
    ds_read_b64_tr_b16 v[76:77], v164 offset:0
    ds_read_b64_tr_b16 v[78:79], v164 offset:960
    ds_read_b64_tr_b16 v[80:81], v164 offset:16
    ds_read_b64_tr_b16 v[82:83], v164 offset:976
    ds_read_b64_tr_b16 v[84:85], v164 offset:32
    ds_read_b64_tr_b16 v[86:87], v164 offset:992
    ds_read_b64_tr_b16 v[88:89], v164 offset:48
    ds_read_b64_tr_b16 v[90:91], v164 offset:1008
    s_waitcnt lgkmcnt(6)
    v_mfma_f32_16x16x32_bf16 v[16:19], v[76:79], v[140:143], v[16:19]
    ds_read_b64_tr_b16 v[92:93], v164 offset:128
    s_add_u32 s61, s61, 128
    s_add_u32 s60, s60, 221184
    s_cmp_eq_u32 s61, 1152
    s_cselect_b32 s61, 0, s61
    s_cselect_b32 s60, s50, s60
    s_add_u32 s48, s60, 0
    s_add_u32 m0, s51, 100480
    s_nop 0
    buffer_load_dwordx4 v5, s[28:31], s48 offen lds
    v_mfma_f32_16x16x32_bf16 v[44:47], v[76:79], v[144:147], v[44:47]
    ds_read_b64_tr_b16 v[94:95], v164 offset:1088
    s_add_u32 s9, s9, 1024
    v_add_u32 v210, s9, v1
    s_waitcnt lgkmcnt(6)
    v_mfma_f32_16x16x32_bf16 v[20:23], v[80:83], v[140:143], v[20:23]
    ds_read_b64_tr_b16 v[96:97], v164 offset:144
    v_mfma_f32_16x16x32_bf16 v[48:51], v[80:83], v[144:147], v[48:51]
    ds_read_b64_tr_b16 v[98:99], v164 offset:1104
    v_mul_u32_u24 v211, 3641, v210
    v_lshrrev_b32 v211, 16, v211
    s_waitcnt lgkmcnt(6)
    v_mfma_f32_16x16x32_bf16 v[24:27], v[84:87], v[140:143], v[24:27]
    ds_read_b64_tr_b16 v[100:101], v165 offset:0
    s_add_u32 s48, s60, 13824
    s_add_u32 m0, s51, 101440
    s_nop 0
    buffer_load_dwordx4 v5, s[28:31], s48 offen lds
    v_mfma_f32_16x16x32_bf16 v[52:55], v[84:87], v[144:147], v[52:55]
    ds_read_b64_tr_b16 v[102:103], v165 offset:960
    v_mul_u32_u24 v212, 18, v211
    v_sub_u32 v212, v210, v212
    s_waitcnt lgkmcnt(6)
    v_mfma_f32_16x16x32_bf16 v[28:31], v[88:91], v[140:143], v[28:31]
    ds_read_b64_tr_b16 v[132:133], v166 offset:0
    v_mfma_f32_16x16x32_bf16 v[56:59], v[88:91], v[144:147], v[56:59]
    ds_read_b64_tr_b16 v[134:135], v166 offset:960
    v_lshlrev_b32 v212, 4, v212
    v_mul_u32_u24 v213, 304, v211
    s_waitcnt lgkmcnt(6)
    v_mfma_f32_16x16x32_bf16 v[32:35], v[92:95], v[140:143], v[32:35]
    ds_read_b128 v[148:151], v168 offset:0
    s_add_u32 s48, s61, 0
    s_add_u32 m0, s58, 115904
    s_nop 0
    buffer_load_dwordx4 v2, s[24:27], s48 offen lds
    v_mfma_f32_16x16x32_bf16 v[60:63], v[92:95], v[144:147], v[60:63]
    ds_read_b128 v[152:155], v168 offset:2048
    v_add_u32 v251, v213, v212
    v_mul_u32_u24 v213, 2304, v211
    s_waitcnt lgkmcnt(6)
    v_mfma_f32_16x16x32_bf16 v[36:39], v[96:99], v[140:143], v[36:39]
    ds_read_b128 v[160:163], v170
    v_mfma_f32_16x16x32_bf16 v[64:67], v[96:99], v[144:147], v[64:67]
    ds_read_b64_tr_b16 v[104:105], v164 offset:7680
    v_add3_u32 v254, v213, v212, s10
    s_lshl_b32 s9, s5, 3
    s_waitcnt lgkmcnt(6)
    v_mfma_f32_16x16x32_bf16 v[40:43], v[100:103], v[140:143], v[40:43]
    ds_read_b64_tr_b16 v[106:107], v164 offset:8640
    s_add_u32 s48, s61, 9216
    s_add_u32 m0, s58, 116928
    s_nop 0
    buffer_load_dwordx4 v2, s[24:27], s48 offen lds
    v_mfma_f32_16x16x32_bf16 v[68:71], v[100:103], v[144:147], v[68:71]
    ds_read_b64_tr_b16 v[108:109], v164 offset:7696
    s_add_u32 s9, s9, s6
    s_lshl_b32 s9, s9, 3
    s_waitcnt lgkmcnt(6)
    v_mfma_f32_16x16x32_bf16 v[72:75], v[132:135], v[156:159], v[72:75]
    ds_read_b64_tr_b16 v[110:111], v164 offset:8656
    s_waitcnt lgkmcnt(2)
    v_mfma_f32_16x16x32_bf16 v[16:19], v[104:107], v[148:151], v[16:19]
    ds_read_b64_tr_b16 v[112:113], v164 offset:7712
    s_add_u32 s9, s9, s8
    s_mul_i32 s9, s9, 40960
    v_mfma_f32_16x16x32_bf16 v[44:47], v[104:107], v[152:155], v[44:47]
    ds_read_b64_tr_b16 v[114:115], v164 offset:8672
    s_add_u32 s48, s61, 18432
    s_add_u32 m0, s58, 117952
    s_nop 0
    buffer_load_dwordx4 v2, s[24:27], s48 offen lds
    s_waitcnt lgkmcnt(2)
    v_mfma_f32_16x16x32_bf16 v[20:23], v[108:111], v[148:151], v[20:23]
    ds_read_b64_tr_b16 v[116:117], v164 offset:7728
    s_mul_i32 s10, s68, 5120
    s_add_u32 s9, s9, s10
    v_mfma_f32_16x16x32_bf16 v[48:51], v[108:111], v[152:155], v[48:51]
    ds_read_b64_tr_b16 v[118:119], v164 offset:8688
    s_waitcnt lgkmcnt(2)
    v_mfma_f32_16x16x32_bf16 v[24:27], v[112:115], v[148:151], v[24:27]
    ds_read_b64_tr_b16 v[120:121], v164 offset:7808
    v_lshlrev_b32 v210, 4, v1
    v_add_u32 v255, s9, v210
    v_mfma_f32_16x16x32_bf16 v[52:55], v[112:115], v[152:155], v[52:55]
    ds_read_b64_tr_b16 v[122:123], v164 offset:8768
    s_add_u32 s48, s61, 27648
    s_add_u32 m0, s58, 118976
    s_nop 0
    buffer_load_dwordx4 v2, s[24:27], s48 offen lds
    s_waitcnt lgkmcnt(2)
    v_mfma_f32_16x16x32_bf16 v[28:31], v[116:119], v[148:151], v[28:31]
    ds_read_b64_tr_b16 v[124:125], v164 offset:7824
    v_mfma_f32_16x16x32_bf16 v[56:59], v[116:119], v[152:155], v[56:59]
    ds_read_b64_tr_b16 v[126:127], v164 offset:8784
    s_waitcnt lgkmcnt(2)
    v_mfma_f32_16x16x32_bf16 v[32:35], v[120:123], v[148:151], v[32:35]
    ds_read_b64_tr_b16 v[128:129], v165 offset:7680
    v_mfma_f32_16x16x32_bf16 v[60:63], v[120:123], v[152:155], v[60:63]
    ds_read_b64_tr_b16 v[130:131], v165 offset:8640
    s_mov_b32 s48, s61
    s_add_u32 m0, s59, 115904
    s_nop 0
    buffer_load_dwordx4 v4, s[24:27], s48 offen lds
    s_waitcnt lgkmcnt(2)
    v_mfma_f32_16x16x32_bf16 v[36:39], v[124:127], v[148:151], v[36:39]
    ds_read_b64_tr_b16 v[136:137], v166 offset:7680
    v_mfma_f32_16x16x32_bf16 v[64:67], v[124:127], v[152:155], v[64:67]
    ds_read_b64_tr_b16 v[138:139], v166 offset:8640
    s_waitcnt lgkmcnt(2)
    v_mfma_f32_16x16x32_bf16 v[40:43], v[128:131], v[148:151], v[40:43]
    v_mfma_f32_16x16x32_bf16 v[68:71], v[128:131], v[152:155], v[68:71]
    s_waitcnt lgkmcnt(0)
    v_mfma_f32_16x16x32_bf16 v[72:75], v[136:139], v[160:163], v[72:75]
    s_waitcnt vmcnt(7)
    s_barrier
    ds_read_b128 v[140:143], v175 offset:0
    ds_read_b128 v[144:147], v175 offset:2048
    ds_read_b128 v[156:159], v177
    ds_read_b64_tr_b16 v[76:77], v172 offset:0
    ds_read_b64_tr_b16 v[78:79], v172 offset:960
    ds_read_b64_tr_b16 v[80:81], v172 offset:16
    ds_read_b64_tr_b16 v[82:83], v172 offset:976
    ds_read_b64_tr_b16 v[84:85], v172 offset:32
    ds_read_b64_tr_b16 v[86:87], v172 offset:992
    ds_read_b64_tr_b16 v[88:89], v172 offset:48
    ds_read_b64_tr_b16 v[90:91], v172 offset:1008
    s_waitcnt lgkmcnt(6)
    v_mfma_f32_16x16x32_bf16 v[16:19], v[76:79], v[140:143], v[16:19]
    ds_read_b64_tr_b16 v[92:93], v172 offset:128
    v_mov_b32 v8, 64
    s_nop 0
    buffer_load_dwordx2 v[6:7], v8, s[44:47], 0 offen sc1
    v_mfma_f32_16x16x32_bf16 v[44:47], v[76:79], v[144:147], v[44:47]
    ds_read_b64_tr_b16 v[94:95], v172 offset:1088
    s_waitcnt lgkmcnt(6)
    v_mfma_f32_16x16x32_bf16 v[20:23], v[80:83], v[140:143], v[20:23]
    ds_read_b64_tr_b16 v[96:97], v172 offset:144
    v_mfma_f32_16x16x32_bf16 v[48:51], v[80:83], v[144:147], v[48:51]
    ds_read_b64_tr_b16 v[98:99], v172 offset:1104
    s_waitcnt lgkmcnt(6)
    v_mfma_f32_16x16x32_bf16 v[24:27], v[84:87], v[140:143], v[24:27]
    ds_read_b64_tr_b16 v[100:101], v173 offset:0
    v_mfma_f32_16x16x32_bf16 v[52:55], v[84:87], v[144:147], v[52:55]
    ds_read_b64_tr_b16 v[102:103], v173 offset:960
    s_waitcnt lgkmcnt(6)
    v_mfma_f32_16x16x32_bf16 v[28:31], v[88:91], v[140:143], v[28:31]
    ds_read_b64_tr_b16 v[132:133], v174 offset:0
    v_mfma_f32_16x16x32_bf16 v[56:59], v[88:91], v[144:147], v[56:59]
    ds_read_b64_tr_b16 v[134:135], v174 offset:960
    s_waitcnt lgkmcnt(6)
    v_mfma_f32_16x16x32_bf16 v[32:35], v[92:95], v[140:143], v[32:35]
    ds_read_b128 v[148:151], v176 offset:0
    v_mfma_f32_16x16x32_bf16 v[60:63], v[92:95], v[144:147], v[60:63]
    ds_read_b128 v[152:155], v176 offset:2048
    s_waitcnt lgkmcnt(6)
    v_mfma_f32_16x16x32_bf16 v[36:39], v[96:99], v[140:143], v[36:39]
    ds_read_b128 v[160:163], v178
    v_mfma_f32_16x16x32_bf16 v[64:67], v[96:99], v[144:147], v[64:67]
    ds_read_b64_tr_b16 v[104:105], v172 offset:7680
    s_waitcnt lgkmcnt(6)
    v_mfma_f32_16x16x32_bf16 v[40:43], v[100:103], v[140:143], v[40:43]
    ds_read_b64_tr_b16 v[106:107], v172 offset:8640
    v_mfma_f32_16x16x32_bf16 v[68:71], v[100:103], v[144:147], v[68:71]
    ds_read_b64_tr_b16 v[108:109], v172 offset:7696
    s_waitcnt lgkmcnt(6)
    v_mfma_f32_16x16x32_bf16 v[72:75], v[132:135], v[156:159], v[72:75]
    ds_read_b64_tr_b16 v[110:111], v172 offset:8656
    s_waitcnt lgkmcnt(2)
    v_mfma_f32_16x16x32_bf16 v[16:19], v[104:107], v[148:151], v[16:19]
    ds_read_b64_tr_b16 v[112:113], v172 offset:7712
    v_mfma_f32_16x16x32_bf16 v[44:47], v[104:107], v[152:155], v[44:47]
    ds_read_b64_tr_b16 v[114:115], v172 offset:8672
    s_waitcnt lgkmcnt(2)
    v_mfma_f32_16x16x32_bf16 v[20:23], v[108:111], v[148:151], v[20:23]
    ds_read_b64_tr_b16 v[116:117], v172 offset:7728
    v_mfma_f32_16x16x32_bf16 v[48:51], v[108:111], v[152:155], v[48:51]
    ds_read_b64_tr_b16 v[118:119], v172 offset:8688
    s_waitcnt lgkmcnt(2)
    v_mfma_f32_16x16x32_bf16 v[24:27], v[112:115], v[148:151], v[24:27]
    ds_read_b64_tr_b16 v[120:121], v172 offset:7808
    v_mfma_f32_16x16x32_bf16 v[52:55], v[112:115], v[152:155], v[52:55]
    ds_read_b64_tr_b16 v[122:123], v172 offset:8768
    s_waitcnt lgkmcnt(2)
    v_mfma_f32_16x16x32_bf16 v[28:31], v[116:119], v[148:151], v[28:31]
    ds_read_b64_tr_b16 v[124:125], v172 offset:7824
    v_mfma_f32_16x16x32_bf16 v[56:59], v[116:119], v[152:155], v[56:59]
    ds_read_b64_tr_b16 v[126:127], v172 offset:8784
    s_waitcnt lgkmcnt(2)
    v_mfma_f32_16x16x32_bf16 v[32:35], v[120:123], v[148:151], v[32:35]
    ds_read_b64_tr_b16 v[128:129], v173 offset:7680
    v_mfma_f32_16x16x32_bf16 v[60:63], v[120:123], v[152:155], v[60:63]
    ds_read_b64_tr_b16 v[130:131], v173 offset:8640
    s_waitcnt lgkmcnt(2)
    v_mfma_f32_16x16x32_bf16 v[36:39], v[124:127], v[148:151], v[36:39]
    ds_read_b64_tr_b16 v[136:137], v174 offset:7680
    v_mfma_f32_16x16x32_bf16 v[64:67], v[124:127], v[152:155], v[64:67]
    ds_read_b64_tr_b16 v[138:139], v174 offset:8640
    s_waitcnt lgkmcnt(2)
    v_mfma_f32_16x16x32_bf16 v[40:43], v[128:131], v[148:151], v[40:43]
    v_mfma_f32_16x16x32_bf16 v[68:71], v[128:131], v[152:155], v[68:71]
    s_waitcnt lgkmcnt(0)
    v_mfma_f32_16x16x32_bf16 v[72:75], v[136:139], v[160:163], v[72:75]
    s_waitcnt vmcnt(1)
    s_barrier
    ds_read_b128 v[140:143], v183 offset:0
    ds_read_b128 v[144:147], v183 offset:2048
    ds_read_b128 v[156:159], v185
    ds_read_b64_tr_b16 v[76:77], v180 offset:0
    ds_read_b64_tr_b16 v[78:79], v180 offset:960
    ds_read_b64_tr_b16 v[80:81], v180 offset:16
    ds_read_b64_tr_b16 v[82:83], v180 offset:976
    ds_read_b64_tr_b16 v[84:85], v180 offset:32
    ds_read_b64_tr_b16 v[86:87], v180 offset:992
    ds_read_b64_tr_b16 v[88:89], v180 offset:48
    ds_read_b64_tr_b16 v[90:91], v180 offset:1008
    s_waitcnt lgkmcnt(6)
    v_mfma_f32_16x16x32_bf16 v[16:19], v[76:79], v[140:143], v[16:19]
    ds_read_b64_tr_b16 v[92:93], v180 offset:128
    v_mfma_f32_16x16x32_bf16 v[44:47], v[76:79], v[144:147], v[44:47]
    ds_read_b64_tr_b16 v[94:95], v180 offset:1088
    s_waitcnt lgkmcnt(6)
    v_mfma_f32_16x16x32_bf16 v[20:23], v[80:83], v[140:143], v[20:23]
    ds_read_b64_tr_b16 v[96:97], v180 offset:144
    v_mfma_f32_16x16x32_bf16 v[48:51], v[80:83], v[144:147], v[48:51]
    ds_read_b64_tr_b16 v[98:99], v180 offset:1104
    s_waitcnt lgkmcnt(6)
    v_mfma_f32_16x16x32_bf16 v[24:27], v[84:87], v[140:143], v[24:27]
    ds_read_b64_tr_b16 v[100:101], v181 offset:0
    v_mfma_f32_16x16x32_bf16 v[52:55], v[84:87], v[144:147], v[52:55]
    ds_read_b64_tr_b16 v[102:103], v181 offset:960
    s_waitcnt lgkmcnt(6)
    v_mfma_f32_16x16x32_bf16 v[28:31], v[88:91], v[140:143], v[28:31]
    ds_read_b64_tr_b16 v[132:133], v182 offset:0
    v_mfma_f32_16x16x32_bf16 v[56:59], v[88:91], v[144:147], v[56:59]
    ds_read_b64_tr_b16 v[134:135], v182 offset:960
    s_waitcnt lgkmcnt(6)
    v_mfma_f32_16x16x32_bf16 v[32:35], v[92:95], v[140:143], v[32:35]
    ds_read_b128 v[148:151], v184 offset:0
    v_mfma_f32_16x16x32_bf16 v[60:63], v[92:95], v[144:147], v[60:63]
    ds_read_b128 v[152:155], v184 offset:2048
    s_waitcnt lgkmcnt(6)
    v_mfma_f32_16x16x32_bf16 v[36:39], v[96:99], v[140:143], v[36:39]
    ds_read_b128 v[160:163], v186
    v_mfma_f32_16x16x32_bf16 v[64:67], v[96:99], v[144:147], v[64:67]
    ds_read_b64_tr_b16 v[104:105], v180 offset:7680
    s_waitcnt lgkmcnt(6)
    v_mfma_f32_16x16x32_bf16 v[40:43], v[100:103], v[140:143], v[40:43]
    ds_read_b64_tr_b16 v[106:107], v180 offset:8640
    v_mfma_f32_16x16x32_bf16 v[68:71], v[100:103], v[144:147], v[68:71]
    ds_read_b64_tr_b16 v[108:109], v180 offset:7696
    s_waitcnt lgkmcnt(6)
    v_mfma_f32_16x16x32_bf16 v[72:75], v[132:135], v[156:159], v[72:75]
    ds_read_b64_tr_b16 v[110:111], v180 offset:8656
    s_waitcnt lgkmcnt(2)
    v_mfma_f32_16x16x32_bf16 v[16:19], v[104:107], v[148:151], v[16:19]
    ds_read_b64_tr_b16 v[112:113], v180 offset:7712
    v_mfma_f32_16x16x32_bf16 v[44:47], v[104:107], v[152:155], v[44:47]
    ds_read_b64_tr_b16 v[114:115], v180 offset:8672
    s_waitcnt lgkmcnt(2)
    v_mfma_f32_16x16x32_bf16 v[20:23], v[108:111], v[148:151], v[20:23]
    ds_read_b64_tr_b16 v[116:117], v180 offset:7728
    v_mfma_f32_16x16x32_bf16 v[48:51], v[108:111], v[152:155], v[48:51]
    ds_read_b64_tr_b16 v[118:119], v180 offset:8688
    s_waitcnt lgkmcnt(2)
    v_mfma_f32_16x16x32_bf16 v[24:27], v[112:115], v[148:151], v[24:27]
    ds_read_b64_tr_b16 v[120:121], v180 offset:7808
    v_mfma_f32_16x16x32_bf16 v[52:55], v[112:115], v[152:155], v[52:55]
    ds_read_b64_tr_b16 v[122:123], v180 offset:8768
    s_waitcnt lgkmcnt(2)
    v_mfma_f32_16x16x32_bf16 v[28:31], v[116:119], v[148:151], v[28:31]
    ds_read_b64_tr_b16 v[124:125], v180 offset:7824
    v_mfma_f32_16x16x32_bf16 v[56:59], v[116:119], v[152:155], v[56:59]
    ds_read_b64_tr_b16 v[126:127], v180 offset:8784
    s_waitcnt lgkmcnt(2)
    v_mfma_f32_16x16x32_bf16 v[32:35], v[120:123], v[148:151], v[32:35]
    ds_read_b64_tr_b16 v[128:129], v181 offset:7680
    v_mfma_f32_16x16x32_bf16 v[60:63], v[120:123], v[152:155], v[60:63]
    ds_read_b64_tr_b16 v[130:131], v181 offset:8640
    s_waitcnt lgkmcnt(2)
    v_mfma_f32_16x16x32_bf16 v[36:39], v[124:127], v[148:151], v[36:39]
    ds_read_b64_tr_b16 v[136:137], v182 offset:7680
    v_mfma_f32_16x16x32_bf16 v[64:67], v[124:127], v[152:155], v[64:67]
    ds_read_b64_tr_b16 v[138:139], v182 offset:8640
    s_waitcnt lgkmcnt(2)
    v_mfma_f32_16x16x32_bf16 v[40:43], v[128:131], v[148:151], v[40:43]
    v_mfma_f32_16x16x32_bf16 v[68:71], v[128:131], v[152:155], v[68:71]
    s_waitcnt lgkmcnt(0)
    v_mfma_f32_16x16x32_bf16 v[72:75], v[136:139], v[160:163], v[72:75]
L_Bepi:
    s_nop 7
    v_cvt_pk_bf16_f32 v76, v16, v17
    v_cvt_pk_bf16_f32 v77, v18, v19
    v_cvt_pk_bf16_f32 v78, v20, v21
    v_cvt_pk_bf16_f32 v79, v22, v23
    v_cvt_pk_bf16_f32 v80, v24, v25
    v_cvt_pk_bf16_f32 v81, v26, v27
    v_cvt_pk_bf16_f32 v82, v28, v29
    v_cvt_pk_bf16_f32 v83, v30, v31
    v_cvt_pk_bf16_f32 v84, v32, v33
    v_cvt_pk_bf16_f32 v85, v34, v35
    v_cvt_pk_bf16_f32 v86, v36, v37
    v_cvt_pk_bf16_f32 v87, v38, v39
    v_cvt_pk_bf16_f32 v88, v40, v41
    v_cvt_pk_bf16_f32 v89, v42, v43
    v_cvt_pk_bf16_f32 v90, v44, v45
    v_cvt_pk_bf16_f32 v91, v46, v47
    v_cvt_pk_bf16_f32 v92, v48, v49
    v_cvt_pk_bf16_f32 v93, v50, v51
    v_cvt_pk_bf16_f32 v94, v52, v53
    v_cvt_pk_bf16_f32 v95, v54, v55
    v_cvt_pk_bf16_f32 v96, v56, v57
    v_cvt_pk_bf16_f32 v97, v58, v59
    v_cvt_pk_bf16_f32 v98, v60, v61
    v_cvt_pk_bf16_f32 v99, v62, v63
    v_cvt_pk_bf16_f32 v100, v64, v65
    v_cvt_pk_bf16_f32 v101, v66, v67
    v_cvt_pk_bf16_f32 v102, v68, v69
    v_cvt_pk_bf16_f32 v103, v70, v71
    v_cvt_pk_bf16_f32 v104, v72, v73
    v_cvt_pk_bf16_f32 v105, v74, v75
    ds_write_b64 v187, v[76:77] offset:0
    ds_write_b64 v187, v[78:79] offset:32
    ds_write_b64 v187, v[80:81] offset:72
    ds_write_b64 v187, v[82:83] offset:104
    ds_write_b64 v187, v[84:85] offset:144
    ds_write_b64 v187, v[86:87] offset:176
    ds_write_b64 v188, v[88:89] offset:0
    ds_write_b64 v187, v[90:91] offset:3456
    ds_write_b64 v187, v[92:93] offset:3488
    ds_write_b64 v187, v[94:95] offset:3528
    ds_write_b64 v187, v[96:97] offset:3560
    ds_write_b64 v187, v[98:99] offset:3600
    ds_write_b64 v187, v[100:101] offset:3632
    ds_write_b64 v188, v[102:103] offset:3456
    s_cmp_ge_u32 s8, 5
    s_cbranch_scc1 L_B_nohalo
    ds_write_b64 v189, v[104:105]
L_B_nohalo:
    s_waitcnt lgkmcnt(0)
    s_barrier
    ds_read_b64 v[16:17], v190 offset:3024
    ds_read_b64 v[18:19], v190 offset:3032
    ds_read_b64 v[20:21], v190 offset:3040
    ds_read_b64 v[22:23], v190 offset:3048
    ds_read_b32 v24, v191 offset:3024
    ds_read_b64 v[26:27], v190 offset:3096
    ds_read_b64 v[28:29], v190 offset:3104
    ds_read_b64 v[30:31], v190 offset:3112
    ds_read_b64 v[32:33], v190 offset:3120
    ds_read_b32 v34, v191 offset:3096
    ds_read_b64 v[36:37], v190 offset:2664
    ds_read_b64 v[38:39], v190 offset:2672
    ds_read_b64 v[40:41], v190 offset:2680
    ds_read_b64 v[42:43], v190 offset:2688
    ds_read_b32 v44, v191 offset:2664
    ds_read_b64 v[46:47], v190 offset:2232
    ds_read_b64 v[48:49], v190 offset:2240
    ds_read_b64 v[50:51], v190 offset:2248
    ds_read_b64 v[52:53], v190 offset:2256
    ds_read_b32 v54, v191 offset:2232
    ds_read_b64 v[56:57], v190 offset:1800
    ds_read_b64 v[58:59], v190 offset:1808
    ds_read_b64 v[60:61], v190 offset:1816
    ds_read_b64 v[62:63], v190 offset:1824
    ds_read_b32 v64, v191 offset:1800
    ds_read_b64 v[66:67], v190 offset:1368
    ds_read_b64 v[68:69], v190 offset:1376
    ds_read_b64 v[70:71], v190 offset:1384
    ds_read_b64 v[72:73], v190 offset:1392
    ds_read_b32 v74, v191 offset:1368
    ds_read_b64 v[76:77], v190 offset:936
    ds_read_b64 v[78:79], v190 offset:944
    ds_read_b64 v[80:81], v190 offset:952
    ds_read_b64 v[82:83], v190 offset:960
    ds_read_b32 v84, v191 offset:936
    ds_read_b64 v[86:87], v190 offset:504
    ds_read_b64 v[88:89], v190 offset:512
    ds_read_b64 v[90:91], v190 offset:520
    ds_read_b64 v[92:93], v190 offset:528
    ds_read_b32 v94, v191 offset:504
    ds_read_b64 v[96:97], v190 offset:72
    ds_read_b64 v[98:99], v190 offset:80
    ds_read_b64 v[100:101], v190 offset:88
    ds_read_b64 v[102:103], v190 offset:96
    ds_read_b32 v104, v191 offset:72
    s_cmp_eq_u32 s5, 0
    s_cselect_b64 s[22:23], s[22:23], s[56:57]
    s_mov_b32 s24, s22
    s_mov_b32 s25, s23
    s_mov_b32 s26, 663552
    s_mov_b32 s27, 0x00020000
    s_mov_b32 s28, s16
    s_mov_b32 s29, s17
    s_mov_b32 s30, 4718592
    s_mov_b32 s31, 0x00020000
    s_lshl_b32 s51, s8, 10
    s_mov_b32 s49, s65
    s_mov_b32 s48, 0
    s_add_u32 m0, s51, 81920
    s_nop 0
    buffer_load_dwordx4 v232, s[24:27], s48 offen lds
    s_mov_b32 s48, 0
    s_add_u32 m0, s51, 90112
    s_nop 0
    buffer_load_dwordx4 v233, s[24:27], s48 offen lds
    s_cmp_ge_u32 s8, 3
    s_cbranch_scc1 L_Bp_nd0
    s_mov_b32 s48, 0
    s_add_u32 m0, s51, 98304
    s_nop 0
    buffer_load_dwordx4 v234, s[24:27], s48 offen lds
L_Bp_nd0:
    s_mov_b32 s48, 82944
    s_add_u32 m0, s51, 101376
    s_nop 0
    buffer_load_dwordx4 v232, s[24:27], s48 offen lds
    s_mov_b32 s48, 82944
    s_add_u32 m0, s51, 109568
    s_nop 0
    buffer_load_dwordx4 v233, s[24:27], s48 offen lds
    s_cmp_ge_u32 s8, 3
    s_cbranch_scc1 L_Bp_nd1
    s_mov_b32 s48, 82944
    s_add_u32 m0, s51, 117760
    s_nop 0
    buffer_load_dwordx4 v234, s[24:27], s48 offen lds
L_Bp_nd1:
    s_mov_b32 s48, 165888
    s_add_u32 m0, s51, 120832
    s_nop 0
    buffer_load_dwordx4 v232, s[24:27], s48 offen lds
    s_mov_b32 s48, 165888
    s_add_u32 m0, s51, 129024
    s_nop 0
    buffer_load_dwordx4 v233, s[24:27], s48 offen lds
    s_cmp_ge_u32 s8, 3
    s_cbranch_scc1 L_Bp_nd2
    s_mov_b32 s48, 165888
    s_add_u32 m0, s51, 137216
    s_nop 0
    buffer_load_dwordx4 v234, s[24:27], s48 offen lds
L_Bp_nd2:
    s_mov_b32 s48, 248832
    s_add_u32 m0, s51, 140288
    s_nop 0
    buffer_load_dwordx4 v232, s[24:27], s48 offen lds
    s_mov_b32 s48, 248832
    s_add_u32 m0, s51, 148480
    s_nop 0
    buffer_load_dwordx4 v233, s[24:27], s48 offen lds
    s_cmp_ge_u32 s8, 3
    s_cbranch_scc1 L_Bp_nd3
    s_mov_b32 s48, 248832
    s_add_u32 m0, s51, 156672
    s_nop 0
    buffer_load_dwordx4 v234, s[24:27], s48 offen lds
L_Bp_nd3:
    ds_read_b64 v[106:107], v190 offset:3168
    ds_read_b64 v[108:109], v190 offset:3176
    ds_read_b64 v[110:111], v190 offset:3184
    ds_read_b64 v[112:113], v190 offset:3192
    ds_read_b32 v114, v191 offset:3168
    ds_read_b64 v[116:117], v190 offset:2736
    ds_read_b64 v[118:119], v190 offset:2744
    ds_read_b64 v[120:121], v190 offset:2752
    ds_read_b64 v[122:123], v190 offset:2760
    ds_read_b32 v124, v191 offset:2736
    ds_read_b64 v[126:127], v190 offset:2304
    ds_read_b64 v[128:129], v190 offset:2312
    ds_read_b64 v[130:131], v190 offset:2320
    ds_read_b64 v[132:133], v190 offset:2328
    ds_read_b32 v134, v191 offset:2304
    ds_read_b64 v[136:137], v190 offset:1872
    ds_read_b64 v[138:139], v190 offset:1880
    ds_read_b64 v[140:141], v190 offset:1888
    ds_read_b64 v[142:143], v190 offset:1896
    ds_read_b32 v144, v191 offset:1872
    ds_read_b64 v[146:147], v190 offset:1440
    ds_read_b64 v[148:149], v190 offset:1448
    ds_read_b64 v[150:151], v190 offset:1456
    ds_read_b64 v[152:153], v190 offset:1464
    ds_read_b32 v154, v191 offset:1440
    ds_read_b64 v[156:157], v190 offset:1008
    ds_read_b64 v[158:159], v190 offset:1016
    ds_read_b64 v[160:161], v190 offset:1024
    ds_read_b64 v[162:163], v190 offset:1032
    ds_read_b32 v164, v191 offset:1008
    ds_read_b64 v[166:167], v190 offset:576
    ds_read_b64 v[168:169], v190 offset:584
    ds_read_b64 v[170:171], v190 offset:592
    ds_read_b64 v[172:173], v190 offset:600
    ds_read_b32 v174, v191 offset:576
    ds_read_b64 v[176:177], v190 offset:144
    ds_read_b64 v[178:179], v190 offset:152
    ds_read_b64 v[180:181], v190 offset:160
    ds_read_b64 v[182:183], v190 offset:168
    ds_read_b32 v184, v191 offset:144
    s_waitcnt lgkmcnt(15)
    v_dot2_f32_bf16 v220, v16, v26, 0
    v_dot2_f32_bf16 v221, v16, v36, 0
    v_dot2_f32_bf16 v222, v16, v46, 0
    v_dot2_f32_bf16 v223, v16, v56, 0
    v_dot2_f32_bf16 v224, v16, v66, 0
    v_dot2_f32_bf16 v225, v16, v76, 0
    v_dot2_f32_bf16 v226, v16, v86, 0
    v_dot2_f32_bf16 v227, v16, v96, 0
    v_dot2_f32_bf16 v220, v17, v27, v220
    v_dot2_f32_bf16 v221, v17, v37, v221
    v_dot2_f32_bf16 v222, v17, v47, v222
    v_dot2_f32_bf16 v223, v17, v57, v223
    v_dot2_f32_bf16 v224, v17, v67, v224
    v_dot2_f32_bf16 v225, v17, v77, v225
    v_dot2_f32_bf16 v226, v17, v87, v226
    v_dot2_f32_bf16 v227, v17, v97, v227
    v_dot2_f32_bf16 v220, v18, v28, v220
    v_dot2_f32_bf16 v221, v18, v38, v221
    v_dot2_f32_bf16 v222, v18, v48, v222
    v_dot2_f32_bf16 v223, v18, v58, v223
    v_dot2_f32_bf16 v224, v18, v68, v224
    v_dot2_f32_bf16 v225, v18, v78, v225
    v_dot2_f32_bf16 v226, v18, v88, v226
    v_dot2_f32_bf16 v227, v18, v98, v227
    v_dot2_f32_bf16 v220, v19, v29, v220
    v_dot2_f32_bf16 v221, v19, v39, v221
    v_dot2_f32_bf16 v222, v19, v49, v222
    v_dot2_f32_bf16 v223, v19, v59, v223
    v_dot2_f32_bf16 v224, v19, v69, v224
    v_dot2_f32_bf16 v225, v19, v79, v225
    v_dot2_f32_bf16 v226, v19, v89, v226
    v_dot2_f32_bf16 v227, v19, v99, v227
    v_dot2_f32_bf16 v220, v20, v30, v220
    v_dot2_f32_bf16 v221, v20, v40, v221
    v_dot2_f32_bf16 v222, v20, v50, v222
    v_dot2_f32_bf16 v223, v20, v60, v223
    v_dot2_f32_bf16 v224, v20, v70, v224
    v_dot2_f32_bf16 v225, v20, v80, v225
    v_dot2_f32_bf16 v226, v20, v90, v226
    v_dot2_f32_bf16 v227, v20, v100, v227
    v_dot2_f32_bf16 v220, v21, v31, v220
    v_dot2_f32_bf16 v221, v21, v41, v221
    v_dot2_f32_bf16 v222, v21, v51, v222
    v_dot2_f32_bf16 v223, v21, v61, v223
    v_dot2_f32_bf16 v224, v21, v71, v224
    v_dot2_f32_bf16 v225, v21, v81, v225
    v_dot2_f32_bf16 v226, v21, v91, v226
    v_dot2_f32_bf16 v227, v21, v101, v227
    v_dot2_f32_bf16 v220, v22, v32, v220
    v_dot2_f32_bf16 v221, v22, v42, v221
    v_dot2_f32_bf16 v222, v22, v52, v222
    v_dot2_f32_bf16 v223, v22, v62, v223
    v_dot2_f32_bf16 v224, v22, v72, v224
    v_dot2_f32_bf16 v225, v22, v82, v225
    v_dot2_f32_bf16 v226, v22, v92, v226
    v_dot2_f32_bf16 v227, v22, v102, v227
    v_dot2_f32_bf16 v220, v23, v33, v220
    v_dot2_f32_bf16 v221, v23, v43, v221
    v_dot2_f32_bf16 v222, v23, v53, v222
    v_dot2_f32_bf16 v223, v23, v63, v223
    v_dot2_f32_bf16 v224, v23, v73, v224
    v_dot2_f32_bf16 v225, v23, v83, v225
    v_dot2_f32_bf16 v226, v23, v93, v226
    v_dot2_f32_bf16 v227, v23, v103, v227
    v_dot2_f32_bf16 v220, v24, v34, v220
    v_dot2_f32_bf16 v221, v24, v44, v221
    v_dot2_f32_bf16 v222, v24, v54, v222
    v_dot2_f32_bf16 v223, v24, v64, v223
    v_dot2_f32_bf16 v224, v24, v74, v224
    v_dot2_f32_bf16 v225, v24, v84, v225
    v_dot2_f32_bf16 v226, v24, v94, v226
    v_dot2_f32_bf16 v227, v24, v104, v227
    s_mov_b32 s60, 1047616495
    s_mov_b32 s61, 1069066811
    s_nop 0
    v_cvt_pk_bf16_f32 v220, 0, v220
    v_cvt_pk_bf16_f32 v221, 0, v221
    v_cvt_pk_bf16_f32 v222, 0, v222
    v_cvt_pk_bf16_f32 v223, 0, v223
    v_cvt_pk_bf16_f32 v224, 0, v224
    v_cvt_pk_bf16_f32 v225, 0, v225
    v_cvt_pk_bf16_f32 v226, 0, v226
    v_cvt_pk_bf16_f32 v227, 0, v227
    v_mul_f32 v220, s60, v220
    v_mul_f32 v221, s60, v221
    v_mul_f32 v222, s60, v222
    v_mul_f32 v223, s60, v223
    v_mul_f32 v224, s60, v224
    v_mul_f32 v225, s60, v225
    v_mul_f32 v226, s60, v226
    v_mul_f32 v227, s60, v227
    v_cvt_pk_bf16_f32 v220, 0, v220
    v_cvt_pk_bf16_f32 v221, 0, v221
    v_cvt_pk_bf16_f32 v222, 0, v222
    v_cvt_pk_bf16_f32 v223, 0, v223
    v_cvt_pk_bf16_f32 v224, 0, v224
    v_cvt_pk_bf16_f32 v225, 0, v225
    v_cvt_pk_bf16_f32 v226, 0, v226
    v_cvt_pk_bf16_f32 v227, 0, v227
    s_cmp_lg_u32 s6, 0
    s_cbranch_scc1 L_B_nomask
    v_mov_b32 v214, 0xce6e6b28
    v_cmp_le_u32 vcc, 2, v192
    s_nop 1
    v_cndmask_b32 v221, v214, v221, vcc
    v_cmp_le_u32 vcc, 4, v192
    s_nop 1
    v_cndmask_b32 v222, v214, v222, vcc
    v_cmp_le_u32 vcc, 6, v192
    s_nop 1
    v_cndmask_b32 v223, v214, v223, vcc
    v_cmp_le_u32 vcc, 8, v192
    s_nop 1
    v_cndmask_b32 v224, v214, v224, vcc
    v_cmp_le_u32 vcc, 10, v192
    s_nop 1
    v_cndmask_b32 v225, v214, v225, vcc
    v_cmp_le_u32 vcc, 12, v192
    s_nop 1
    v_cndmask_b32 v226, v214, v226, vcc
    v_cmp_le_u32 vcc, 14, v192
    s_nop 1
    v_cndmask_b32 v227, v214, v227, vcc
L_B_nomask:
    v_max3_f32 v210, v220, v221, v222
    v_max3_f32 v211, v223, v224, v225
    v_max3_f32 v210, v210, v226, v227
    v_max_f32 v210, v210, v211
    v_sub_f32 v220, v220, v210
    v_sub_f32 v221, v221, v210
    v_sub_f32 v222, v222, v210
    v_sub_f32 v223, v223, v210
    v_sub_f32 v224, v224, v210
    v_sub_f32 v225, v225, v210
    v_sub_f32 v226, v226, v210
    v_sub_f32 v227, v227, v210
    v_mul_f32 v220, s61, v220
    v_mul_f32 v221, s61, v221
    v_mul_f32 v222, s61, v222
    v_mul_f32 v223, s61, v223
    v_mul_f32 v224, s61, v224
    v_mul_f32 v225, s61, v225
    v_mul_f32 v226, s61, v226
    v_mul_f32 v227, s61, v227
    v_exp_f32 v220, v220
    v_exp_f32 v221, v221
    v_exp_f32 v222, v222
    v_exp_f32 v223, v223
    v_exp_f32 v224, v224
    v_exp_f32 v225, v225
    v_exp_f32 v226, v226
    v_exp_f32 v227, v227
    s_nop 0
    v_add_f32 v210, v220, v221
    v_add_f32 v211, v222, v223
    v_add_f32 v212, v224, v225
    v_add_f32 v213, v226, v227
    v_add_f32 v210, v210, v211
    v_add_f32 v212, v212, v213
    v_add_f32 v210, v210, v212
    v_rcp_f32 v210, v210
    s_nop 0
    v_mul_f32 v220, v220, v210
    v_mul_f32 v221, v221, v210
    v_mul_f32 v222, v222, v210
    v_mul_f32 v223, v223, v210
    v_mul_f32 v224, v224, v210
    v_mul_f32 v225, v225, v210
    v_mul_f32 v226, v226, v210
    v_mul_f32 v227, v227, v210
    v_cvt_pk_bf16_f32 v214, v220, v221
    v_cvt_pk_bf16_f32 v215, v222, v223
    v_cvt_pk_bf16_f32 v216, v224, v225
    v_cvt_pk_bf16_f32 v217, v226, v227
    s_mov_b32 s60, 0x05040100
    s_mov_b32 s61, 0x07060302
    s_waitcnt lgkmcnt(0)
    v_perm_b32 v44, v116, v106, s60
    v_perm_b32 v45, v116, v106, s61
    v_perm_b32 v46, v117, v107, s60
    v_perm_b32 v47, v117, v107, s61
    v_perm_b32 v48, v118, v108, s60
    v_perm_b32 v49, v118, v108, s61
    v_perm_b32 v50, v119, v109, s60
    v_perm_b32 v51, v119, v109, s61
    v_perm_b32 v52, v120, v110, s60
    v_perm_b32 v53, v120, v110, s61
    v_perm_b32 v54, v121, v111, s60
    v_perm_b32 v55, v121, v111, s61
    v_perm_b32 v56, v122, v112, s60
    v_perm_b32 v57, v122, v112, s61
    v_perm_b32 v58, v123, v113, s60
    v_perm_b32 v59, v123, v113, s61
    v_perm_b32 v60, v124, v114, s60
    v_perm_b32 v61, v124, v114, s61
    v_dot2_f32_bf16 v26, v44, v214, 0
    v_dot2_f32_bf16 v27, v45, v214, 0
    v_dot2_f32_bf16 v28, v46, v214, 0
    v_dot2_f32_bf16 v29, v47, v214, 0
    v_dot2_f32_bf16 v30, v48, v214, 0
    v_dot2_f32_bf16 v31, v49, v214, 0
    v_dot2_f32_bf16 v32, v50, v214, 0
    v_dot2_f32_bf16 v33, v51, v214, 0
    v_dot2_f32_bf16 v34, v52, v214, 0
    v_dot2_f32_bf16 v35, v53, v214, 0
    v_dot2_f32_bf16 v36, v54, v214, 0
    v_dot2_f32_bf16 v37, v55, v214, 0
    v_dot2_f32_bf16 v38, v56, v214, 0
    v_dot2_f32_bf16 v39, v57, v214, 0
    v_dot2_f32_bf16 v40, v58, v214, 0
    v_dot2_f32_bf16 v41, v59, v214, 0
    v_dot2_f32_bf16 v42, v60, v214, 0
    v_dot2_f32_bf16 v43, v61, v214, 0
    v_perm_b32 v44, v136, v126, s60
    v_perm_b32 v45, v136, v126, s61
    v_perm_b32 v46, v137, v127, s60
    v_perm_b32 v47, v137, v127, s61
    v_perm_b32 v48, v138, v128, s60
    v_perm_b32 v49, v138, v128, s61
    v_perm_b32 v50, v139, v129, s60
    v_perm_b32 v51, v139, v129, s61
    v_perm_b32 v52, v140, v130, s60
    v_perm_b32 v53, v140, v130, s61
    v_perm_b32 v54, v141, v131, s60
    v_perm_b32 v55, v141, v131, s61
    v_perm_b32 v56, v142, v132, s60
    v_perm_b32 v57, v142, v132, s61
    v_perm_b32 v58, v143, v133, s60
    v_perm_b32 v59, v143, v133, s61
    v_perm_b32 v60, v144, v134, s60
    v_perm_b32 v61, v144, v134, s61
    v_dot2_f32_bf16 v26, v44, v215, v26
    v_dot2_f32_bf16 v27, v45, v215, v27
    v_dot2_f32_bf16 v28, v46, v215, v28
    v_dot2_f32_bf16 v29, v47, v215, v29
    v_dot2_f32_bf16 v30, v48, v215, v30
    v_dot2_f32_bf16 v31, v49, v215, v31
    v_dot2_f32_bf16 v32, v50, v215, v32
    v_dot2_f32_bf16 v33, v51, v215, v33
    v_dot2_f32_bf16 v34, v52, v215, v34
    v_dot2_f32_bf16 v35, v53, v215, v35
    v_dot2_f32_bf16 v36, v54, v215, v36
    v_dot2_f32_bf16 v37, v55, v215, v37
    v_dot2_f32_bf16 v38, v56, v215, v38
    v_dot2_f32_bf16 v39, v57, v215, v39
    v_dot2_f32_bf16 v40, v58, v215, v40
    v_dot2_f32_bf16 v41, v59, v215, v41
    v_dot2_f32_bf16 v42, v60, v215, v42
    v_dot2_f32_bf16 v43, v61, v215, v43
    v_perm_b32 v44, v156, v146, s60
    v_perm_b32 v45, v156, v146, s61
    v_perm_b32 v46, v157, v147, s60
    v_perm_b32 v47, v157, v147, s61
    v_perm_b32 v48, v158, v148, s60
    v_perm_b32 v49, v158, v148, s61
    v_perm_b32 v50, v159, v149, s60
    v_perm_b32 v51, v159, v149, s61
    v_perm_b32 v52, v160, v150, s60
    v_perm_b32 v53, v160, v150, s61
    v_perm_b32 v54, v161, v151, s60
    v_perm_b32 v55, v161, v151, s61
    v_perm_b32 v56, v162, v152, s60
    v_perm_b32 v57, v162, v152, s61
    v_perm_b32 v58, v163, v153, s60
    v_perm_b32 v59, v163, v153, s61
    v_perm_b32 v60, v164, v154, s60
    v_perm_b32 v61, v164, v154, s61
    v_dot2_f32_bf16 v26, v44, v216, v26
    v_dot2_f32_bf16 v27, v45, v216, v27
    v_dot2_f32_bf16 v28, v46, v216, v28
    v_dot2_f32_bf16 v29, v47, v216, v29
    v_dot2_f32_bf16 v30, v48, v216, v30
    v_dot2_f32_bf16 v31, v49, v216, v31
    v_dot2_f32_bf16 v32, v50, v216, v32
    v_dot2_f32_bf16 v33, v51, v216, v33
    v_dot2_f32_bf16 v34, v52, v216, v34
    v_dot2_f32_bf16 v35, v53, v216, v35
    v_dot2_f32_bf16 v36, v54, v216, v36
    v_dot2_f32_bf16 v37, v55, v216, v37
    v_dot2_f32_bf16 v38, v56, v216, v38
    v_dot2_f32_bf16 v39, v57, v216, v39
    v_dot2_f32_bf16 v40, v58, v216, v40
    v_dot2_f32_bf16 v41, v59, v216, v41
    v_dot2_f32_bf16 v42, v60, v216, v42
    v_dot2_f32_bf16 v43, v61, v216, v43
    v_perm_b32 v44, v176, v166, s60
    v_perm_b32 v45, v176, v166, s61
    v_perm_b32 v46, v177, v167, s60
    v_perm_b32 v47, v177, v167, s61
    v_perm_b32 v48, v178, v168, s60
    v_perm_b32 v49, v178, v168, s61
    v_perm_b32 v50, v179, v169, s60
    v_perm_b32 v51, v179, v169, s61
    v_perm_b32 v52, v180, v170, s60
    v_perm_b32 v53, v180, v170, s61
    v_perm_b32 v54, v181, v171, s60
    v_perm_b32 v55, v181, v171, s61
    v_perm_b32 v56, v182, v172, s60
    v_perm_b32 v57, v182, v172, s61
    v_perm_b32 v58, v183, v173, s60
    v_perm_b32 v59, v183, v173, s61
    v_perm_b32 v60, v184, v174, s60
    v_perm_b32 v61, v184, v174, s61
    v_dot2_f32_bf16 v26, v44, v217, v26
    v_dot2_f32_bf16 v27, v45, v217, v27
    v_dot2_f32_bf16 v28, v46, v217, v28
    v_dot2_f32_bf16 v29, v47, v217, v29
    v_dot2_f32_bf16 v30, v48, v217, v30
    v_dot2_f32_bf16 v31, v49, v217, v31
    v_dot2_f32_bf16 v32, v50, v217, v32
    v_dot2_f32_bf16 v33, v51, v217, v33
    v_dot2_f32_bf16 v34, v52, v217, v34
    v_dot2_f32_bf16 v35, v53, v217, v35
    v_dot2_f32_bf16 v36, v54, v217, v36
    v_dot2_f32_bf16 v37, v55, v217, v37
    v_dot2_f32_bf16 v38, v56, v217, v38
    v_dot2_f32_bf16 v39, v57, v217, v39
    v_dot2_f32_bf16 v40, v58, v217, v40
    v_dot2_f32_bf16 v41, v59, v217, v41
    v_dot2_f32_bf16 v42, v60, v217, v42
    v_dot2_f32_bf16 v43, v61, v217, v43
    s_nop 2
    v_cvt_pk_bf16_f32 v62, v26, v27
    v_cvt_pk_bf16_f32 v63, v28, v29
    v_cvt_pk_bf16_f32 v64, v30, v31
    v_cvt_pk_bf16_f32 v65, v32, v33
    v_cvt_pk_bf16_f32 v66, v34, v35
    v_cvt_pk_bf16_f32 v67, v36, v37
    v_cvt_pk_bf16_f32 v68, v38, v39
    v_cvt_pk_bf16_f32 v69, v40, v41
    v_cvt_pk_bf16_f32 v70, v42, v43
    ds_write_b64 v193, v[62:63] offset:0
    ds_write_b64 v193, v[64:65] offset:8
    ds_write_b64 v193, v[66:67] offset:16
    ds_write_b64 v193, v[68:69] offset:24
    ds_write_b32 v194, v70
    s_mul_i32 s9, s8, 2560
    v_lshlrev_b32 v9, 4, v1
    v_add_u32 v9, s9, v9
    v_add_u32 v8, 61440, v9
    s_lshl_b32 s9, s5, 3
    s_add_u32 s9, s9, s6
    s_lshl_b32 s9, s9, 4
    s_add_u32 s9, s9, s7
    s_mul_i32 s9, s9, 20480
    s_waitcnt lgkmcnt(0)
    ds_read_b128 v[76:79], v8 offset:0
    ds_read_b128 v[80:83], v8 offset:1024
    ds_read_b128 v[84:87], v8 offset:2048
    s_waitcnt lgkmcnt(1)
    buffer_store_dwordx4 v[76:79], v9, s[36:39], s9 offen offset:0 sc0 sc1
    buffer_store_dwordx4 v[80:83], v9, s[36:39], s9 offen offset:1024 sc0 sc1
    s_waitcnt lgkmcnt(0)
    s_mov_b32 exec_hi, 0
    buffer_store_dwordx4 v[84:87], v9, s[36:39], s9 offen offset:2048 sc0 sc1
    s_mov_b32 exec_hi, -1
    s_waitcnt vmcnt(0)
    v_readfirstlane_b32 s72, v6
    v_readfirstlane_b32 s73, v7
    s_mov_b32 s11, 0
L_B_np:
    s_cmp_lg_u32 s72, 0
    s_cbranch_scc1 L_B_nd
    v_mov_b32 v8, 64
    buffer_load_dwordx2 v[6:7], v8, s[44:47], 0 offen sc1
    s_waitcnt vmcnt(0)
    v_readfirstlane_b32 s72, v6
    v_readfirstlane_b32 s73, v7
    s_add_u32 s11, s11, 1
    s_cmp_lt_u32 s11, 0x40000
    s_cbranch_scc1 L_B_np
L_B_nd:
L_phase2:
    s_cmp_eq_u32 s49, 3
    s_cbranch_scc1 L_p2_3
    s_waitcnt vmcnt(0) lgkmcnt(0)
    s_lshl_b32 s9, s5, 3
    s_add_u32 s9, s9, s6
    s_lshl_b32 s9, s9, 4
    s_add_u32 s9, s9, s7
    s_lshl_b32 s9, s9, 3
    s_add_u32 s9, s9, s8
    s_lshl_b32 s9, s9, 8
    v_mov_b32 v210, s9
    s_mov_b64 exec, 1
    buffer_store_dwordx2 v[6:7], v210, s[76:79], 0 offen offset:128 sc0 sc1
    s_mov_b64 exec, -1
    s_barrier
    ds_read_b64_tr_b16 v[100:101], v238 offset:0
    ds_read_b64_tr_b16 v[102:103], v238 offset:1152
    ds_read_b64_tr_b16 v[104:105], v238 offset:32
    ds_read_b64_tr_b16 v[106:107], v238 offset:1184
    ds_read_b64_tr_b16 v[112:113], v238 offset:9728
    ds_read_b64_tr_b16 v[114:115], v238 offset:10880
    ds_read_b64_tr_b16 v[116:117], v238 offset:9760
    ds_read_b64_tr_b16 v[118:119], v238 offset:10912
    ds_read_b64_tr_b16 v[124:125], v240 offset:0
    ds_read_b64_tr_b16 v[126:127], v240 offset:1152
    ds_read_b64_tr_b16 v[128:129], v240 offset:32
    ds_read_b64_tr_b16 v[130:131], v240 offset:1184
    ds_read_b64_tr_b16 v[136:137], v240 offset:9728
    ds_read_b64_tr_b16 v[138:139], v240 offset:10880
    ds_read_b64_tr_b16 v[140:141], v240 offset:9760
    ds_read_b64_tr_b16 v[142:143], v240 offset:10912
    ds_read_b64_tr_b16 v[148:149], v242 offset:0
    ds_read_b64_tr_b16 v[150:151], v242 offset:1152
    ds_read_b64_tr_b16 v[152:153], v242 offset:32
    ds_read_b64_tr_b16 v[154:155], v242 offset:1184
    ds_read_b64_tr_b16 v[160:161], v242 offset:9728
    ds_read_b64_tr_b16 v[162:163], v242 offset:10880
    ds_read_b64_tr_b16 v[164:165], v242 offset:9760
    ds_read_b64_tr_b16 v[166:167], v242 offset:10912
    ds_read_b64_tr_b16 v[172:173], v244 offset:0
    ds_read_b64_tr_b16 v[174:175], v244 offset:1152
    ds_read_b64_tr_b16 v[176:177], v244 offset:32
    ds_read_b64_tr_b16 v[178:179], v244 offset:1184
    ds_read_b64_tr_b16 v[184:185], v244 offset:9728
    ds_read_b64_tr_b16 v[186:187], v244 offset:10880
    ds_read_b64_tr_b16 v[188:189], v244 offset:9760
    ds_read_b64_tr_b16 v[190:191], v244 offset:10912
    s_waitcnt lgkmcnt(0)
    s_barrier
    s_mov_b32 s48, 331776
    s_add_u32 m0, s51, 81920
    s_nop 0
    buffer_load_dwordx4 v232, s[24:27], s48 offen lds
    s_mov_b32 s48, 331776
    s_add_u32 m0, s51, 90112
    s_nop 0
    buffer_load_dwordx4 v233, s[24:27], s48 offen lds
    s_cmp_ge_u32 s8, 3
    s_cbranch_scc1 L_g2_nd4
    s_mov_b32 s48, 331776
    s_add_u32 m0, s51, 98304
    s_nop 0
    buffer_load_dwordx4 v234, s[24:27], s48 offen lds
L_g2_nd4:
    s_mov_b32 s48, 414720
    s_add_u32 m0, s51, 101376
    s_nop 0
    buffer_load_dwordx4 v232, s[24:27], s48 offen lds
    s_mov_b32 s48, 414720
    s_add_u32 m0, s51, 109568
    s_nop 0
    buffer_load_dwordx4 v233, s[24:27], s48 offen lds
    s_cmp_ge_u32 s8, 3
    s_cbranch_scc1 L_g2_nd5
    s_mov_b32 s48, 414720
    s_add_u32 m0, s51, 117760
    s_nop 0
    buffer_load_dwordx4 v234, s[24:27], s48 offen lds
L_g2_nd5:
    s_mov_b32 s48, 497664
    s_add_u32 m0, s51, 120832
    s_nop 0
    buffer_load_dwordx4 v232, s[24:27], s48 offen lds
    s_mov_b32 s48, 497664
    s_add_u32 m0, s51, 129024
    s_nop 0
    buffer_load_dwordx4 v233, s[24:27], s48 offen lds
    s_cmp_ge_u32 s8, 3
    s_cbranch_scc1 L_g2_nd6
    s_mov_b32 s48, 497664
    s_add_u32 m0, s51, 137216
    s_nop 0
    buffer_load_dwordx4 v234, s[24:27], s48 offen lds
L_g2_nd6:
    s_mov_b32 s48, 580608
    s_add_u32 m0, s51, 140288
    s_nop 0
    buffer_load_dwordx4 v232, s[24:27], s48 offen lds
    s_mov_b32 s48, 580608
    s_add_u32 m0, s51, 148480
    s_nop 0
    buffer_load_dwordx4 v233, s[24:27], s48 offen lds
    s_cmp_ge_u32 s8, 3
    s_cbranch_scc1 L_g2_nd7
    s_mov_b32 s48, 580608
    s_add_u32 m0, s51, 156672
    s_nop 0
    buffer_load_dwordx4 v234, s[24:27], s48 offen lds
L_g2_nd7:
    s_cmp_lg_u32 s8, 0
    s_cbranch_scc1 L_g2_fw
    s_lshl_b32 s9, s5, 3
    s_add_u32 s9, s9, s6
    s_lshl_b32 s9, s9, 4
    v_add_u32 v40, s9, v10
    v_lshlrev_b32 v40, 3, v40
    v_and_b32 v41, 1, v11
    s_lshr_b32 s9, s7, 2
    s_lshl_b32 s9, s9, 1
    v_add3_u32 v40, v40, v41, s9
    v_lshlrev_b32 v40, 8, v40
    s_mov_b32 s11, 0
L_g2_fp:
    buffer_load_dwordx2 v[42:43], v40, s[76:79], 0 offen offset:128 sc1
    s_waitcnt vmcnt(0)
    v_cmp_ne_u64 vcc, s[72:73], v[42:43]
    s_add_u32 s11, s11, 1
    s_cmp_eq_u64 vcc, 0
    s_cbranch_scc1 L_g2_fw
    s_cmp_lt_u32 s11, 0x40000
    s_cbranch_scc1 L_g2_fp
L_g2_fw:
    s_barrier
    v_add_u32 v14, 40960, v246
    s_mul_i32 s9, s8, 10240
    s_mov_b32 s48, 0
    s_add_u32 m0, s9, 0
    s_nop 0
    buffer_load_dwordx4 v255, s[36:39], s48 offen offset:0 sc1 lds
    buffer_load_dwordx4 v255, s[36:39], s48 offen offset:1024 sc1 lds
    buffer_load_dwordx4 v255, s[36:39], s48 offen offset:2048 sc1 lds
    buffer_load_dwordx4 v255, s[36:39], s48 offen offset:3072 sc1 lds
    s_mov_b32 s48, 4096
    s_add_u32 m0, s9, 4096
    s_nop 0
    buffer_load_dwordx4 v255, s[36:39], s48 offen offset:0 sc1 lds
    s_mov_b32 s48, 20480
    s_add_u32 m0, s9, 5120
    s_nop 0
    buffer_load_dwordx4 v255, s[36:39], s48 offen offset:0 sc1 lds
    buffer_load_dwordx4 v255, s[36:39], s48 offen offset:1024 sc1 lds
    buffer_load_dwordx4 v255, s[36:39], s48 offen offset:2048 sc1 lds
    buffer_load_dwordx4 v255, s[36:39], s48 offen offset:3072 sc1 lds
    s_mov_b32 s48, 24576
    s_add_u32 m0, s9, 9216
    s_nop 0
    buffer_load_dwordx4 v255, s[36:39], s48 offen offset:0 sc1 lds
    s_waitcnt vmcnt(0)
    s_barrier
    ds_read_b128 v[76:79], v246 offset:0
    ds_read_b128 v[80:83], v246 offset:1280
    ds_read_b128 v[84:87], v246 offset:5120
    ds_read_b128 v[88:91], v246 offset:6400
    ds_read_b64_tr_b16 v[196:197], v238 offset:0
    ds_read_b64_tr_b16 v[198:199], v238 offset:1152
    ds_read_b64_tr_b16 v[200:201], v238 offset:32
    ds_read_b64_tr_b16 v[202:203], v238 offset:1184
    ds_read_b64_tr_b16 v[208:209], v238 offset:9728
    ds_read_b64_tr_b16 v[210:211], v238 offset:10880
    ds_read_b64_tr_b16 v[212:213], v238 offset:9760
    ds_read_b64_tr_b16 v[214:215], v238 offset:10912
    s_waitcnt lgkmcnt(10)
    v_mfma_f32_16x16x32_bf16 v[16:19], v[100:103], v[76:79], 0
    ds_read_b128 v[92:95], v246 offset:10240
    ds_read_b128 v[96:99], v246 offset:11520
    v_mfma_f32_16x16x32_bf16 v[28:31], v[100:103], v[80:83], 0
    v_mfma_f32_16x16x32_bf16 v[20:23], v[104:107], v[76:79], 0
    v_mfma_f32_16x16x32_bf16 v[32:35], v[104:107], v[80:83], 0
    s_waitcnt lgkmcnt(10)
    v_mfma_f32_16x16x32_bf16 v[16:19], v[112:115], v[84:87], v[16:19]
    ds_read_b128 v[76:79], v246 offset:15360
    ds_read_b128 v[80:83], v246 offset:16640
    v_mfma_f32_16x16x32_bf16 v[28:31], v[112:115], v[88:91], v[28:31]
    v_mfma_f32_16x16x32_bf16 v[20:23], v[116:119], v[84:87], v[20:23]
    v_mfma_f32_16x16x32_bf16 v[32:35], v[116:119], v[88:91], v[32:35]
    s_waitcnt lgkmcnt(4)
    s_barrier
    s_mov_b32 s48, 0
    s_add_u32 m0, s51, 81920
    s_nop 0
    buffer_load_dwordx4 v235, s[24:27], s48 offen lds
    s_mov_b32 s48, 0
    s_add_u32 m0, s51, 90112
    s_nop 0
    buffer_load_dwordx4 v236, s[24:27], s48 offen lds
    s_cmp_ge_u32 s8, 3
    s_cbranch_scc1 L_g2t_nd8
    s_mov_b32 s48, 0
    s_add_u32 m0, s51, 98304
    s_nop 0
    buffer_load_dwordx4 v237, s[24:27], s48 offen lds
L_g2t_nd8:
    s_waitcnt lgkmcnt(2)
    v_mfma_f32_16x16x32_bf16 v[16:19], v[124:127], v[92:95], v[16:19]
    ds_read_b128 v[84:87], v246 offset:20480
    ds_read_b128 v[88:91], v246 offset:21760
    v_mfma_f32_16x16x32_bf16 v[28:31], v[124:127], v[96:99], v[28:31]
    v_mfma_f32_16x16x32_bf16 v[20:23], v[128:131], v[92:95], v[20:23]
    v_mfma_f32_16x16x32_bf16 v[32:35], v[128:131], v[96:99], v[32:35]
    s_waitcnt lgkmcnt(2)
    v_mfma_f32_16x16x32_bf16 v[16:19], v[136:139], v[76:79], v[16:19]
    ds_read_b128 v[92:95], v246 offset:25600
    ds_read_b128 v[96:99], v246 offset:26880
    v_mfma_f32_16x16x32_bf16 v[28:31], v[136:139], v[80:83], v[28:31]
    v_mfma_f32_16x16x32_bf16 v[20:23], v[140:143], v[76:79], v[20:23]
    v_mfma_f32_16x16x32_bf16 v[32:35], v[140:143], v[80:83], v[32:35]
    s_waitcnt lgkmcnt(2)
    v_mfma_f32_16x16x32_bf16 v[16:19], v[148:151], v[84:87], v[16:19]
    ds_read_b128 v[76:79], v246 offset:30720
    ds_read_b128 v[80:83], v246 offset:32000
    v_mfma_f32_16x16x32_bf16 v[28:31], v[148:151], v[88:91], v[28:31]
    v_mfma_f32_16x16x32_bf16 v[20:23], v[152:155], v[84:87], v[20:23]
    v_mfma_f32_16x16x32_bf16 v[32:35], v[152:155], v[88:91], v[32:35]
    s_waitcnt lgkmcnt(2)
    v_mfma_f32_16x16x32_bf16 v[16:19], v[160:163], v[92:95], v[16:19]
    ds_read_b128 v[84:87], v246 offset:35840
    ds_read_b128 v[88:91], v246 offset:37120
    v_mfma_f32_16x16x32_bf16 v[28:31], v[160:163], v[96:99], v[28:31]
    v_mfma_f32_16x16x32_bf16 v[20:23], v[164:167], v[92:95], v[20:23]
    v_mfma_f32_16x16x32_bf16 v[32:35], v[164:167], v[96:99], v[32:35]
    s_waitcnt lgkmcnt(2)
    v_mfma_f32_16x16x32_bf16 v[16:19], v[172:175], v[76:79], v[16:19]
    ds_read_b128 v[92:95], v246 offset:40960
    ds_read_b128 v[96:99], v246 offset:42240
    v_mfma_f32_16x16x32_bf16 v[28:31], v[172:175], v[80:83], v[28:31]
    v_mfma_f32_16x16x32_bf16 v[20:23], v[176:179], v[76:79], v[20:23]
    v_mfma_f32_16x16x32_bf16 v[32:35], v[176:179], v[80:83], v[32:35]
    s_waitcnt lgkmcnt(2)
    v_mfma_f32_16x16x32_bf16 v[16:19], v[184:187], v[84:87], v[16:19]
    ds_read_b128 v[76:79], v246 offset:46080
    ds_read_b128 v[80:83], v246 offset:47360
    v_mfma_f32_16x16x32_bf16 v[28:31], v[184:187], v[88:91], v[28:31]
    v_mfma_f32_16x16x32_bf16 v[20:23], v[188:191], v[84:87], v[20:23]
    v_mfma_f32_16x16x32_bf16 v[32:35], v[188:191], v[88:91], v[32:35]
    s_waitcnt lgkmcnt(2)
    v_mfma_f32_16x16x32_bf16 v[16:19], v[196:199], v[92:95], v[16:19]
    ds_read_b128 v[84:87], v246 offset:51200
    ds_read_b128 v[88:91], v246 offset:52480
    v_mfma_f32_16x16x32_bf16 v[28:31], v[196:199], v[96:99], v[28:31]
    ds_read_b64_tr_b16 v[52:53], v240 offset:0
    ds_read_b64_tr_b16 v[54:55], v240 offset:1152
    v_mfma_f32_16x16x32_bf16 v[20:23], v[200:203], v[92:95], v[20:23]
    ds_read_b64_tr_b16 v[56:57], v240 offset:32
    ds_read_b64_tr_b16 v[58:59], v240 offset:1184
    v_mfma_f32_16x16x32_bf16 v[32:35], v[200:203], v[96:99], v[32:35]
    s_waitcnt lgkmcnt(6)
    v_mfma_f32_16x16x32_bf16 v[16:19], v[208:211], v[76:79], v[16:19]
    ds_read_b128 v[92:95], v246 offset:56320
    ds_read_b128 v[96:99], v246 offset:57600
    v_mfma_f32_16x16x32_bf16 v[28:31], v[208:211], v[80:83], v[28:31]
    ds_read_b64_tr_b16 v[64:65], v240 offset:9728
    ds_read_b64_tr_b16 v[66:67], v240 offset:10880
    v_mfma_f32_16x16x32_bf16 v[20:23], v[212:215], v[76:79], v[20:23]
    ds_read_b64_tr_b16 v[68:69], v240 offset:9760
    ds_read_b64_tr_b16 v[70:71], v240 offset:10912
    v_mfma_f32_16x16x32_bf16 v[32:35], v[212:215], v[80:83], v[32:35]
    s_waitcnt lgkmcnt(8)
    v_mfma_f32_16x16x32_bf16 v[16:19], v[52:55], v[84:87], v[16:19]
    ds_read_b128 v[76:79], v246 offset:61440
    ds_read_b128 v[80:83], v246 offset:62720
    v_mfma_f32_16x16x32_bf16 v[28:31], v[52:55], v[88:91], v[28:31]
    ds_read_b64_tr_b16 v[40:41], v242 offset:0
    ds_read_b64_tr_b16 v[42:43], v242 offset:1152
    s_waitcnt lgkmcnt(10)
    v_mfma_f32_16x16x32_bf16 v[20:23], v[56:59], v[84:87], v[20:23]
    ds_read_b64_tr_b16 v[44:45], v242 offset:32
    ds_read_b64_tr_b16 v[46:47], v242 offset:1184
    v_mfma_f32_16x16x32_bf16 v[32:35], v[56:59], v[88:91], v[32:35]
    s_waitcnt lgkmcnt(8)
    v_mfma_f32_16x16x32_bf16 v[16:19], v[64:67], v[92:95], v[16:19]
    ds_read_b128 v[84:87], v14 offset:25600
    ds_read_b128 v[88:91], v14 offset:26880
    v_mfma_f32_16x16x32_bf16 v[28:31], v[64:67], v[96:99], v[28:31]
    ds_read_b64_tr_b16 v[52:53], v242 offset:9728
    ds_read_b64_tr_b16 v[54:55], v242 offset:10880
    s_waitcnt lgkmcnt(10)
    v_mfma_f32_16x16x32_bf16 v[20:23], v[68:71], v[92:95], v[20:23]
    ds_read_b64_tr_b16 v[56:57], v242 offset:9760
    ds_read_b64_tr_b16 v[58:59], v242 offset:10912
    v_mfma_f32_16x16x32_bf16 v[32:35], v[68:71], v[96:99], v[32:35]
    s_waitcnt lgkmcnt(8)
    v_mfma_f32_16x16x32_bf16 v[16:19], v[40:43], v[76:79], v[16:19]
    ds_read_b128 v[92:95], v14 offset:30720
    ds_read_b128 v[96:99], v14 offset:32000
    v_mfma_f32_16x16x32_bf16 v[28:31], v[40:43], v[80:83], v[28:31]
    ds_read_b64_tr_b16 v[64:65], v244 offset:0
    ds_read_b64_tr_b16 v[66:67], v244 offset:1152
    s_waitcnt lgkmcnt(10)
    v_mfma_f32_16x16x32_bf16 v[20:23], v[44:47], v[76:79], v[20:23]
    ds_read_b64_tr_b16 v[68:69], v244 offset:32
    ds_read_b64_tr_b16 v[70:71], v244 offset:1184
    v_mfma_f32_16x16x32_bf16 v[32:35], v[44:47], v[80:83], v[32:35]
    s_waitcnt lgkmcnt(8)
    v_mfma_f32_16x16x32_bf16 v[16:19], v[52:55], v[84:87], v[16:19]
    ds_read_b128 v[76:79], v14 offset:35840
    ds_read_b128 v[80:83], v14 offset:37120
    v_mfma_f32_16x16x32_bf16 v[28:31], v[52:55], v[88:91], v[28:31]
    ds_read_b64_tr_b16 v[40:41], v244 offset:9728
    ds_read_b64_tr_b16 v[42:43], v244 offset:10880
    s_waitcnt lgkmcnt(10)
    v_mfma_f32_16x16x32_bf16 v[20:23], v[56:59], v[84:87], v[20:23]
    ds_read_b64_tr_b16 v[44:45], v244 offset:9760
    ds_read_b64_tr_b16 v[46:47], v244 offset:10912
    v_mfma_f32_16x16x32_bf16 v[32:35], v[56:59], v[88:91], v[32:35]
    s_waitcnt vmcnt(0)
    s_barrier
    s_waitcnt lgkmcnt(8)
    v_mfma_f32_16x16x32_bf16 v[16:19], v[64:67], v[92:95], v[16:19]
    ds_read_b64 v[84:85], v247 offset:0
    ds_read_b64 v[86:87], v247 offset:5120
    v_mfma_f32_16x16x32_bf16 v[28:31], v[64:67], v[96:99], v[28:31]
    ds_read_b64 v[88:89], v247 offset:1280
    ds_read_b64 v[90:91], v247 offset:6400
    s_waitcnt lgkmcnt(10)
    v_mfma_f32_16x16x32_bf16 v[20:23], v[68:71], v[92:95], v[20:23]
    ds_read_b64_tr_b16 v[52:53], v238 offset:0
    ds_read_b64_tr_b16 v[54:55], v238 offset:1152
    v_mfma_f32_16x16x32_bf16 v[32:35], v[68:71], v[96:99], v[32:35]
    ds_read_b64_tr_b16 v[56:57], v238 offset:32
    ds_read_b64_tr_b16 v[58:59], v238 offset:1184
    s_waitcnt lgkmcnt(10)
    v_mfma_f32_16x16x32_bf16 v[16:19], v[40:43], v[76:79], v[16:19]
    ds_read_b64 v[92:93], v247 offset:40960
    ds_read_b64 v[94:95], v247 offset:46080
    v_mfma_f32_16x16x32_bf16 v[28:31], v[40:43], v[80:83], v[28:31]
    ds_read_b64 v[96:97], v247 offset:42240
    ds_read_b64 v[98:99], v247 offset:47360
    s_waitcnt lgkmcnt(12)
    v_mfma_f32_16x16x32_bf16 v[20:23], v[44:47], v[76:79], v[20:23]
    ds_read_b64_tr_b16 v[64:65], v238 offset:9728
    ds_read_b64_tr_b16 v[66:67], v238 offset:10880
    v_mfma_f32_16x16x32_bf16 v[32:35], v[44:47], v[80:83], v[32:35]
    ds_read_b64_tr_b16 v[68:69], v238 offset:9760
    ds_read_b64_tr_b16 v[70:71], v238 offset:10912
    s_waitcnt lgkmcnt(10)
    v_mfma_f32_16x16x32_bf16 v[16:19], v[52:55], v[84:87], v[16:19]
    v_mfma_f32_16x16x32_bf16 v[28:31], v[52:55], v[88:91], v[28:31]
    s_waitcnt lgkmcnt(8)
    v_mfma_f32_16x16x32_bf16 v[20:23], v[56:59], v[84:87], v[20:23]
    v_mfma_f32_16x16x32_bf16 v[32:35], v[56:59], v[88:91], v[32:35]
    s_waitcnt lgkmcnt(2)
    v_mfma_f32_16x16x32_bf16 v[16:19], v[64:67], v[92:95], v[16:19]
    v_mfma_f32_16x16x32_bf16 v[28:31], v[64:67], v[96:99], v[28:31]
    s_waitcnt lgkmcnt(0)
    v_mfma_f32_16x16x32_bf16 v[20:23], v[68:71], v[92:95], v[20:23]
    v_mfma_f32_16x16x32_bf16 v[32:35], v[68:71], v[96:99], v[32:35]
    s_nop 7
    v_cvt_pk_bf16_f32 v44, v16, v17
    v_cvt_pk_bf16_f32 v45, v18, v19
    v_cvt_pk_bf16_f32 v46, v20, v21
    v_cvt_pk_bf16_f32 v47, v22, v23
    v_cvt_pk_bf16_f32 v50, v28, v29
    v_cvt_pk_bf16_f32 v51, v30, v31
    v_cvt_pk_bf16_f32 v52, v32, v33
    v_cvt_pk_bf16_f32 v53, v34, v35
    s_barrier
    ds_write_b64 v248, v[44:45] offset:0
    ds_write_b64 v248, v[46:47] offset:32
    ds_write_b64 v248, v[50:51] offset:4864
    ds_write_b64 v248, v[52:53] offset:4896
    s_waitcnt lgkmcnt(0)
    s_barrier
    s_branch L_p2_store
L_p2_3:
    s_waitcnt vmcnt(0) lgkmcnt(0)
    s_lshl_b32 s9, s5, 3
    s_add_u32 s9, s9, s6
    s_lshl_b32 s9, s9, 4
    s_add_u32 s9, s9, s7
    s_lshl_b32 s9, s9, 3
    s_add_u32 s9, s9, s8
    s_lshl_b32 s9, s9, 8
    v_mov_b32 v210, s9
    s_mov_b64 exec, 1
    buffer_store_dwordx2 v[6:7], v210, s[76:79], 0 offen offset:128 sc0 sc1
    s_mov_b64 exec, -1
    s_barrier
    ds_read_b64_tr_b16 v[100:101], v238 offset:0
    ds_read_b64_tr_b16 v[102:103], v238 offset:1152
    ds_read_b64_tr_b16 v[104:105], v238 offset:32
    ds_read_b64_tr_b16 v[106:107], v238 offset:1184
    ds_read_b64_tr_b16 v[108:109], v239 offset:0
    ds_read_b64_tr_b16 v[110:111], v239 offset:1152
    ds_read_b64_tr_b16 v[112:113], v238 offset:9728
    ds_read_b64_tr_b16 v[114:115], v238 offset:10880
    ds_read_b64_tr_b16 v[116:117], v238 offset:9760
    ds_read_b64_tr_b16 v[118:119], v238 offset:10912
    ds_read_b64_tr_b16 v[120:121], v239 offset:9728
    ds_read_b64_tr_b16 v[122:123], v239 offset:10880
    ds_read_b64_tr_b16 v[124:125], v240 offset:0
    ds_read_b64_tr_b16 v[126:127], v240 offset:1152
    ds_read_b64_tr_b16 v[128:129], v240 offset:32
    ds_read_b64_tr_b16 v[130:131], v240 offset:1184
    ds_read_b64_tr_b16 v[132:133], v241 offset:0
    ds_read_b64_tr_b16 v[134:135], v241 offset:1152
    ds_read_b64_tr_b16 v[136:137], v240 offset:9728
    ds_read_b64_tr_b16 v[138:139], v240 offset:10880
    ds_read_b64_tr_b16 v[140:141], v240 offset:9760
    ds_read_b64_tr_b16 v[142:143], v240 offset:10912
    ds_read_b64_tr_b16 v[144:145], v241 offset:9728
    ds_read_b64_tr_b16 v[146:147], v241 offset:10880
    ds_read_b64_tr_b16 v[148:149], v242 offset:0
    ds_read_b64_tr_b16 v[150:151], v242 offset:1152
    ds_read_b64_tr_b16 v[152:153], v242 offset:32
    ds_read_b64_tr_b16 v[154:155], v242 offset:1184
    ds_read_b64_tr_b16 v[156:157], v243 offset:0
    ds_read_b64_tr_b16 v[158:159], v243 offset:1152
    ds_read_b64_tr_b16 v[160:161], v242 offset:9728
    ds_read_b64_tr_b16 v[162:163], v242 offset:10880
    ds_read_b64_tr_b16 v[164:165], v242 offset:9760
    ds_read_b64_tr_b16 v[166:167], v242 offset:10912
    ds_read_b64_tr_b16 v[168:169], v243 offset:9728
    ds_read_b64_tr_b16 v[170:171], v243 offset:10880
    ds_read_b64_tr_b16 v[172:173], v244 offset:0
    ds_read_b64_tr_b16 v[174:175], v244 offset:1152
    ds_read_b64_tr_b16 v[176:177], v244 offset:32
    ds_read_b64_tr_b16 v[178:179], v244 offset:1184
    ds_read_b64_tr_b16 v[180:181], v245 offset:0
    ds_read_b64_tr_b16 v[182:183], v245 offset:1152
    ds_read_b64_tr_b16 v[184:185], v244 offset:9728
    ds_read_b64_tr_b16 v[186:187], v244 offset:10880
    ds_read_b64_tr_b16 v[188:189], v244 offset:9760
    ds_read_b64_tr_b16 v[190:191], v244 offset:10912
    ds_read_b64_tr_b16 v[192:193], v245 offset:9728
    ds_read_b64_tr_b16 v[194:195], v245 offset:10880
    s_waitcnt lgkmcnt(0)
    s_barrier
    s_mov_b32 s48, 331776
    s_add_u32 m0, s51, 81920
    s_nop 0
    buffer_load_dwordx4 v232, s[24:27], s48 offen lds
    s_mov_b32 s48, 331776
    s_add_u32 m0, s51, 90112
    s_nop 0
    buffer_load_dwordx4 v233, s[24:27], s48 offen lds
    s_cmp_ge_u32 s8, 3
    s_cbranch_scc1 L_g3_nd4
    s_mov_b32 s48, 331776
    s_add_u32 m0, s51, 98304
    s_nop 0
    buffer_load_dwordx4 v234, s[24:27], s48 offen lds
L_g3_nd4:
    s_mov_b32 s48, 414720
    s_add_u32 m0, s51, 101376
    s_nop 0
    buffer_load_dwordx4 v232, s[24:27], s48 offen lds
    s_mov_b32 s48, 414720
    s_add_u32 m0, s51, 109568
    s_nop 0
    buffer_load_dwordx4 v233, s[24:27], s48 offen lds
    s_cmp_ge_u32 s8, 3
    s_cbranch_scc1 L_g3_nd5
    s_mov_b32 s48, 414720
    s_add_u32 m0, s51, 117760
    s_nop 0
    buffer_load_dwordx4 v234, s[24:27], s48 offen lds
L_g3_nd5:
    s_mov_b32 s48, 497664
    s_add_u32 m0, s51, 120832
    s_nop 0
    buffer_load_dwordx4 v232, s[24:27], s48 offen lds
    s_mov_b32 s48, 497664
    s_add_u32 m0, s51, 129024
    s_nop 0
    buffer_load_dwordx4 v233, s[24:27], s48 offen lds
    s_cmp_ge_u32 s8, 3
    s_cbranch_scc1 L_g3_nd6
    s_mov_b32 s48, 497664
    s_add_u32 m0, s51, 137216
    s_nop 0
    buffer_load_dwordx4 v234, s[24:27], s48 offen lds
L_g3_nd6:
    s_mov_b32 s48, 580608
    s_add_u32 m0, s51, 140288
    s_nop 0
    buffer_load_dwordx4 v232, s[24:27], s48 offen lds
    s_mov_b32 s48, 580608
    s_add_u32 m0, s51, 148480
    s_nop 0
    buffer_load_dwordx4 v233, s[24:27], s48 offen lds
    s_cmp_ge_u32 s8, 3
    s_cbranch_scc1 L_g3_nd7
    s_mov_b32 s48, 580608
    s_add_u32 m0, s51, 156672
    s_nop 0
    buffer_load_dwordx4 v234, s[24:27], s48 offen lds
L_g3_nd7:
    s_cmp_lg_u32 s8, 0
    s_cbranch_scc1 L_g3_fw
    s_lshl_b32 s9, s5, 3
    s_add_u32 s9, s9, s6
    s_lshl_b32 s9, s9, 4
    v_add_u32 v40, s9, v10
    v_lshlrev_b32 v40, 3, v40
    v_and_b32 v41, 1, v11
    s_lshr_b32 s9, s7, 2
    s_lshl_b32 s9, s9, 1
    v_add3_u32 v40, v40, v41, s9
    v_lshlrev_b32 v40, 8, v40
    s_mov_b32 s11, 0
L_g3_fp:
    buffer_load_dwordx2 v[42:43], v40, s[76:79], 0 offen offset:128 sc1
    s_waitcnt vmcnt(0)
    v_cmp_ne_u64 vcc, s[72:73], v[42:43]
    s_add_u32 s11, s11, 1
    s_cmp_eq_u64 vcc, 0
    s_cbranch_scc1 L_g3_fw
    s_cmp_lt_u32 s11, 0x40000
    s_cbranch_scc1 L_g3_fp
L_g3_fw:
    s_barrier
    v_add_u32 v14, 40960, v246
    s_mul_i32 s9, s8, 10240
    s_mov_b32 s48, 0
    s_add_u32 m0, s9, 0
    s_nop 0
    buffer_load_dwordx4 v255, s[36:39], s48 offen offset:0 sc1 lds
    buffer_load_dwordx4 v255, s[36:39], s48 offen offset:1024 sc1 lds
    buffer_load_dwordx4 v255, s[36:39], s48 offen offset:2048 sc1 lds
    buffer_load_dwordx4 v255, s[36:39], s48 offen offset:3072 sc1 lds
    s_mov_b32 s48, 4096
    s_add_u32 m0, s9, 4096
    s_nop 0
    buffer_load_dwordx4 v255, s[36:39], s48 offen offset:0 sc1 lds
    s_mov_b32 s48, 20480
    s_add_u32 m0, s9, 5120
    s_nop 0
    buffer_load_dwordx4 v255, s[36:39], s48 offen offset:0 sc1 lds
    buffer_load_dwordx4 v255, s[36:39], s48 offen offset:1024 sc1 lds
    buffer_load_dwordx4 v255, s[36:39], s48 offen offset:2048 sc1 lds
    buffer_load_dwordx4 v255, s[36:39], s48 offen offset:3072 sc1 lds
    s_mov_b32 s48, 24576
    s_add_u32 m0, s9, 9216
    s_nop 0
    buffer_load_dwordx4 v255, s[36:39], s48 offen offset:0 sc1 lds
    s_waitcnt vmcnt(0)
    s_barrier
    ds_read_b128 v[76:79], v246 offset:0
    ds_read_b128 v[80:83], v246 offset:1280
    ds_read_b128 v[84:87], v246 offset:5120
    ds_read_b128 v[88:91], v246 offset:6400
    ds_read_b64_tr_b16 v[196:197], v238 offset:0
    ds_read_b64_tr_b16 v[198:199], v238 offset:1152
    ds_read_b64_tr_b16 v[200:201], v238 offset:32
    ds_read_b64_tr_b16 v[202:203], v238 offset:1184
    ds_read_b64_tr_b16 v[204:205], v239 offset:0
    ds_read_b64_tr_b16 v[206:207], v239 offset:1152
    ds_read_b64_tr_b16 v[208:209], v238 offset:9728
    ds_read_b64_tr_b16 v[210:211], v238 offset:10880
    ds_read_b64_tr_b16 v[212:213], v238 offset:9760
    ds_read_b64_tr_b16 v[214:215], v238 offset:10912
    ds_read_b64_tr_b16 v[216:217], v239 offset:9728
    ds_read_b64_tr_b16 v[218:219], v239 offset:10880
    s_waitcnt lgkmcnt(14)
    v_mfma_f32_16x16x32_bf16 v[16:19], v[100:103], v[76:79], 0
    ds_read_b128 v[92:95], v246 offset:10240
    ds_read_b128 v[96:99], v246 offset:11520
    v_mfma_f32_16x16x32_bf16 v[28:31], v[100:103], v[80:83], 0
    v_mfma_f32_16x16x32_bf16 v[20:23], v[104:107], v[76:79], 0
    v_mfma_f32_16x16x32_bf16 v[32:35], v[104:107], v[80:83], 0
    v_mfma_f32_16x16x32_bf16 v[24:27], v[108:111], v[76:79], 0
    v_mfma_f32_16x16x32_bf16 v[36:39], v[108:111], v[80:83], 0
    s_waitcnt lgkmcnt(14)
    v_mfma_f32_16x16x32_bf16 v[16:19], v[112:115], v[84:87], v[16:19]
    ds_read_b128 v[76:79], v246 offset:15360
    ds_read_b128 v[80:83], v246 offset:16640
    v_mfma_f32_16x16x32_bf16 v[28:31], v[112:115], v[88:91], v[28:31]
    v_mfma_f32_16x16x32_bf16 v[20:23], v[116:119], v[84:87], v[20:23]
    v_mfma_f32_16x16x32_bf16 v[32:35], v[116:119], v[88:91], v[32:35]
    v_mfma_f32_16x16x32_bf16 v[24:27], v[120:123], v[84:87], v[24:27]
    v_mfma_f32_16x16x32_bf16 v[36:39], v[120:123], v[88:91], v[36:39]
    s_waitcnt lgkmcnt(4)
    s_barrier
    s_mov_b32 s48, 0
    s_add_u32 m0, s51, 81920
    s_nop 0
    buffer_load_dwordx4 v235, s[24:27], s48 offen lds
    s_mov_b32 s48, 0
    s_add_u32 m0, s51, 90112
    s_nop 0
    buffer_load_dwordx4 v236, s[24:27], s48 offen lds
    s_cmp_ge_u32 s8, 3
    s_cbranch_scc1 L_g3t_nd8
    s_mov_b32 s48, 0
    s_add_u32 m0, s51, 98304
    s_nop 0
    buffer_load_dwordx4 v237, s[24:27], s48 offen lds
L_g3t_nd8:
    s_waitcnt lgkmcnt(2)
    v_mfma_f32_16x16x32_bf16 v[16:19], v[124:127], v[92:95], v[16:19]
    ds_read_b128 v[84:87], v246 offset:20480
    ds_read_b128 v[88:91], v246 offset:21760
    v_mfma_f32_16x16x32_bf16 v[28:31], v[124:127], v[96:99], v[28:31]
    v_mfma_f32_16x16x32_bf16 v[20:23], v[128:131], v[92:95], v[20:23]
    v_mfma_f32_16x16x32_bf16 v[32:35], v[128:131], v[96:99], v[32:35]
    v_mfma_f32_16x16x32_bf16 v[24:27], v[132:135], v[92:95], v[24:27]
    v_mfma_f32_16x16x32_bf16 v[36:39], v[132:135], v[96:99], v[36:39]
    s_waitcnt lgkmcnt(2)
    v_mfma_f32_16x16x32_bf16 v[16:19], v[136:139], v[76:79], v[16:19]
    ds_read_b128 v[92:95], v246 offset:25600
    ds_read_b128 v[96:99], v246 offset:26880
    v_mfma_f32_16x16x32_bf16 v[28:31], v[136:139], v[80:83], v[28:31]
    v_mfma_f32_16x16x32_bf16 v[20:23], v[140:143], v[76:79], v[20:23]
    v_mfma_f32_16x16x32_bf16 v[32:35], v[140:143], v[80:83], v[32:35]
    v_mfma_f32_16x16x32_bf16 v[24:27], v[144:147], v[76:79], v[24:27]
    v_mfma_f32_16x16x32_bf16 v[36:39], v[144:147], v[80:83], v[36:39]
    s_waitcnt lgkmcnt(2)
    v_mfma_f32_16x16x32_bf16 v[16:19], v[148:151], v[84:87], v[16:19]
    ds_read_b128 v[76:79], v246 offset:30720
    ds_read_b128 v[80:83], v246 offset:32000
    v_mfma_f32_16x16x32_bf16 v[28:31], v[148:151], v[88:91], v[28:31]
    v_mfma_f32_16x16x32_bf16 v[20:23], v[152:155], v[84:87], v[20:23]
    v_mfma_f32_16x16x32_bf16 v[32:35], v[152:155], v[88:91], v[32:35]
    v_mfma_f32_16x16x32_bf16 v[24:27], v[156:159], v[84:87], v[24:27]
    v_mfma_f32_16x16x32_bf16 v[36:39], v[156:159], v[88:91], v[36:39]
    s_waitcnt lgkmcnt(2)
    v_mfma_f32_16x16x32_bf16 v[16:19], v[160:163], v[92:95], v[16:19]
    ds_read_b128 v[84:87], v246 offset:35840
    ds_read_b128 v[88:91], v246 offset:37120
    v_mfma_f32_16x16x32_bf16 v[28:31], v[160:163], v[96:99], v[28:31]
    v_mfma_f32_16x16x32_bf16 v[20:23], v[164:167], v[92:95], v[20:23]
    v_mfma_f32_16x16x32_bf16 v[32:35], v[164:167], v[96:99], v[32:35]
    v_mfma_f32_16x16x32_bf16 v[24:27], v[168:171], v[92:95], v[24:27]
    v_mfma_f32_16x16x32_bf16 v[36:39], v[168:171], v[96:99], v[36:39]
    s_waitcnt lgkmcnt(2)
    v_mfma_f32_16x16x32_bf16 v[16:19], v[172:175], v[76:79], v[16:19]
    ds_read_b128 v[92:95], v246 offset:40960
    ds_read_b128 v[96:99], v246 offset:42240
    v_mfma_f32_16x16x32_bf16 v[28:31], v[172:175], v[80:83], v[28:31]
    v_mfma_f32_16x16x32_bf16 v[20:23], v[176:179], v[76:79], v[20:23]
    v_mfma_f32_16x16x32_bf16 v[32:35], v[176:179], v[80:83], v[32:35]
    v_mfma_f32_16x16x32_bf16 v[24:27], v[180:183], v[76:79], v[24:27]
    v_mfma_f32_16x16x32_bf16 v[36:39], v[180:183], v[80:83], v[36:39]
    s_waitcnt lgkmcnt(2)
    v_mfma_f32_16x16x32_bf16 v[16:19], v[184:187], v[84:87], v[16:19]
    ds_read_b128 v[76:79], v246 offset:46080
    ds_read_b128 v[80:83], v246 offset:47360
    v_mfma_f32_16x16x32_bf16 v[28:31], v[184:187], v[88:91], v[28:31]
    v_mfma_f32_16x16x32_bf16 v[20:23], v[188:191], v[84:87], v[20:23]
    v_mfma_f32_16x16x32_bf16 v[32:35], v[188:191], v[88:91], v[32:35]
    v_mfma_f32_16x16x32_bf16 v[24:27], v[192:195], v[84:87], v[24:27]
    v_mfma_f32_16x16x32_bf16 v[36:39], v[192:195], v[88:91], v[36:39]
    s_waitcnt lgkmcnt(2)
    v_mfma_f32_16x16x32_bf16 v[16:19], v[196:199], v[92:95], v[16:19]
    ds_read_b128 v[84:87], v246 offset:51200
    ds_read_b128 v[88:91], v246 offset:52480
    v_mfma_f32_16x16x32_bf16 v[28:31], v[196:199], v[96:99], v[28:31]
    ds_read_b64_tr_b16 v[52:53], v240 offset:0
    ds_read_b64_tr_b16 v[54:55], v240 offset:1152
    v_mfma_f32_16x16x32_bf16 v[20:23], v[200:203], v[92:95], v[20:23]
    ds_read_b64_tr_b16 v[56:57], v240 offset:32
    ds_read_b64_tr_b16 v[58:59], v240 offset:1184
    v_mfma_f32_16x16x32_bf16 v[32:35], v[200:203], v[96:99], v[32:35]
    ds_read_b64_tr_b16 v[60:61], v241 offset:0
    ds_read_b64_tr_b16 v[62:63], v241 offset:1152
    v_mfma_f32_16x16x32_bf16 v[24:27], v[204:207], v[92:95], v[24:27]
    v_mfma_f32_16x16x32_bf16 v[36:39], v[204:207], v[96:99], v[36:39]
    s_waitcnt lgkmcnt(8)
    v_mfma_f32_16x16x32_bf16 v[16:19], v[208:211], v[76:79], v[16:19]
    ds_read_b128 v[92:95], v246 offset:56320
    ds_read_b128 v[96:99], v246 offset:57600
    v_mfma_f32_16x16x32_bf16 v[28:31], v[208:211], v[80:83], v[28:31]
    ds_read_b64_tr_b16 v[64:65], v240 offset:9728
    ds_read_b64_tr_b16 v[66:67], v240 offset:10880
    v_mfma_f32_16x16x32_bf16 v[20:23], v[212:215], v[76:79], v[20:23]
    ds_read_b64_tr_b16 v[68:69], v240 offset:9760
    ds_read_b64_tr_b16 v[70:71], v240 offset:10912
    v_mfma_f32_16x16x32_bf16 v[32:35], v[212:215], v[80:83], v[32:35]
    ds_read_b64_tr_b16 v[72:73], v241 offset:9728
    ds_read_b64_tr_b16 v[74:75], v241 offset:10880
    v_mfma_f32_16x16x32_bf16 v[24:27], v[216:219], v[76:79], v[24:27]
    v_mfma_f32_16x16x32_bf16 v[36:39], v[216:219], v[80:83], v[36:39]
    s_waitcnt lgkmcnt(12)
    v_mfma_f32_16x16x32_bf16 v[16:19], v[52:55], v[84:87], v[16:19]
    ds_read_b128 v[76:79], v246 offset:61440
    ds_read_b128 v[80:83], v246 offset:62720
    v_mfma_f32_16x16x32_bf16 v[28:31], v[52:55], v[88:91], v[28:31]
    ds_read_b64_tr_b16 v[40:41], v242 offset:0
    ds_read_b64_tr_b16 v[42:43], v242 offset:1152
    s_waitcnt lgkmcnt(14)
    v_mfma_f32_16x16x32_bf16 v[20:23], v[56:59], v[84:87], v[20:23]
    ds_read_b64_tr_b16 v[44:45], v242 offset:32
    ds_read_b64_tr_b16 v[46:47], v242 offset:1184
    v_mfma_f32_16x16x32_bf16 v[32:35], v[56:59], v[88:91], v[32:35]
    ds_read_b64_tr_b16 v[48:49], v243 offset:0
    ds_read_b64_tr_b16 v[50:51], v243 offset:1152
    s_waitcnt lgkmcnt(15)
    v_mfma_f32_16x16x32_bf16 v[24:27], v[60:63], v[84:87], v[24:27]
    v_mfma_f32_16x16x32_bf16 v[36:39], v[60:63], v[88:91], v[36:39]
    s_waitcnt lgkmcnt(12)
    v_mfma_f32_16x16x32_bf16 v[16:19], v[64:67], v[92:95], v[16:19]
    ds_read_b128 v[84:87], v14 offset:25600
    ds_read_b128 v[88:91], v14 offset:26880
    v_mfma_f32_16x16x32_bf16 v[28:31], v[64:67], v[96:99], v[28:31]
    ds_read_b64_tr_b16 v[52:53], v242 offset:9728
    ds_read_b64_tr_b16 v[54:55], v242 offset:10880
    s_waitcnt lgkmcnt(14)
    v_mfma_f32_16x16x32_bf16 v[20:23], v[68:71], v[92:95], v[20:23]
    ds_read_b64_tr_b16 v[56:57], v242 offset:9760
    ds_read_b64_tr_b16 v[58:59], v242 offset:10912
    v_mfma_f32_16x16x32_bf16 v[32:35], v[68:71], v[96:99], v[32:35]
    ds_read_b64_tr_b16 v[60:61], v243 offset:9728
    ds_read_b64_tr_b16 v[62:63], v243 offset:10880
    s_waitcnt lgkmcnt(15)
    v_mfma_f32_16x16x32_bf16 v[24:27], v[72:75], v[92:95], v[24:27]
    v_mfma_f32_16x16x32_bf16 v[36:39], v[72:75], v[96:99], v[36:39]
    s_waitcnt lgkmcnt(12)
    v_mfma_f32_16x16x32_bf16 v[16:19], v[40:43], v[76:79], v[16:19]
    ds_read_b128 v[92:95], v14 offset:30720
    ds_read_b128 v[96:99], v14 offset:32000
    v_mfma_f32_16x16x32_bf16 v[28:31], v[40:43], v[80:83], v[28:31]
    ds_read_b64_tr_b16 v[64:65], v244 offset:0
    ds_read_b64_tr_b16 v[66:67], v244 offset:1152
    s_waitcnt lgkmcnt(14)
    v_mfma_f32_16x16x32_bf16 v[20:23], v[44:47], v[76:79], v[20:23]
    ds_read_b64_tr_b16 v[68:69], v244 offset:32
    ds_read_b64_tr_b16 v[70:71], v244 offset:1184
    v_mfma_f32_16x16x32_bf16 v[32:35], v[44:47], v[80:83], v[32:35]
    ds_read_b64_tr_b16 v[72:73], v245 offset:0
    ds_read_b64_tr_b16 v[74:75], v245 offset:1152
    s_waitcnt lgkmcnt(15)
    v_mfma_f32_16x16x32_bf16 v[24:27], v[48:51], v[76:79], v[24:27]
    v_mfma_f32_16x16x32_bf16 v[36:39], v[48:51], v[80:83], v[36:39]
    s_waitcnt lgkmcnt(12)
    v_mfma_f32_16x16x32_bf16 v[16:19], v[52:55], v[84:87], v[16:19]
    ds_read_b128 v[76:79], v14 offset:35840
    ds_read_b128 v[80:83], v14 offset:37120
    v_mfma_f32_16x16x32_bf16 v[28:31], v[52:55], v[88:91], v[28:31]
    ds_read_b64_tr_b16 v[40:41], v244 offset:9728
    ds_read_b64_tr_b16 v[42:43], v244 offset:10880
    s_waitcnt lgkmcnt(14)
    v_mfma_f32_16x16x32_bf16 v[20:23], v[56:59], v[84:87], v[20:23]
    ds_read_b64_tr_b16 v[44:45], v244 offset:9760
    ds_read_b64_tr_b16 v[46:47], v244 offset:10912
    v_mfma_f32_16x16x32_bf16 v[32:35], v[56:59], v[88:91], v[32:35]
    ds_read_b64_tr_b16 v[48:49], v245 offset:9728
    ds_read_b64_tr_b16 v[50:51], v245 offset:10880
    s_waitcnt lgkmcnt(15)
    v_mfma_f32_16x16x32_bf16 v[24:27], v[60:63], v[84:87], v[24:27]
    v_mfma_f32_16x16x32_bf16 v[36:39], v[60:63], v[88:91], v[36:39]
    s_waitcnt vmcnt(0)
    s_barrier
    s_waitcnt lgkmcnt(12)
    v_mfma_f32_16x16x32_bf16 v[16:19], v[64:67], v[92:95], v[16:19]
    ds_read_b64 v[84:85], v247 offset:0
    ds_read_b64 v[86:87], v247 offset:5120
    v_mfma_f32_16x16x32_bf16 v[28:31], v[64:67], v[96:99], v[28:31]
    ds_read_b64 v[88:89], v247 offset:1280
    ds_read_b64 v[90:91], v247 offset:6400
    s_waitcnt lgkmcnt(14)
    v_mfma_f32_16x16x32_bf16 v[20:23], v[68:71], v[92:95], v[20:23]
    ds_read_b64_tr_b16 v[52:53], v238 offset:0
    ds_read_b64_tr_b16 v[54:55], v238 offset:1152
    v_mfma_f32_16x16x32_bf16 v[32:35], v[68:71], v[96:99], v[32:35]
    ds_read_b64_tr_b16 v[56:57], v238 offset:32
    ds_read_b64_tr_b16 v[58:59], v238 offset:1184
    s_waitcnt lgkmcnt(15)
    v_mfma_f32_16x16x32_bf16 v[24:27], v[72:75], v[92:95], v[24:27]
    ds_read_b64_tr_b16 v[60:61], v239 offset:0
    ds_read_b64_tr_b16 v[62:63], v239 offset:1152
    v_mfma_f32_16x16x32_bf16 v[36:39], v[72:75], v[96:99], v[36:39]
    s_waitcnt lgkmcnt(14)
    v_mfma_f32_16x16x32_bf16 v[16:19], v[40:43], v[76:79], v[16:19]
    ds_read_b64 v[92:93], v247 offset:40960
    ds_read_b64 v[94:95], v247 offset:46080
    v_mfma_f32_16x16x32_bf16 v[28:31], v[40:43], v[80:83], v[28:31]
    ds_read_b64 v[96:97], v247 offset:42240
    ds_read_b64 v[98:99], v247 offset:47360
    s_waitcnt lgkmcnt(15)
    v_mfma_f32_16x16x32_bf16 v[20:23], v[44:47], v[76:79], v[20:23]
    ds_read_b64_tr_b16 v[64:65], v238 offset:9728
    ds_read_b64_tr_b16 v[66:67], v238 offset:10880
    v_mfma_f32_16x16x32_bf16 v[32:35], v[44:47], v[80:83], v[32:35]
    ds_read_b64_tr_b16 v[68:69], v238 offset:9760
    ds_read_b64_tr_b16 v[70:71], v238 offset:10912
    s_waitcnt lgkmcnt(15)
    v_mfma_f32_16x16x32_bf16 v[24:27], v[48:51], v[76:79], v[24:27]
    ds_read_b64_tr_b16 v[72:73], v239 offset:9728
    ds_read_b64_tr_b16 v[74:75], v239 offset:10880
    v_mfma_f32_16x16x32_bf16 v[36:39], v[48:51], v[80:83], v[36:39]
    s_waitcnt lgkmcnt(14)
    v_mfma_f32_16x16x32_bf16 v[16:19], v[52:55], v[84:87], v[16:19]
    v_mfma_f32_16x16x32_bf16 v[28:31], v[52:55], v[88:91], v[28:31]
    s_waitcnt lgkmcnt(12)
    v_mfma_f32_16x16x32_bf16 v[20:23], v[56:59], v[84:87], v[20:23]
    v_mfma_f32_16x16x32_bf16 v[32:35], v[56:59], v[88:91], v[32:35]
    s_waitcnt lgkmcnt(10)
    v_mfma_f32_16x16x32_bf16 v[24:27], v[60:63], v[84:87], v[24:27]
    v_mfma_f32_16x16x32_bf16 v[36:39], v[60:63], v[88:91], v[36:39]
    s_waitcnt lgkmcnt(4)
    v_mfma_f32_16x16x32_bf16 v[16:19], v[64:67], v[92:95], v[16:19]
    v_mfma_f32_16x16x32_bf16 v[28:31], v[64:67], v[96:99], v[28:31]
    s_waitcnt lgkmcnt(2)
    v_mfma_f32_16x16x32_bf16 v[20:23], v[68:71], v[92:95], v[20:23]
    v_mfma_f32_16x16x32_bf16 v[32:35], v[68:71], v[96:99], v[32:35]
    s_waitcnt lgkmcnt(0)
    v_mfma_f32_16x16x32_bf16 v[24:27], v[72:75], v[92:95], v[24:27]
    v_mfma_f32_16x16x32_bf16 v[36:39], v[72:75], v[96:99], v[36:39]
    s_nop 7
    v_cvt_pk_bf16_f32 v44, v16, v17
    v_cvt_pk_bf16_f32 v45, v18, v19
    v_cvt_pk_bf16_f32 v46, v20, v21
    v_cvt_pk_bf16_f32 v47, v22, v23
    v_cvt_pk_bf16_f32 v48, v24, v25
    v_cvt_pk_bf16_f32 v49, v26, v27
    v_cvt_pk_bf16_f32 v50, v28, v29
    v_cvt_pk_bf16_f32 v51, v30, v31
    v_cvt_pk_bf16_f32 v52, v32, v33
    v_cvt_pk_bf16_f32 v53, v34, v35
    v_cvt_pk_bf16_f32 v54, v36, v37
    v_cvt_pk_bf16_f32 v55, v38, v39
    s_barrier
    ds_write_b64 v248, v[44:45] offset:0
    ds_write_b64 v248, v[46:47] offset:32
    ds_write_b64 v248, v[48:49] offset:64
    ds_write_b64 v248, v[50:51] offset:4864
    ds_write_b64 v248, v[52:53] offset:4896
    ds_write_b64 v248, v[54:55] offset:4928
    s_waitcnt lgkmcnt(0)
    s_barrier
L_p2_store:
    ds_read_b128 v[44:47], v249 offset:0
    ds_read_b128 v[48:51], v250 offset:0
    s_cmp_ge_u32 s8, 2
    s_cbranch_scc1 L_p2_st2
    ds_read_b128 v[52:55], v251 offset:0
    s_waitcnt lgkmcnt(0)
    buffer_store_dwordx4 v[52:55], v254, s[28:31], 0 offen nt
L_p2_st2:
    s_waitcnt lgkmcnt(0)
    buffer_store_dwordx4 v[44:47], v252, s[28:31], 0 offen nt
    buffer_store_dwordx4 v[48:51], v253, s[28:31], 0 offen nt
L_end:
    s_endpgm
.section .rodata,"a"
.p2align 6
.amdhsa_kernel concat_heads__linear_kernel_hedgehog__sliding_local_dilated__prompt_kernel
  .amdhsa_next_free_vgpr 256
  .amdhsa_next_free_sgpr 102
  .amdhsa_accum_offset 256
  .amdhsa_group_segment_fixed_size 0
  .amdhsa_kernarg_size 80
  .amdhsa_user_sgpr_count 2
  .amdhsa_user_sgpr_kernarg_segment_ptr 1
  .amdhsa_system_sgpr_workgroup_id_x 1
.end_amdhsa_kernel
```
